```python
import torch

def _softmax(x, axis=-1):
    return torch.softmax(x, dim=axis)
def _gelu(x):
    return torch.nn.functional.gelu(x, approximate="tanh")
def _silu(x):
    return torch.nn.functional.silu(x)
def _sigmoid(x):
    return torch.sigmoid(x)
def _layernorm(x, axis=-1, eps=1e-5):
    m = x.mean(dim=axis, keepdim=True)
    v = x.var(dim=axis, keepdim=True, unbiased=False)
    return (x - m) / torch.sqrt(v + eps)
def _scatter_add(tgt, idx, src, axis=0):
    return tgt.clone().index_add_(axis, idx, src)
def _segment_sum(src, seg, n):
    out = torch.zeros((n,) + src.shape[1:], dtype=src.dtype)
    return out.index_add_(0, seg, src)
def _pad(x, pw):
    flat = tuple(v for pair in reversed(pw) for v in pair)
    return torch.nn.functional.pad(x, flat)

kernel_name = 'recurrent_scan__sliding_block_cached__swiglu_ffn__prompt'

def setup_inputs():

    _w = (lambda a: (lambda t: t.to(torch.bfloat16) if t.is_floating_point() else t)(torch.as_tensor(a)))
    def _A_setup():
        B, Sq, D = 1, 2048, 640
        Hq, Hkv, Sk, Dh = 32, 32, 2048, 128
        assert Hq % Hkv == 0, (Hq, Hkv)
        return {
            "x": _w((lambda *s: torch.randn(*s, dtype=torch.bfloat16) * 0.05)(B, Sq, D)),
            "k_cache": _w((lambda *s: torch.randn(*s, dtype=torch.bfloat16) * 0.8)(B, Hkv, Sk, Dh)),
            "v_cache": _w((lambda *s: torch.randn(*s, dtype=torch.bfloat16) * 0.2)(B, Hkv, Sk, Dh)),
            "wq": _w((lambda *s: torch.randn(*s, dtype=torch.bfloat16) * 0.8)(D, Hq * Dh) * (D ** -0.5)),
            "wo": _w((lambda *s: torch.randn(*s, dtype=torch.bfloat16) * 0.2)(Hq * Dh, D) * ((Hq * Dh) ** -0.5)),
        }
    _A_in = _A_setup()

    def _B_setup():
        B, S, D, F = 1, 2048, 640, 1728
        return {
            "x": _w((lambda *s: torch.randn(*s, dtype=torch.bfloat16) * 0.05)(B, S, D)),
            "w_gate": _w((lambda *s: torch.randn(*s, dtype=torch.bfloat16) * 0.1)(D, F)),
            "w_up": _w((lambda *s: torch.randn(*s, dtype=torch.bfloat16) * 0.1)(D, F)),
            "w_down": _w((lambda *s: torch.randn(*s, dtype=torch.bfloat16) * 0.1)(F, D)),
        }
    _B_in = _B_setup()

    return {
        "A_x": _A_in["x"],
        "A_k_cache": _A_in["k_cache"],
        "A_v_cache": _A_in["v_cache"],
        "A_wq": _A_in["wq"],
        "A_wo": _A_in["wo"],
        "B_x": _B_in["x"],
        "B_w_gate": _B_in["w_gate"],
        "B_w_up": _B_in["w_up"],
        "B_w_down": _B_in["w_down"],
    }

def reference(A_x, A_k_cache, A_v_cache, A_wq, A_wo, B_x, B_w_gate, B_w_up, B_w_down):
    def _A_ref(x, k_cache, v_cache, wq, wo):
        B, Sq, D = x.shape
        Hq, Dh = 32, 128
        Hkv, Sk = k_cache.shape[1], k_cache.shape[2]
        W = min(4096, max(256, Sk // 4))
        rep = Hq // Hkv
        q = (lambda x, *d: x.permute(*d))((x @ wq).reshape(B, Sq, Hq, Dh), 0, 2, 1, 3)
        k = (lambda x, n, axis: torch.repeat_interleave(x, n, dim=axis))(k_cache[:, :, Sk - W:, :], rep, axis=1)
        v = (lambda x, n, axis: torch.repeat_interleave(x, n, dim=axis))(v_cache[:, :, Sk - W:, :], rep, axis=1)
        scores = torch.einsum("bhqd,bhkd->bhqk", q, k) * (Dh ** -0.5)
        p = _softmax(scores, axis=-1)
        o = torch.einsum("bhqk,bhkd->bhqd", p, v)
        return (lambda x, *d: x.permute(*d))(o, 0, 2, 1, 3).reshape(B, Sq, Hq * Dh) @ wo

    def _B_ref(x, w_gate, w_up, w_down):
        g = _silu(x @ w_gate)
        u = x @ w_up
        return (g * u) @ w_down

    x = A_x
    xn = _layernorm(x, axis=-1)
    s = _A_ref(xn, A_k_cache, A_v_cache, A_wq, A_wo)
    g = _silu(_B_ref(xn, B_w_gate, B_w_up, B_w_down))
    return x + s * g
```

```asm
; @launch grid=(256,1,1) block=(256,1,1) lds=163840
.amdgcn_target "amdgcn-amd-amdhsa--gfx950"
.text
.globl recurrent_scan__sliding_block_cached__swiglu_ffn__prompt_kernel
.p2align 8
.type recurrent_scan__sliding_block_cached__swiglu_ffn__prompt_kernel,@function
recurrent_scan__sliding_block_cached__swiglu_ffn__prompt_kernel:
  s_cmp_ge_u32 s2, 256
  s_cbranch_scc1 L_k1_end
  s_load_dwordx16 s[48:63], s[0:1], 0
  s_load_dwordx8 s[64:71], s[0:1], 64
  s_and_b32 s4, s2, 31
  s_lshr_b32 s5, s2, 5
  v_and_b32 v6, 63, v0
  v_lshrrev_b32 v1, 6, v0
  s_nop 0
  v_readfirstlane_b32 s3, v1
  s_bfe_u32 s6, s4, 0x10002
  s_lshr_b32 s82, s4, 3
  s_and_b32 s83, s4, 3
  s_lshl2_add_u32 s83, s82, s83
  s_mul_i32 s83, s83, 7
  s_add_u32 s83, s83, 3
  s_and_b32 s84, s4, 7
  s_mul_i32 s84, s84, 3
  s_and_b32 s85, s4, 4
  s_sub_u32 s84, s84, s85
  s_add_u32 s84, s84, 87
  s_cmp_lt_u32 s82, 3
  s_cselect_b32 s81, s83, s84
  s_mov_b32 s80, 0xffff0000
  s_lshl_b32 s77, s3, 12
  s_lshl_b32 s78, s3, 11
  s_add_u32 s78, s78, 49152
  s_lshl_b32 s79, s3, 14
  s_add_u32 s79, s79, 98304
  s_mul_i32 s72, s6, 163840
  s_sub_u32 s73, 163840, s72
  s_lshl_b32 s82, s3, 4
  s_lshl_b32 s83, s4, 8
  v_lshrrev_b32 v1, 4, v6
  v_and_b32 v2, 15, v6
  v_lshlrev_b32 v3, 2, v1
  v_xor_b32 v3, v3, v2
  v_lshlrev_b32 v3, 4, v3
  v_add_u32 v7, s82, v1
  v_lshl_add_u32 v241, v7, 8, v3
  v_lshl_add_u32 v10, v7, 13, v3
  v_add_u32 v229, s83, v10
  v_add_u32 v230, 31744, v229
  v_add_u32 v231, 63488, v229
  v_add_u32 v232, 95232, v229
  v_add_u32 v10, 0, v1
  v_xor_b32 v10, v10, v2
  v_lshlrev_b32 v10, 4, v10
  v_lshl_add_u32 v237, v7, 8, v10
  v_add_u32 v10, 4, v1
  v_xor_b32 v10, v10, v2
  v_lshlrev_b32 v10, 4, v10
  v_lshl_add_u32 v238, v7, 8, v10
  v_add_u32 v10, 8, v1
  v_xor_b32 v10, v10, v2
  v_lshlrev_b32 v10, 4, v10
  v_lshl_add_u32 v239, v7, 8, v10
  v_add_u32 v10, 12, v1
  v_xor_b32 v10, v10, v2
  v_lshlrev_b32 v10, 4, v10
  v_lshl_add_u32 v240, v7, 8, v10
  v_lshrrev_b32 v1, 3, v6
  v_and_b32 v2, 7, v6
  v_add_u32 v7, s82, v1
  v_mul_u32_u24 v7, 3456, v7
  v_and_b32 v3, 1, v2
  v_lshl_add_u32 v7, v3, 4, v7
  v_and_b32 v3, 2, v1
  v_lshrrev_b32 v10, 1, v2
  v_xor_b32 v3, v3, v10
  s_lshl2_add_u32 s83, s6, s81
  s_sub_u32 s83, s83, 3
  s_lshl_b32 s83, s83, 5
  s_lshl_b32 s84, s81, 5
  v_mov_b32 v11, s84
  v_lshlrev_b32 v10, 5, v3
  v_add_u32 v10, s83, v10
  v_cmp_eq_u32 vcc, 3, v3
  s_nop 1
  v_cndmask_b32 v10, v10, v11, vcc
  v_add_u32 v233, v7, v10
  v_add_u32 v234, 26624, v233
  v_xor_b32 v3, 1, v3
  v_lshlrev_b32 v10, 5, v3
  v_add_u32 v10, s83, v10
  v_cmp_eq_u32 vcc, 3, v3
  s_nop 1
  v_cndmask_b32 v10, v10, v11, vcc
  v_add_u32 v235, v7, v10
  v_add_u32 v236, 26624, v235
  s_lshl_b32 s83, s3, 5
  v_add_u32 v7, s83, v1
  v_mul_u32_u24 v7, 1280, v7
  v_lshrrev_b32 v3, 1, v1
  v_or_b32 v10, 0, v3
  v_xor_b32 v10, v10, v2
  v_lshl_add_u32 v10, v10, 4, v7
  v_mov_b32 v225, v10
  v_or_b32 v10, 4, v3
  v_xor_b32 v10, v10, v2
  v_lshl_add_u32 v10, v10, 4, v7
  v_add_u32 v226, 9216, v10
  v_or_b32 v10, 0, v3
  v_xor_b32 v10, v10, v2
  v_lshl_add_u32 v10, v10, 4, v7
  v_add_u32 v227, 18432, v10
  v_or_b32 v10, 4, v3
  v_xor_b32 v10, v10, v2
  v_lshl_add_u32 v10, v10, 4, v7
  v_add_u32 v228, 27648, v10
  s_lshr_b32 s83, s4, 3
  s_lshl2_add_u32 s83, s83, s3
  s_mul_i32 s83, s83, 20480
  v_and_b32 v10, 15, v6
  v_mul_u32_u24 v10, 1280, v10
  v_lshrrev_b32 v11, 4, v6
  v_lshl_add_u32 v10, v11, 7, v10
  v_add_u32 v10, s83, v10
  v_mov_b32 v12, 0x40000000
  v_cmp_gt_u32 vcc, 16, v6
  s_nop 1
  v_cndmask_b32 v242, v12, v10, vcc
  s_lshl2_add_u32 s83, s5, s3
  s_lshl_b32 s83, s83, 1
  v_lshrrev_b32 v10, 2, v6
  v_lshlrev_b32 v10, 6, v10
  v_bfe_u32 v11, v6, 1, 1
  v_add3_u32 v10, v10, v11, s83
  v_and_b32 v11, 1, v6
  v_lshlrev_b32 v13, 13, v10
  v_lshl_add_u32 v13, v11, 7, v13
  s_lshl_b32 s83, s4, 8
  v_add_u32 v13, s83, v13
  v_cmp_gt_u32 vcc, 4, v6
  s_nop 1
  v_cndmask_b32 v243, v12, v13, vcc
  v_mul_u32_u24 v10, 3456, v10
  v_mul_u32_u24 v11, 96, v11
  s_mul_i32 s83, s6, 3
  s_add_u32 s83, s83, s81
  s_sub_u32 s83, s83, 3
  s_lshl_b32 s83, s83, 5
  v_add3_u32 v10, v10, v11, s83
  v_cndmask_b32 v244, v12, v10, vcc
  s_waitcnt lgkmcnt(0)
  s_mov_b32 s12, s54
  s_mov_b32 s13, s55
  s_mov_b32 s14, 5242880
  s_mov_b32 s15, 0x20000
  s_mov_b32 s16, s60
  s_mov_b32 s17, s61
  s_mov_b32 s18, 2211840
  s_mov_b32 s19, 0x20000
  s_mov_b32 s20, s62
  s_mov_b32 s21, s63
  s_mov_b32 s22, 2211840
  s_mov_b32 s23, 0x20000
  s_mul_i32 s83, s5, 327680
  s_add_u32 s8, s48, s83
  s_addc_u32 s9, s49, 0
  s_mov_b32 s10, 327680
  s_mov_b32 s11, 0x20000
  s_mov_b32 s85, 0
  buffer_load_dword a204, v242, s[8:11], s85 offen
  s_mov_b32 s85, 0
  buffer_load_dword a204, v243, s[12:15], s85 offen
  s_mov_b32 s85, 0
  buffer_load_dword a204, v244, s[16:19], s85 offen
  s_mov_b32 s85, 0
  buffer_load_dword a204, v244, s[20:23], s85 offen
  s_getpc_b64 s[84:85]
L_pc:
  s_lshr_b32 s82, s2, 3
  s_lshl2_add_u32 s82, s82, s3
  s_mul_i32 s82, s82, 512
  s_min_u32 s82, s82, L_k1_end-L_pc-512
  s_add_u32 s84, s84, s82
  s_addc_u32 s85, s85, 0
  s_load_dword s89, s[84:85], 0
  s_load_dword s89, s[84:85], 64
  s_load_dword s89, s[84:85], 128
  s_load_dword s89, s[84:85], 192
  s_load_dword s89, s[84:85], 256
  s_load_dword s89, s[84:85], 320
  s_load_dword s89, s[84:85], 384
  s_load_dword s89, s[84:85], 448
  s_lshl_b32 s83, s4, 19
  s_add_u32 s83, s83, 393216
  s_add_u32 s24, s50, s83
  s_addc_u32 s25, s51, 0
  s_mov_b32 s26, 131072
  s_mov_b32 s27, 0x20000
  s_add_u32 s28, s52, s83
  s_addc_u32 s29, s53, 0
  s_mov_b32 s30, 131072
  s_mov_b32 s31, 0x20000
  s_mul_i32 s83, s5, 2990080
  s_add_u32 s32, s70, s83
  s_addc_u32 s33, s71, 0
  s_mov_b32 s34, 2990080
  s_mov_b32 s35, 0x20000
  s_mov_b32 s36, s56
  s_mov_b32 s37, s57
  s_mov_b32 s38, 5242880
  s_mov_b32 s39, 0x20000
  s_mov_b32 s40, s64
  s_mov_b32 s41, s65
  s_mov_b32 s42, 2211840
  s_mov_b32 s43, 0x20000
  s_mov_b32 s50, 2621440
  s_mov_b32 s51, 0x20000
  s_and_b32 s7, s4, 3
  s_lshr_b32 s88, s4, 2
  s_and_b32 s84, s4, 4
  s_mul_i32 s84, s84, 373760
  s_add_u32 s83, s83, s84
  s_add_u32 s52, s70, s83
  s_addc_u32 s53, s71, 0
  s_mov_b32 s54, 1495040
  s_mov_b32 s55, 0x20000
  s_mov_b32 s56, s66
  s_mov_b32 s57, s67
  s_mov_b32 s58, 2621440
  s_mov_b32 s59, 0x20000
  s_mov_b32 s60, s68
  s_mov_b32 s61, s69
  s_mov_b32 s62, 256
  s_mov_b32 s63, 0x20000
  s_add_u32 s64, s70, 25165824
  s_addc_u32 s65, s71, 0
  s_mov_b32 s66, 18894848
  s_mov_b32 s67, 0x20000
  s_lshl_b32 s83, s5, 2
  s_add_u32 s83, s83, s7
  s_lshl_b32 s83, s83, 7
  s_lshl_b32 s84, s88, 2
  s_add_u32 s83, s83, s84
  s_add_u32 s68, s83, 18874368
  s_lshr_b32 s83, s2, 2
  s_lshl_b32 s83, s83, 7
  s_lshl_b32 s84, s7, 2
  s_add_u32 s83, s83, s84
  s_add_u32 s69, s83, 18878464
  s_lshl_b32 s86, s5, 5
  s_mov_b32 s87, 30000
  v_lshrrev_b32 v1, 5, v6
  v_bfe_u32 v2, v6, 2, 2
  v_and_b32 v3, 3, v6
  v_bfe_u32 v7, v6, 4, 1
  v_and_b32 v10, 1, v3
  v_lshlrev_b32 v12, 4, v10
  v_lshrrev_b32 v10, 1, v3
  v_lshl_add_u32 v12, v10, 3, v12
  v_lshl_add_u32 v13, v1, 3, v2
  v_lshl_add_u32 v14, v7, 5, v12
  v_lshl_add_u32 v15, v13, 8, v14
  s_add_u32 s83, s3, 0
  s_and_b32 s83, s83, 3
  v_xor_b32 v10, s83, v2
  v_lshl_add_u32 v212, v10, 6, v15
  s_add_u32 s83, s3, 1
  s_and_b32 s83, s83, 3
  v_xor_b32 v10, s83, v2
  v_lshl_add_u32 v213, v10, 6, v15
  s_add_u32 s83, s3, 2
  s_and_b32 s83, s83, 3
  v_xor_b32 v10, s83, v2
  v_lshl_add_u32 v214, v10, 6, v15
  s_add_u32 s83, s3, 3
  s_and_b32 s83, s83, 3
  v_xor_b32 v10, s83, v2
  v_lshl_add_u32 v215, v10, 6, v15
  v_lshl_add_u32 v10, v1, 2, v2
  v_lshl_add_u32 v15, v10, 8, v14
  v_add_u32 v15, 49152, v15
  v_xor_b32 v10, 0, v2
  v_lshl_add_u32 v250, v10, 6, v15
  v_xor_b32 v10, 1, v2
  v_lshl_add_u32 v251, v10, 6, v15
  v_xor_b32 v10, 2, v2
  v_lshl_add_u32 v252, v10, 6, v15
  v_xor_b32 v10, 3, v2
  v_lshl_add_u32 v253, v10, 6, v15
  v_lshl_add_u32 v15, v13, 7, v12
  v_lshl_add_u32 v15, v7, 13, v15
  v_add_u32 v15, 49152, v15
  v_and_b32 v14, 2, v2
  v_or_b32 v14, v14, v7
  v_xor_b32 v10, 0, v14
  v_lshl_add_u32 v216, v10, 5, v15
  v_xor_b32 v10, 1, v14
  v_lshl_add_u32 v217, v10, 5, v15
  v_xor_b32 v10, 2, v14
  v_lshl_add_u32 v218, v10, 5, v15
  v_xor_b32 v10, 3, v14
  v_lshl_add_u32 v219, v10, 5, v15
  v_xor_b32 v10, s3, v14
  v_lshl_add_u32 v220, v10, 5, v15
  v_and_b32 v13, 31, v6
  v_lshlrev_b32 v15, 7, v13
  v_add_u32 v15, s79, v15
  v_bfe_u32 v14, v6, 1, 3
  v_xor_b32 v14, v14, v1
  v_xor_b32 v10, 0, v14
  v_lshl_add_u32 v221, v10, 4, v15
  v_xor_b32 v10, 2, v14
  v_lshl_add_u32 v222, v10, 4, v15
  v_xor_b32 v10, 4, v14
  v_lshl_add_u32 v223, v10, 4, v15
  v_xor_b32 v10, 6, v14
  v_lshl_add_u32 v224, v10, 4, v15
  v_and_b32 v10, 1, v6
  v_cmp_eq_u32 vcc, v10, v7
  v_mov_b32 v11, 0x3f803f80
  s_nop 0
  v_cndmask_b32 v10, 0, v11, vcc
  v_accvgpr_write_b32 a200, v10
  v_accvgpr_write_b32 a201, v10
  v_accvgpr_write_b32 a202, v10
  v_accvgpr_write_b32 a203, v10
  v_mov_b32 v192, 0
  v_mov_b32 v193, 0
  v_mov_b32 v194, 0
  v_mov_b32 v195, 0
  v_mov_b32 v196, 0
  v_mov_b32 v197, 0
  v_mov_b32 v198, 0
  v_mov_b32 v199, 0
  s_add_u32 m0, s77, 0
  s_mov_b32 s74, 0
  buffer_load_dwordx4 v229, s[12:15], s74 offen lds
  buffer_load_dwordx4 v230, s[12:15], s74 offen offset:1024 lds
  buffer_load_dwordx4 v231, s[12:15], s74 offen offset:2048 lds
  buffer_load_dwordx4 v232, s[12:15], s74 offen offset:3072 lds
  s_add_u32 m0, s78, 0
  s_mov_b32 s75, 0
  buffer_load_dwordx4 v233, s[16:19], s75 offen lds
  buffer_load_dwordx4 v234, s[16:19], s75 offen offset:1024 lds
  s_add_u32 m0, s78, 8192
  s_nop 0
  buffer_load_dwordx4 v235, s[20:23], s75 offen lds
  buffer_load_dwordx4 v236, s[20:23], s75 offen offset:1024 lds
  s_add_u32 m0, s79, 0
  s_add_u32 s76, s72, 0
  buffer_load_dwordx4 v225, s[8:11], s76 offen lds
  buffer_load_dwordx4 v226, s[8:11], s76 offen offset:1024 lds
  buffer_load_dwordx4 v227, s[8:11], s76 offen offset:2048 lds
  buffer_load_dwordx4 v228, s[8:11], s76 offen offset:3072 lds
  s_add_u32 m0, s79, 4096
  s_add_u32 s76, s73, 0
  buffer_load_dwordx4 v225, s[8:11], s76 offen lds
  buffer_load_dwordx4 v226, s[8:11], s76 offen offset:1024 lds
  buffer_load_dwordx4 v227, s[8:11], s76 offen offset:2048 lds
  buffer_load_dwordx4 v228, s[8:11], s76 offen offset:3072 lds
  s_mov_b32 s85, 524288
  buffer_load_dword a204, v243, s[12:15], s85 offen
  s_mov_b32 s85, 221184
  buffer_load_dword a204, v244, s[16:19], s85 offen
  s_mov_b32 s85, 221184
  buffer_load_dword a204, v244, s[20:23], s85 offen
  s_mov_b32 s85, 128
  buffer_load_dword a204, v242, s[8:11], s85 offen
  s_waitcnt vmcnt(4)
  s_barrier
  ds_read_b128 v[128:131], v221 offset:0
  ds_read_b128 v[132:135], v221 offset:4096
  ds_read_b128 v[136:139], v222 offset:0
  ds_read_b128 v[140:143], v222 offset:4096
  ds_read_b128 v[144:147], v223 offset:0
  ds_read_b128 v[148:151], v223 offset:4096
  ds_read_b128 v[152:155], v224 offset:0
  ds_read_b128 v[156:159], v224 offset:4096
  ds_read_b64_tr_b16 a[128:129], v212 offset:0
  ds_read_b64_tr_b16 a[130:131], v212 offset:1024
  ds_read_b64_tr_b16 a[132:133], v213 offset:0
  ds_read_b64_tr_b16 a[134:135], v213 offset:1024
  ds_read_b64_tr_b16 a[136:137], v214 offset:0
  ds_read_b64_tr_b16 a[138:139], v214 offset:1024
  ds_read_b64_tr_b16 a[140:141], v215 offset:0
  ds_read_b64_tr_b16 a[142:143], v215 offset:1024
  ds_read_b64_tr_b16 a[144:145], v216 offset:0
  ds_read_b64_tr_b16 a[146:147], v216 offset:512
  ds_read_b64_tr_b16 a[148:149], v217 offset:0
  ds_read_b64_tr_b16 a[150:151], v217 offset:512
  ds_read_b64_tr_b16 a[152:153], v218 offset:0
  ds_read_b64_tr_b16 a[154:155], v218 offset:512
  ds_read_b64_tr_b16 a[156:157], v219 offset:0
  ds_read_b64_tr_b16 a[158:159], v219 offset:512
  ds_read_b64_tr_b16 a[160:161], v220 offset:0
  ds_read_b64_tr_b16 a[162:163], v220 offset:512
  s_waitcnt lgkmcnt(0)
  v_mfma_f32_32x32x16_bf16 a[0:15], a[128:131], v[128:131], 0
  ds_read_b64_tr_b16 a[164:165], v212 offset:4096
  v_mfma_f32_32x32x16_bf16 a[16:31], a[128:131], v[132:135], 0
  s_add_u32 m0, s77, 16384
  s_mov_b32 s74, 524288
  buffer_load_dwordx4 v229, s[12:15], s74 offen lds
  v_mfma_f32_32x32x16_bf16 a[32:47], a[132:135], v[128:131], 0
  ds_read_b64_tr_b16 a[166:167], v212 offset:5120
  ds_read_b64_tr_b16 a[168:169], v213 offset:4096
  v_mfma_f32_32x32x16_bf16 a[48:63], a[132:135], v[132:135], 0
  buffer_load_dwordx4 v230, s[12:15], s74 offen offset:1024 lds
  ds_read_b64_tr_b16 a[170:171], v213 offset:5120
  v_mfma_f32_32x32x16_bf16 a[64:79], a[136:139], v[128:131], 0
  ds_read_b64_tr_b16 a[172:173], v214 offset:4096
  ds_read_b64_tr_b16 a[174:175], v214 offset:5120
  v_mfma_f32_32x32x16_bf16 a[80:95], a[136:139], v[132:135], 0
  buffer_load_dwordx4 v231, s[12:15], s74 offen offset:2048 lds
  ds_read_b64_tr_b16 a[176:177], v215 offset:4096
  v_mfma_f32_32x32x16_bf16 a[96:111], a[140:143], v[128:131], 0
  ds_read_b64_tr_b16 a[178:179], v215 offset:5120
  buffer_load_dwordx4 v232, s[12:15], s74 offen offset:3072 lds
  v_mfma_f32_32x32x16_bf16 a[112:127], a[140:143], v[132:135], 0
  ds_read_b64_tr_b16 a[180:181], v216 offset:2048
  ds_read_b64_tr_b16 a[182:183], v216 offset:2560
  v_mfma_f32_32x32x16_bf16 a[208:223], a[144:147], v[128:131], 0
  s_mov_b32 s85, 1048576
  buffer_load_dword a204, v243, s[12:15], s85 offen
  v_mfma_f32_32x32x16_bf16 a[224:239], a[144:147], v[132:135], 0
  ds_read_b64_tr_b16 a[184:185], v217 offset:2048
  ds_read_b64_tr_b16 a[186:187], v217 offset:2560
  v_mfma_f32_32x32x16_bf16 v[48:63], a[148:151], v[128:131], 0
  s_mov_b32 s85, 442368
  buffer_load_dword a204, v244, s[16:19], s85 offen
  v_mfma_f32_32x32x16_bf16 v[64:79], a[148:151], v[132:135], 0
  ds_read_b64_tr_b16 a[188:189], v218 offset:2048
  ds_read_b64_tr_b16 a[190:191], v218 offset:2560
  ds_read_b64_tr_b16 a[192:193], v219 offset:2048
  v_mfma_f32_32x32x16_bf16 v[80:95], a[152:155], v[128:131], 0
  s_mov_b32 s85, 442368
  buffer_load_dword a204, v244, s[20:23], s85 offen
  v_mfma_f32_32x32x16_bf16 v[96:111], a[152:155], v[132:135], 0
  ds_read_b64_tr_b16 a[194:195], v219 offset:2560
  ds_read_b64_tr_b16 a[196:197], v220 offset:2048
  v_mfma_f32_32x32x16_bf16 a[240:255], a[156:159], v[128:131], 0
  s_mov_b32 s85, 256
  buffer_load_dword a204, v242, s[8:11], s85 offen
  v_mfma_f32_16x16x32_bf16 v[204:207], a[200:203], a[128:131], 0
  v_mfma_f32_16x16x32_bf16 v[208:211], a[200:203], a[160:163], 0
  ds_read_b64_tr_b16 a[198:199], v220 offset:2560
  s_waitcnt lgkmcnt(10)
  v_mfma_f32_32x32x16_bf16 a[0:15], a[164:167], v[136:139], a[0:15]
  ds_read_b64_tr_b16 a[128:129], v212 offset:8192
  v_mfma_f32_32x32x16_bf16 a[16:31], a[164:167], v[140:143], a[16:31]
  s_add_u32 m0, s78, 16384
  s_mov_b32 s75, 221184
  buffer_load_dwordx4 v233, s[16:19], s75 offen lds
  v_mfma_f32_32x32x16_bf16 a[32:47], a[168:171], v[136:139], a[32:47]
  ds_read_b64_tr_b16 a[130:131], v212 offset:9216
  ds_read_b64_tr_b16 a[132:133], v213 offset:8192
  v_mfma_f32_32x32x16_bf16 a[48:63], a[168:171], v[140:143], a[48:63]
  buffer_load_dwordx4 v234, s[16:19], s75 offen offset:1024 lds
  ds_read_b64_tr_b16 a[134:135], v213 offset:9216
  v_mfma_f32_32x32x16_bf16 a[64:79], a[172:175], v[136:139], a[64:79]
  ds_read_b64_tr_b16 a[136:137], v214 offset:8192
  ds_read_b64_tr_b16 a[138:139], v214 offset:9216
  v_mfma_f32_32x32x16_bf16 a[80:95], a[172:175], v[140:143], a[80:95]
  s_add_u32 m0, s78, 24576
  s_nop 0
  buffer_load_dwordx4 v235, s[20:23], s75 offen lds
  v_mfma_f32_32x32x16_bf16 a[96:111], a[176:179], v[136:139], a[96:111]
  ds_read_b64_tr_b16 a[140:141], v215 offset:8192
  ds_read_b64_tr_b16 a[142:143], v215 offset:9216
  v_mfma_f32_32x32x16_bf16 a[112:127], a[176:179], v[140:143], a[112:127]
  buffer_load_dwordx4 v236, s[20:23], s75 offen offset:1024 lds
  ds_read_b64_tr_b16 a[144:145], v216 offset:4096
  s_waitcnt lgkmcnt(10)
  v_mfma_f32_32x32x16_bf16 a[208:223], a[180:183], v[136:139], a[208:223]
  ds_read_b64_tr_b16 a[146:147], v216 offset:4608
  v_mfma_f32_32x32x16_bf16 a[224:239], a[180:183], v[140:143], a[224:239]
  s_add_u32 m0, s79, 8192
  s_add_u32 s76, s72, 128
  buffer_load_dwordx4 v225, s[8:11], s76 offen lds
  v_mfma_f32_32x32x16_bf16 v[48:63], a[184:187], v[136:139], v[48:63]
  ds_read_b64_tr_b16 a[148:149], v217 offset:4096
  ds_read_b64_tr_b16 a[150:151], v217 offset:4608
  v_mfma_f32_32x32x16_bf16 v[64:79], a[184:187], v[140:143], v[64:79]
  buffer_load_dwordx4 v226, s[8:11], s76 offen offset:1024 lds
  ds_read_b64_tr_b16 a[152:153], v218 offset:4096
  v_mfma_f32_32x32x16_bf16 v[80:95], a[188:191], v[136:139], v[80:95]
  ds_read_b64_tr_b16 a[154:155], v218 offset:4608
  ds_read_b64_tr_b16 a[156:157], v219 offset:4096
  v_mfma_f32_32x32x16_bf16 v[96:111], a[188:191], v[140:143], v[96:111]
  buffer_load_dwordx4 v227, s[8:11], s76 offen offset:2048 lds
  ds_read_b64_tr_b16 a[158:159], v219 offset:4608
  v_mfma_f32_32x32x16_bf16 a[240:255], a[192:195], v[136:139], a[240:255]
  ds_read_b64_tr_b16 a[160:161], v220 offset:4096
  buffer_load_dwordx4 v228, s[8:11], s76 offen offset:3072 lds
  v_mfma_f32_16x16x32_bf16 v[204:207], a[200:203], a[164:167], v[204:207]
  s_waitcnt lgkmcnt(10)
  v_mfma_f32_16x16x32_bf16 v[208:211], a[200:203], a[196:199], v[208:211]
  ds_read_b64_tr_b16 a[162:163], v220 offset:4608
  v_mfma_f32_32x32x16_bf16 a[0:15], a[128:131], v[144:147], a[0:15]
  ds_read_b64_tr_b16 a[164:165], v212 offset:12288
  ds_read_b64_tr_b16 a[166:167], v212 offset:13312
  v_mfma_f32_32x32x16_bf16 a[16:31], a[128:131], v[148:151], a[16:31]
  s_add_u32 m0, s79, 12288
  s_add_u32 s76, s73, 128
  buffer_load_dwordx4 v225, s[8:11], s76 offen lds
  v_mfma_f32_32x32x16_bf16 a[32:47], a[132:135], v[144:147], a[32:47]
  ds_read_b64_tr_b16 a[168:169], v213 offset:12288
  ds_read_b64_tr_b16 a[170:171], v213 offset:13312
  ds_read_b64_tr_b16 a[172:173], v214 offset:12288
  v_mfma_f32_32x32x16_bf16 a[48:63], a[132:135], v[148:151], a[48:63]
  buffer_load_dwordx4 v226, s[8:11], s76 offen offset:1024 lds
  v_mfma_f32_32x32x16_bf16 a[64:79], a[136:139], v[144:147], a[64:79]
  ds_read_b64_tr_b16 a[174:175], v214 offset:13312
  ds_read_b64_tr_b16 a[176:177], v215 offset:12288
  ds_read_b64_tr_b16 a[178:179], v215 offset:13312
  v_mfma_f32_32x32x16_bf16 a[80:95], a[136:139], v[148:151], a[80:95]
  buffer_load_dwordx4 v227, s[8:11], s76 offen offset:2048 lds
  s_waitcnt lgkmcnt(11)
  v_mfma_f32_32x32x16_bf16 a[96:111], a[140:143], v[144:147], a[96:111]
  ds_read_b64_tr_b16 a[180:181], v216 offset:6144
  ds_read_b64_tr_b16 a[182:183], v216 offset:6656
  ds_read_b64_tr_b16 a[184:185], v217 offset:6144
  v_mfma_f32_32x32x16_bf16 a[112:127], a[140:143], v[148:151], a[112:127]
  buffer_load_dwordx4 v228, s[8:11], s76 offen offset:3072 lds
  v_mfma_f32_32x32x16_bf16 a[208:223], a[144:147], v[144:147], a[208:223]
  ds_read_b64_tr_b16 a[186:187], v217 offset:6656
  ds_read_b64_tr_b16 a[188:189], v218 offset:6144
  ds_read_b64_tr_b16 a[190:191], v218 offset:6656
  v_mfma_f32_32x32x16_bf16 a[224:239], a[144:147], v[148:151], a[224:239]
  s_mov_b32 s85, 1572864
  buffer_load_dword a204, v243, s[12:15], s85 offen
  v_mfma_f32_32x32x16_bf16 v[48:63], a[148:151], v[144:147], v[48:63]
  ds_read_b64_tr_b16 a[192:193], v219 offset:6144
  ds_read_b64_tr_b16 a[194:195], v219 offset:6656
  v_mfma_f32_32x32x16_bf16 v[64:79], a[148:151], v[148:151], v[64:79]
  ds_read_b64_tr_b16 a[196:197], v220 offset:6144
  s_mov_b32 s85, 663552
  buffer_load_dword a204, v244, s[16:19], s85 offen
  v_mfma_f32_32x32x16_bf16 v[80:95], a[152:155], v[144:147], v[80:95]
  ds_read_b64_tr_b16 a[198:199], v220 offset:6656
  v_mfma_f32_32x32x16_bf16 v[96:111], a[152:155], v[148:151], v[96:111]
  s_mov_b32 s85, 663552
  buffer_load_dword a204, v244, s[20:23], s85 offen
  s_waitcnt lgkmcnt(10)
  v_mfma_f32_32x32x16_bf16 a[240:255], a[156:159], v[144:147], a[240:255]
  s_mov_b32 s85, 384
  buffer_load_dword a204, v242, s[8:11], s85 offen
  v_mfma_f32_16x16x32_bf16 v[204:207], a[200:203], a[128:131], v[204:207]
  v_mfma_f32_16x16x32_bf16 v[208:211], a[200:203], a[160:163], v[208:211]
  v_mfma_f32_32x32x16_bf16 a[0:15], a[164:167], v[152:155], a[0:15]
  s_waitcnt vmcnt(12) lgkmcnt(0)
  s_barrier
  v_mfma_f32_32x32x16_bf16 a[16:31], a[164:167], v[156:159], a[16:31]
  ds_read_b64_tr_b16 a[128:129], v212 offset:16384
  s_waitcnt vmcnt(4)
  ds_read_b64_tr_b16 a[130:131], v212 offset:17408
  v_mfma_f32_32x32x16_bf16 a[32:47], a[168:171], v[152:155], a[32:47]
  ds_read_b128 v[160:163], v221 offset:8192
  ds_read_b64_tr_b16 a[132:133], v213 offset:16384
  ds_read_b128 v[164:167], v221 offset:12288
  v_mfma_f32_32x32x16_bf16 a[48:63], a[168:171], v[156:159], a[48:63]
  ds_read_b64_tr_b16 a[134:135], v213 offset:17408
  ds_read_b64_tr_b16 a[136:137], v214 offset:16384
  ds_read_b128 v[168:171], v222 offset:8192
  v_mfma_f32_32x32x16_bf16 a[64:79], a[172:175], v[152:155], a[64:79]
  ds_read_b64_tr_b16 a[138:139], v214 offset:17408
  ds_read_b128 v[172:175], v222 offset:12288
  ds_read_b64_tr_b16 a[140:141], v215 offset:16384
  v_mfma_f32_32x32x16_bf16 a[80:95], a[172:175], v[156:159], a[80:95]
  ds_read_b64_tr_b16 a[142:143], v215 offset:17408
  ds_read_b128 v[176:179], v223 offset:8192
  ds_read_b64_tr_b16 a[144:145], v216 offset:16384
  v_mfma_f32_32x32x16_bf16 a[96:111], a[176:179], v[152:155], a[96:111]
  ds_read_b128 v[180:183], v223 offset:12288
  ds_read_b64_tr_b16 a[146:147], v216 offset:16896
  ds_read_b128 v[184:187], v224 offset:8192
  v_mfma_f32_32x32x16_bf16 a[112:127], a[176:179], v[156:159], a[112:127]
  ds_read_b64_tr_b16 a[148:149], v217 offset:16384
  ds_read_b64_tr_b16 a[150:151], v217 offset:16896
  ds_read_b128 v[188:191], v224 offset:12288
  v_mfma_f32_32x32x16_bf16 a[208:223], a[180:183], v[152:155], a[208:223]
  ds_read_b64_tr_b16 a[152:153], v218 offset:16384
  v_mfma_f32_32x32x16_bf16 a[224:239], a[180:183], v[156:159], a[224:239]
  s_add_u32 m0, s77, 32768
  s_mov_b32 s74, 1048576
  buffer_load_dwordx4 v229, s[12:15], s74 offen lds
  v_mfma_f32_32x32x16_bf16 v[48:63], a[184:187], v[152:155], v[48:63]
  ds_read_b64_tr_b16 a[154:155], v218 offset:16896
  ds_read_b64_tr_b16 a[156:157], v219 offset:16384
  v_mfma_f32_32x32x16_bf16 v[64:79], a[184:187], v[156:159], v[64:79]
  buffer_load_dwordx4 v230, s[12:15], s74 offen offset:1024 lds
  v_mfma_f32_32x32x16_bf16 v[80:95], a[188:191], v[152:155], v[80:95]
  ds_read_b64_tr_b16 a[158:159], v219 offset:16896
  v_mfma_f32_32x32x16_bf16 v[96:111], a[188:191], v[156:159], v[96:111]
  buffer_load_dwordx4 v231, s[12:15], s74 offen offset:2048 lds
  ds_read_b64_tr_b16 a[160:161], v220 offset:16384
  v_mfma_f32_32x32x16_bf16 a[240:255], a[192:195], v[152:155], a[240:255]
  buffer_load_dwordx4 v232, s[12:15], s74 offen offset:3072 lds
  v_mfma_f32_16x16x32_bf16 v[204:207], a[200:203], a[164:167], v[204:207]
  v_mfma_f32_16x16x32_bf16 v[208:211], a[200:203], a[196:199], v[208:211]
  ds_read_b64_tr_b16 a[162:163], v220 offset:16896
  s_waitcnt lgkmcnt(11)
  v_mfma_f32_32x32x16_bf16 a[0:15], a[128:131], v[160:163], a[0:15]
  ds_read_b64_tr_b16 a[164:165], v212 offset:20480
  ds_read_b64_tr_b16 a[166:167], v212 offset:21504
  v_mfma_f32_32x32x16_bf16 a[16:31], a[128:131], v[164:167], a[16:31]
  v_mfma_f32_32x32x16_bf16 a[32:47], a[132:135], v[160:163], a[32:47]
  s_add_u32 m0, s78, 32768
  s_mov_b32 s75, 442368
  buffer_load_dwordx4 v233, s[16:19], s75 offen lds
  v_mfma_f32_32x32x16_bf16 a[48:63], a[132:135], v[164:167], a[48:63]
  ds_read_b64_tr_b16 a[168:169], v213 offset:20480
  v_mfma_f32_32x32x16_bf16 a[64:79], a[136:139], v[160:163], a[64:79]
  ds_read_b64_tr_b16 a[170:171], v213 offset:21504
  ds_read_b64_tr_b16 a[172:173], v214 offset:20480
  ds_read_b64_tr_b16 a[174:175], v214 offset:21504
  v_mfma_f32_32x32x16_bf16 a[80:95], a[136:139], v[164:167], a[80:95]
  ds_read_b64_tr_b16 a[176:177], v215 offset:20480
  v_mfma_f32_32x32x16_bf16 a[96:111], a[140:143], v[160:163], a[96:111]
  buffer_load_dwordx4 v234, s[16:19], s75 offen offset:1024 lds
  v_mfma_f32_32x32x16_bf16 a[112:127], a[140:143], v[164:167], a[112:127]
  ds_read_b64_tr_b16 a[178:179], v215 offset:21504
  ds_read_b64_tr_b16 a[180:181], v216 offset:18432
  s_waitcnt lgkmcnt(10)
  v_mfma_f32_32x32x16_bf16 a[208:223], a[144:147], v[160:163], a[208:223]
  ds_read_b64_tr_b16 a[182:183], v216 offset:18944
  ds_read_b64_tr_b16 a[184:185], v217 offset:18432
  v_mfma_f32_32x32x16_bf16 a[224:239], a[144:147], v[164:167], a[224:239]
  s_add_u32 m0, s78, 40960
  s_nop 0
  buffer_load_dwordx4 v235, s[20:23], s75 offen lds
  v_mfma_f32_32x32x16_bf16 v[48:63], a[148:151], v[160:163], v[48:63]
  v_mfma_f32_32x32x16_bf16 v[64:79], a[148:151], v[164:167], v[64:79]
  ds_read_b64_tr_b16 a[186:187], v217 offset:18944
  ds_read_b64_tr_b16 a[188:189], v218 offset:18432
  v_mfma_f32_32x32x16_bf16 v[80:95], a[152:155], v[160:163], v[80:95]
  ds_read_b64_tr_b16 a[190:191], v218 offset:18944
  ds_read_b64_tr_b16 a[192:193], v219 offset:18432
  ds_read_b64_tr_b16 a[194:195], v219 offset:18944
  v_mfma_f32_32x32x16_bf16 v[96:111], a[152:155], v[164:167], v[96:111]
  buffer_load_dwordx4 v236, s[20:23], s75 offen offset:1024 lds
  v_mfma_f32_32x32x16_bf16 a[240:255], a[156:159], v[160:163], a[240:255]
  v_mfma_f32_16x16x32_bf16 v[204:207], a[200:203], a[128:131], v[204:207]
  ds_read_b64_tr_b16 a[196:197], v220 offset:18432
  s_waitcnt lgkmcnt(11)
  v_mfma_f32_16x16x32_bf16 v[208:211], a[200:203], a[160:163], v[208:211]
  ds_read_b64_tr_b16 a[198:199], v220 offset:18944
  v_mfma_f32_32x32x16_bf16 a[0:15], a[164:167], v[168:171], a[0:15]
  ds_read_b64_tr_b16 a[128:129], v212 offset:24576
  ds_read_b64_tr_b16 a[130:131], v212 offset:25600
  ds_read_b64_tr_b16 a[132:133], v213 offset:24576
  v_mfma_f32_32x32x16_bf16 a[16:31], a[164:167], v[172:175], a[16:31]
  s_add_u32 m0, s79, 0
  s_add_u32 s76, s72, 256
  buffer_load_dwordx4 v225, s[8:11], s76 offen lds
  v_mfma_f32_32x32x16_bf16 a[32:47], a[168:171], v[168:171], a[32:47]
  ds_read_b64_tr_b16 a[134:135], v213 offset:25600
  v_mfma_f32_32x32x16_bf16 a[48:63], a[168:171], v[172:175], a[48:63]
  ds_read_b64_tr_b16 a[136:137], v214 offset:24576
  buffer_load_dwordx4 v226, s[8:11], s76 offen offset:1024 lds
  v_mfma_f32_32x32x16_bf16 a[64:79], a[172:175], v[168:171], a[64:79]
  ds_read_b64_tr_b16 a[138:139], v214 offset:25600
  v_mfma_f32_32x32x16_bf16 a[80:95], a[172:175], v[172:175], a[80:95]
  buffer_load_dwordx4 v227, s[8:11], s76 offen offset:2048 lds
  s_waitcnt lgkmcnt(10)
  v_mfma_f32_32x32x16_bf16 a[96:111], a[176:179], v[168:171], a[96:111]
  ds_read_b64_tr_b16 a[140:141], v215 offset:24576
  ds_read_b64_tr_b16 a[142:143], v215 offset:25600
  buffer_load_dwordx4 v228, s[8:11], s76 offen offset:3072 lds
  v_mfma_f32_32x32x16_bf16 a[112:127], a[176:179], v[172:175], a[112:127]
  ds_read_b64_tr_b16 a[144:145], v216 offset:20480
  ds_read_b64_tr_b16 a[146:147], v216 offset:20992
  v_mfma_f32_32x32x16_bf16 a[208:223], a[180:183], v[168:171], a[208:223]
  ds_read_b64_tr_b16 a[148:149], v217 offset:20480
  ds_read_b64_tr_b16 a[150:151], v217 offset:20992
  v_mfma_f32_32x32x16_bf16 a[224:239], a[180:183], v[172:175], a[224:239]
  s_add_u32 m0, s79, 4096
  s_add_u32 s76, s73, 256
  buffer_load_dwordx4 v225, s[8:11], s76 offen lds
  v_mfma_f32_32x32x16_bf16 v[48:63], a[184:187], v[168:171], v[48:63]
  ds_read_b64_tr_b16 a[152:153], v218 offset:20480
  v_mfma_f32_32x32x16_bf16 v[64:79], a[184:187], v[172:175], v[64:79]
  ds_read_b64_tr_b16 a[154:155], v218 offset:20992
  buffer_load_dwordx4 v226, s[8:11], s76 offen offset:1024 lds
  v_mfma_f32_32x32x16_bf16 v[80:95], a[188:191], v[168:171], v[80:95]
  ds_read_b64_tr_b16 a[156:157], v219 offset:20480
  v_mfma_f32_32x32x16_bf16 v[96:111], a[188:191], v[172:175], v[96:111]
  buffer_load_dwordx4 v227, s[8:11], s76 offen offset:2048 lds
  ds_read_b64_tr_b16 a[158:159], v219 offset:20992
  s_waitcnt lgkmcnt(10)
  v_mfma_f32_32x32x16_bf16 a[240:255], a[192:195], v[168:171], a[240:255]
  ds_read_b64_tr_b16 a[160:161], v220 offset:20480
  buffer_load_dwordx4 v228, s[8:11], s76 offen offset:3072 lds
  v_mfma_f32_16x16x32_bf16 v[204:207], a[200:203], a[164:167], v[204:207]
  v_mfma_f32_16x16x32_bf16 v[208:211], a[200:203], a[196:199], v[208:211]
  ds_read_b64_tr_b16 a[162:163], v220 offset:20992
  v_mfma_f32_32x32x16_bf16 a[0:15], a[128:131], v[176:179], a[0:15]
  ds_read_b64_tr_b16 a[164:165], v212 offset:28672
  ds_read_b64_tr_b16 a[166:167], v212 offset:29696
  v_mfma_f32_32x32x16_bf16 a[16:31], a[128:131], v[180:183], a[16:31]
  s_add_u32 m0, s77, 0
  s_mov_b32 s74, 1572864
  buffer_load_dwordx4 v229, s[12:15], s74 offen lds
  v_mfma_f32_32x32x16_bf16 a[32:47], a[132:135], v[176:179], a[32:47]
  ds_read_b64_tr_b16 a[168:169], v213 offset:28672
  ds_read_b64_tr_b16 a[170:171], v213 offset:29696
  ds_read_b64_tr_b16 a[172:173], v214 offset:28672
  v_mfma_f32_32x32x16_bf16 a[48:63], a[132:135], v[180:183], a[48:63]
  buffer_load_dwordx4 v230, s[12:15], s74 offen offset:1024 lds
  v_mfma_f32_32x32x16_bf16 a[64:79], a[136:139], v[176:179], a[64:79]
  ds_read_b64_tr_b16 a[174:175], v214 offset:29696
  ds_read_b64_tr_b16 a[176:177], v215 offset:28672
  ds_read_b64_tr_b16 a[178:179], v215 offset:29696
  v_mfma_f32_32x32x16_bf16 a[80:95], a[136:139], v[180:183], a[80:95]
  buffer_load_dwordx4 v231, s[12:15], s74 offen offset:2048 lds
  s_waitcnt lgkmcnt(11)
  v_mfma_f32_32x32x16_bf16 a[96:111], a[140:143], v[176:179], a[96:111]
  ds_read_b64_tr_b16 a[180:181], v216 offset:22528
  ds_read_b64_tr_b16 a[182:183], v216 offset:23040
  ds_read_b64_tr_b16 a[184:185], v217 offset:22528
  v_mfma_f32_32x32x16_bf16 a[112:127], a[140:143], v[180:183], a[112:127]
  buffer_load_dwordx4 v232, s[12:15], s74 offen offset:3072 lds
  v_mfma_f32_32x32x16_bf16 a[208:223], a[144:147], v[176:179], a[208:223]
  ds_read_b64_tr_b16 a[186:187], v217 offset:23040
  ds_read_b64_tr_b16 a[188:189], v218 offset:22528
  ds_read_b64_tr_b16 a[190:191], v218 offset:23040
  v_mfma_f32_32x32x16_bf16 a[224:239], a[144:147], v[180:183], a[224:239]
  s_mov_b32 s85, 2097152
  buffer_load_dword a204, v243, s[12:15], s85 offen
  v_mfma_f32_32x32x16_bf16 v[48:63], a[148:151], v[176:179], v[48:63]
  ds_read_b64_tr_b16 a[192:193], v219 offset:22528
  ds_read_b64_tr_b16 a[194:195], v219 offset:23040
  v_mfma_f32_32x32x16_bf16 v[64:79], a[148:151], v[180:183], v[64:79]
  ds_read_b64_tr_b16 a[196:197], v220 offset:22528
  s_mov_b32 s85, 884736
  buffer_load_dword a204, v244, s[16:19], s85 offen
  v_mfma_f32_32x32x16_bf16 v[80:95], a[152:155], v[176:179], v[80:95]
  ds_read_b64_tr_b16 a[198:199], v220 offset:23040
  v_mfma_f32_32x32x16_bf16 v[96:111], a[152:155], v[180:183], v[96:111]
  s_mov_b32 s85, 884736
  buffer_load_dword a204, v244, s[20:23], s85 offen
  s_waitcnt lgkmcnt(10)
  v_mfma_f32_32x32x16_bf16 a[240:255], a[156:159], v[176:179], a[240:255]
  s_mov_b32 s85, 512
  buffer_load_dword a204, v242, s[8:11], s85 offen
  v_mfma_f32_16x16x32_bf16 v[204:207], a[200:203], a[128:131], v[204:207]
  v_mfma_f32_16x16x32_bf16 v[208:211], a[200:203], a[160:163], v[208:211]
  v_mfma_f32_32x32x16_bf16 a[0:15], a[164:167], v[184:187], a[0:15]
  s_waitcnt vmcnt(16) lgkmcnt(0)
  s_barrier
  v_mfma_f32_32x32x16_bf16 a[16:31], a[164:167], v[188:191], a[16:31]
  ds_read_b64_tr_b16 a[128:129], v212 offset:32768
  s_waitcnt vmcnt(8)
  ds_read_b64_tr_b16 a[130:131], v212 offset:33792
  v_mfma_f32_32x32x16_bf16 a[32:47], a[168:171], v[184:187], a[32:47]
  ds_read_b128 v[128:131], v221 offset:0
  ds_read_b64_tr_b16 a[132:133], v213 offset:32768
  ds_read_b128 v[132:135], v221 offset:4096
  v_mfma_f32_32x32x16_bf16 a[48:63], a[168:171], v[188:191], a[48:63]
  ds_read_b64_tr_b16 a[134:135], v213 offset:33792
  ds_read_b64_tr_b16 a[136:137], v214 offset:32768
  ds_read_b128 v[136:139], v222 offset:0
  v_mfma_f32_32x32x16_bf16 a[64:79], a[172:175], v[184:187], a[64:79]
  ds_read_b64_tr_b16 a[138:139], v214 offset:33792
  ds_read_b128 v[140:143], v222 offset:4096
  ds_read_b64_tr_b16 a[140:141], v215 offset:32768
  ds_read_b128 v[144:147], v223 offset:0
  v_mfma_f32_32x32x16_bf16 a[80:95], a[172:175], v[188:191], a[80:95]
  ds_read_b64_tr_b16 a[142:143], v215 offset:33792
  ds_read_b128 v[148:151], v223 offset:4096
  ds_read_b64_tr_b16 a[144:145], v216 offset:32768
  v_mfma_f32_32x32x16_bf16 a[96:111], a[176:179], v[184:187], a[96:111]
  ds_read_b64_tr_b16 a[146:147], v216 offset:33280
  ds_read_b128 v[152:155], v224 offset:0
  ds_read_b64_tr_b16 a[148:149], v217 offset:32768
  v_mfma_f32_32x32x16_bf16 a[112:127], a[176:179], v[188:191], a[112:127]
  ds_read_b128 v[156:159], v224 offset:4096
  ds_read_b64_tr_b16 a[150:151], v217 offset:33280
  v_mfma_f32_32x32x16_bf16 a[208:223], a[180:183], v[184:187], a[208:223]
  ds_read_b64_tr_b16 a[152:153], v218 offset:32768
  ds_read_b64_tr_b16 a[154:155], v218 offset:33280
  v_mfma_f32_32x32x16_bf16 a[224:239], a[180:183], v[188:191], a[224:239]
  s_add_u32 m0, s79, 8192
  s_add_u32 s76, s72, 384
  buffer_load_dwordx4 v225, s[8:11], s76 offen lds
  v_mfma_f32_32x32x16_bf16 v[48:63], a[184:187], v[184:187], v[48:63]
  ds_read_b64_tr_b16 a[156:157], v219 offset:32768
  v_mfma_f32_32x32x16_bf16 v[64:79], a[184:187], v[188:191], v[64:79]
  buffer_load_dwordx4 v226, s[8:11], s76 offen offset:1024 lds
  v_mfma_f32_32x32x16_bf16 v[80:95], a[188:191], v[184:187], v[80:95]
  ds_read_b64_tr_b16 a[158:159], v219 offset:33280
  v_mfma_f32_32x32x16_bf16 v[96:111], a[188:191], v[188:191], v[96:111]
  buffer_load_dwordx4 v227, s[8:11], s76 offen offset:2048 lds
  ds_read_b64_tr_b16 a[160:161], v220 offset:32768
  v_mfma_f32_32x32x16_bf16 a[240:255], a[192:195], v[184:187], a[240:255]
  buffer_load_dwordx4 v228, s[8:11], s76 offen offset:3072 lds
  v_mfma_f32_16x16x32_bf16 v[204:207], a[200:203], a[164:167], v[204:207]
  v_mfma_f32_16x16x32_bf16 v[208:211], a[200:203], a[196:199], v[208:211]
  ds_read_b64_tr_b16 a[162:163], v220 offset:33280
  s_waitcnt lgkmcnt(11)
  v_mfma_f32_32x32x16_bf16 a[0:15], a[128:131], v[128:131], a[0:15]
  ds_read_b64_tr_b16 a[164:165], v212 offset:36864
  ds_read_b64_tr_b16 a[166:167], v212 offset:37888
  v_mfma_f32_32x32x16_bf16 a[16:31], a[128:131], v[132:135], a[16:31]
  v_mfma_f32_32x32x16_bf16 a[32:47], a[132:135], v[128:131], a[32:47]
  s_add_u32 m0, s78, 0
  s_mov_b32 s75, 663552
  buffer_load_dwordx4 v233, s[16:19], s75 offen lds
  v_mfma_f32_32x32x16_bf16 a[48:63], a[132:135], v[132:135], a[48:63]
  ds_read_b64_tr_b16 a[168:169], v213 offset:36864
  v_mfma_f32_32x32x16_bf16 a[64:79], a[136:139], v[128:131], a[64:79]
  ds_read_b64_tr_b16 a[170:171], v213 offset:37888
  ds_read_b64_tr_b16 a[172:173], v214 offset:36864
  ds_read_b64_tr_b16 a[174:175], v214 offset:37888
  v_mfma_f32_32x32x16_bf16 a[80:95], a[136:139], v[132:135], a[80:95]
  ds_read_b64_tr_b16 a[176:177], v215 offset:36864
  v_mfma_f32_32x32x16_bf16 a[96:111], a[140:143], v[128:131], a[96:111]
  buffer_load_dwordx4 v234, s[16:19], s75 offen offset:1024 lds
  v_mfma_f32_32x32x16_bf16 a[112:127], a[140:143], v[132:135], a[112:127]
  ds_read_b64_tr_b16 a[178:179], v215 offset:37888
  ds_read_b64_tr_b16 a[180:181], v216 offset:34816
  s_waitcnt lgkmcnt(10)
  v_mfma_f32_32x32x16_bf16 a[208:223], a[144:147], v[128:131], a[208:223]
  ds_read_b64_tr_b16 a[182:183], v216 offset:35328
  ds_read_b64_tr_b16 a[184:185], v217 offset:34816
  v_mfma_f32_32x32x16_bf16 a[224:239], a[144:147], v[132:135], a[224:239]
  s_add_u32 m0, s78, 8192
  s_nop 0
  buffer_load_dwordx4 v235, s[20:23], s75 offen lds
  v_mfma_f32_32x32x16_bf16 v[48:63], a[148:151], v[128:131], v[48:63]
  v_mfma_f32_32x32x16_bf16 v[64:79], a[148:151], v[132:135], v[64:79]
  ds_read_b64_tr_b16 a[186:187], v217 offset:35328
  ds_read_b64_tr_b16 a[188:189], v218 offset:34816
  v_mfma_f32_32x32x16_bf16 v[80:95], a[152:155], v[128:131], v[80:95]
  ds_read_b64_tr_b16 a[190:191], v218 offset:35328
  ds_read_b64_tr_b16 a[192:193], v219 offset:34816
  ds_read_b64_tr_b16 a[194:195], v219 offset:35328
  v_mfma_f32_32x32x16_bf16 v[96:111], a[152:155], v[132:135], v[96:111]
  buffer_load_dwordx4 v236, s[20:23], s75 offen offset:1024 lds
  v_mfma_f32_32x32x16_bf16 a[240:255], a[156:159], v[128:131], a[240:255]
  v_mfma_f32_16x16x32_bf16 v[204:207], a[200:203], a[128:131], v[204:207]
  ds_read_b64_tr_b16 a[196:197], v220 offset:34816
  s_waitcnt lgkmcnt(11)
  v_mfma_f32_16x16x32_bf16 v[208:211], a[200:203], a[160:163], v[208:211]
  ds_read_b64_tr_b16 a[198:199], v220 offset:35328
  v_mfma_f32_32x32x16_bf16 a[0:15], a[164:167], v[136:139], a[0:15]
  ds_read_b64_tr_b16 a[128:129], v212 offset:40960
  ds_read_b64_tr_b16 a[130:131], v212 offset:41984
  ds_read_b64_tr_b16 a[132:133], v213 offset:40960
  v_mfma_f32_32x32x16_bf16 a[16:31], a[164:167], v[140:143], a[16:31]
  s_add_u32 m0, s79, 12288
  s_add_u32 s76, s73, 384
  buffer_load_dwordx4 v225, s[8:11], s76 offen lds
  v_mfma_f32_32x32x16_bf16 a[32:47], a[168:171], v[136:139], a[32:47]
  ds_read_b64_tr_b16 a[134:135], v213 offset:41984
  v_mfma_f32_32x32x16_bf16 a[48:63], a[168:171], v[140:143], a[48:63]
  ds_read_b64_tr_b16 a[136:137], v214 offset:40960
  buffer_load_dwordx4 v226, s[8:11], s76 offen offset:1024 lds
  v_mfma_f32_32x32x16_bf16 a[64:79], a[172:175], v[136:139], a[64:79]
  ds_read_b64_tr_b16 a[138:139], v214 offset:41984
  ds_read_b64_tr_b16 a[140:141], v215 offset:40960
  v_mfma_f32_32x32x16_bf16 a[80:95], a[172:175], v[140:143], a[80:95]
  buffer_load_dwordx4 v227, s[8:11], s76 offen offset:2048 lds
  s_waitcnt lgkmcnt(10)
  v_mfma_f32_32x32x16_bf16 a[96:111], a[176:179], v[136:139], a[96:111]
  ds_read_b64_tr_b16 a[142:143], v215 offset:41984
  ds_read_b64_tr_b16 a[144:145], v216 offset:36864
  v_mfma_f32_32x32x16_bf16 a[112:127], a[176:179], v[140:143], a[112:127]
  buffer_load_dwordx4 v228, s[8:11], s76 offen offset:3072 lds
  v_mfma_f32_32x32x16_bf16 a[208:223], a[180:183], v[136:139], a[208:223]
  ds_read_b64_tr_b16 a[146:147], v216 offset:37376
  ds_read_b64_tr_b16 a[148:149], v217 offset:36864
  v_mfma_f32_32x32x16_bf16 a[224:239], a[180:183], v[140:143], a[224:239]
  s_add_u32 m0, s77, 16384
  s_mov_b32 s74, 2097152
  buffer_load_dwordx4 v229, s[12:15], s74 offen lds
  v_mfma_f32_32x32x16_bf16 v[48:63], a[184:187], v[136:139], v[48:63]
  ds_read_b64_tr_b16 a[150:151], v217 offset:37376
  ds_read_b64_tr_b16 a[152:153], v218 offset:36864
  v_mfma_f32_32x32x16_bf16 v[64:79], a[184:187], v[140:143], v[64:79]
  buffer_load_dwordx4 v230, s[12:15], s74 offen offset:1024 lds
  v_mfma_f32_32x32x16_bf16 v[80:95], a[188:191], v[136:139], v[80:95]
  ds_read_b64_tr_b16 a[154:155], v218 offset:37376
  ds_read_b64_tr_b16 a[156:157], v219 offset:36864
  v_mfma_f32_32x32x16_bf16 v[96:111], a[188:191], v[140:143], v[96:111]
  buffer_load_dwordx4 v231, s[12:15], s74 offen offset:2048 lds
  ds_read_b64_tr_b16 a[158:159], v219 offset:37376
  s_waitcnt lgkmcnt(10)
  v_mfma_f32_32x32x16_bf16 a[240:255], a[192:195], v[136:139], a[240:255]
  ds_read_b64_tr_b16 a[160:161], v220 offset:36864
  buffer_load_dwordx4 v232, s[12:15], s74 offen offset:3072 lds
  v_mfma_f32_16x16x32_bf16 v[204:207], a[200:203], a[164:167], v[204:207]
  v_mfma_f32_16x16x32_bf16 v[208:211], a[200:203], a[196:199], v[208:211]
  ds_read_b64_tr_b16 a[162:163], v220 offset:37376
  v_mfma_f32_32x32x16_bf16 a[0:15], a[128:131], v[144:147], a[0:15]
  ds_read_b64_tr_b16 a[164:165], v212 offset:45056
  ds_read_b64_tr_b16 a[166:167], v212 offset:46080
  v_mfma_f32_32x32x16_bf16 a[16:31], a[128:131], v[148:151], a[16:31]
  ds_read_b64_tr_b16 a[168:169], v213 offset:45056
  v_mfma_f32_32x32x16_bf16 a[32:47], a[132:135], v[144:147], a[32:47]
  s_add_u32 m0, s78, 16384
  s_mov_b32 s75, 884736
  buffer_load_dwordx4 v233, s[16:19], s75 offen lds
  v_mfma_f32_32x32x16_bf16 a[48:63], a[132:135], v[148:151], a[48:63]
  v_mfma_f32_32x32x16_bf16 a[64:79], a[136:139], v[144:147], a[64:79]
  ds_read_b64_tr_b16 a[170:171], v213 offset:46080
  ds_read_b64_tr_b16 a[172:173], v214 offset:45056
  ds_read_b64_tr_b16 a[174:175], v214 offset:46080
  v_mfma_f32_32x32x16_bf16 a[80:95], a[136:139], v[148:151], a[80:95]
  ds_read_b64_tr_b16 a[176:177], v215 offset:45056
  ds_read_b64_tr_b16 a[178:179], v215 offset:46080
  s_waitcnt lgkmcnt(11)
  v_mfma_f32_32x32x16_bf16 a[96:111], a[140:143], v[144:147], a[96:111]
  ds_read_b64_tr_b16 a[180:181], v216 offset:38912
  v_mfma_f32_32x32x16_bf16 a[112:127], a[140:143], v[148:151], a[112:127]
  buffer_load_dwordx4 v234, s[16:19], s75 offen offset:1024 lds
  v_mfma_f32_32x32x16_bf16 a[208:223], a[144:147], v[144:147], a[208:223]
  ds_read_b64_tr_b16 a[182:183], v216 offset:39424
  ds_read_b64_tr_b16 a[184:185], v217 offset:38912
  v_mfma_f32_32x32x16_bf16 a[224:239], a[144:147], v[148:151], a[224:239]
  ds_read_b64_tr_b16 a[186:187], v217 offset:39424
  ds_read_b64_tr_b16 a[188:189], v218 offset:38912
  ds_read_b64_tr_b16 a[190:191], v218 offset:39424
  v_mfma_f32_32x32x16_bf16 v[48:63], a[148:151], v[144:147], v[48:63]
  ds_read_b64_tr_b16 a[192:193], v219 offset:38912
  v_mfma_f32_32x32x16_bf16 v[64:79], a[148:151], v[148:151], v[64:79]
  s_add_u32 m0, s78, 24576
  s_nop 0
  buffer_load_dwordx4 v235, s[20:23], s75 offen lds
  v_mfma_f32_32x32x16_bf16 v[80:95], a[152:155], v[144:147], v[80:95]
  ds_read_b64_tr_b16 a[194:195], v219 offset:39424
  v_mfma_f32_32x32x16_bf16 v[96:111], a[152:155], v[148:151], v[96:111]
  ds_read_b64_tr_b16 a[196:197], v220 offset:38912
  ds_read_b64_tr_b16 a[198:199], v220 offset:39424
  s_waitcnt lgkmcnt(13)
  v_mfma_f32_32x32x16_bf16 a[240:255], a[156:159], v[144:147], a[240:255]
  buffer_load_dwordx4 v236, s[20:23], s75 offen offset:1024 lds
  v_mfma_f32_16x16x32_bf16 v[204:207], a[200:203], a[128:131], v[204:207]
  v_mfma_f32_16x16x32_bf16 v[208:211], a[200:203], a[160:163], v[208:211]
  v_mfma_f32_32x32x16_bf16 a[0:15], a[164:167], v[152:155], a[0:15]
  s_waitcnt vmcnt(12) lgkmcnt(0)
  s_barrier
  v_mfma_f32_32x32x16_bf16 a[16:31], a[164:167], v[156:159], a[16:31]
  s_waitcnt vmcnt(8)
  ds_read_b64_tr_b16 a[128:129], v212 offset:0
  ds_read_b128 v[160:163], v221 offset:8192
  ds_read_b64_tr_b16 a[130:131], v212 offset:1024
  v_mfma_f32_32x32x16_bf16 a[32:47], a[168:171], v[152:155], a[32:47]
  ds_read_b128 v[164:167], v221 offset:12288
  ds_read_b64_tr_b16 a[132:133], v213 offset:0
  ds_read_b128 v[168:171], v222 offset:8192
  ds_read_b64_tr_b16 a[134:135], v213 offset:1024
  ds_read_b128 v[172:175], v222 offset:12288
  v_mfma_f32_32x32x16_bf16 a[48:63], a[168:171], v[156:159], a[48:63]
  ds_read_b64_tr_b16 a[136:137], v214 offset:0
  ds_read_b128 v[176:179], v223 offset:8192
  ds_read_b64_tr_b16 a[138:139], v214 offset:1024
  ds_read_b128 v[180:183], v223 offset:12288
  v_mfma_f32_32x32x16_bf16 a[64:79], a[172:175], v[152:155], a[64:79]
  ds_read_b64_tr_b16 a[140:141], v215 offset:0
  ds_read_b128 v[184:187], v224 offset:8192
  ds_read_b64_tr_b16 a[142:143], v215 offset:1024
  ds_read_b128 v[188:191], v224 offset:12288
  ds_read_b64_tr_b16 a[144:145], v216 offset:0
  v_mfma_f32_32x32x16_bf16 a[80:95], a[172:175], v[156:159], a[80:95]
  ds_read_b64_tr_b16 a[146:147], v216 offset:512
  v_mfma_f32_32x32x16_bf16 a[96:111], a[176:179], v[152:155], a[96:111]
  s_add_u32 m0, s79, 0
  s_add_u32 s76, s72, 512
  buffer_load_dwordx4 v225, s[8:11], s76 offen lds
  ds_read_b64_tr_b16 a[148:149], v217 offset:0
  v_mfma_f32_32x32x16_bf16 a[112:127], a[176:179], v[156:159], a[112:127]
  buffer_load_dwordx4 v226, s[8:11], s76 offen offset:1024 lds
  v_mfma_f32_32x32x16_bf16 a[208:223], a[180:183], v[152:155], a[208:223]
  ds_read_b64_tr_b16 a[150:151], v217 offset:512
  buffer_load_dwordx4 v227, s[8:11], s76 offen offset:2048 lds
  v_mfma_f32_32x32x16_bf16 a[224:239], a[180:183], v[156:159], a[224:239]
  ds_read_b64_tr_b16 a[152:153], v218 offset:0
  buffer_load_dwordx4 v228, s[8:11], s76 offen offset:3072 lds
  v_mfma_f32_32x32x16_bf16 v[48:63], a[184:187], v[152:155], v[48:63]
  ds_read_b64_tr_b16 a[154:155], v218 offset:512
  ds_read_b64_tr_b16 a[156:157], v219 offset:0
  v_mfma_f32_32x32x16_bf16 v[64:79], a[184:187], v[156:159], v[64:79]
  s_add_u32 m0, s79, 4096
  s_add_u32 s76, s73, 512
  buffer_load_dwordx4 v225, s[8:11], s76 offen lds
  v_mfma_f32_32x32x16_bf16 v[80:95], a[188:191], v[152:155], v[80:95]
  ds_read_b64_tr_b16 a[158:159], v219 offset:512
  buffer_load_dwordx4 v226, s[8:11], s76 offen offset:1024 lds
  v_mfma_f32_32x32x16_bf16 v[96:111], a[188:191], v[156:159], v[96:111]
  ds_read_b64_tr_b16 a[160:161], v220 offset:0
  v_mfma_f32_32x32x16_bf16 a[240:255], a[192:195], v[152:155], a[240:255]
  buffer_load_dwordx4 v227, s[8:11], s76 offen offset:2048 lds
  ds_read_b64_tr_b16 a[162:163], v220 offset:512
  v_mfma_f32_16x16x32_bf16 v[204:207], a[200:203], a[164:167], v[204:207]
  buffer_load_dwordx4 v228, s[8:11], s76 offen offset:3072 lds
  v_mfma_f32_16x16x32_bf16 v[208:211], a[200:203], a[196:199], v[208:211]
  s_waitcnt lgkmcnt(8)
  v_mfma_f32_32x32x16_bf16 a[0:15], a[128:131], v[160:163], a[0:15]
  s_lshl2_add_u32 s82, s4, s3
  ds_read_b64_tr_b16 a[164:165], v212 offset:4096
  s_mul_i32 s82, s82, 2560
  ds_read_b64_tr_b16 a[166:167], v212 offset:5120
  v_lshrrev_b32 v39, 5, v6
  v_mfma_f32_32x32x16_bf16 a[16:31], a[128:131], v[164:167], a[16:31]
  ds_read_b64_tr_b16 a[168:169], v213 offset:4096
  s_add_u32 m0, s79, 8192
  s_add_u32 s76, s72, 640
  buffer_load_dwordx4 v225, s[8:11], s76 offen lds
  v_mul_u32_u24 v40, 1280, v39
  v_mfma_f32_32x32x16_bf16 a[32:47], a[132:135], v[160:163], a[32:47]
  ds_read_b64_tr_b16 a[170:171], v213 offset:5120
  v_add_u32 v40, s82, v40
  v_and_b32 v38, 31, v6
  v_mfma_f32_32x32x16_bf16 a[48:63], a[132:135], v[164:167], a[48:63]
  ds_read_b64_tr_b16 a[172:173], v214 offset:4096
  buffer_load_dwordx4 v226, s[8:11], s76 offen offset:1024 lds
  v_lshl_add_u32 v41, v38, 3, v40
  v_mfma_f32_32x32x16_bf16 a[64:79], a[136:139], v[160:163], a[64:79]
  ds_read_b64_tr_b16 a[174:175], v214 offset:5120
  ds_read_b64_tr_b16 a[176:177], v215 offset:4096
  v_lshl_add_u32 v40, v38, 4, v40
  v_mfma_f32_32x32x16_bf16 a[80:95], a[136:139], v[164:167], a[80:95]
  buffer_load_dwordx4 v[16:19], v40, s[8:11], 0 offen
  buffer_load_dwordx4 v227, s[8:11], s76 offen offset:2048 lds
  v_mfma_f32_32x32x16_bf16 a[96:111], a[140:143], v[160:163], a[96:111]
  buffer_load_dwordx4 v[20:23], v40, s[8:11], 0 offen offset:512
  ds_read_b64_tr_b16 a[178:179], v215 offset:5120
  v_mfma_f32_32x32x16_bf16 a[112:127], a[140:143], v[164:167], a[112:127]
  buffer_load_dwordx2 v[24:25], v41, s[8:11], 0 offen offset:1024
  ds_read_b64_tr_b16 a[180:181], v216 offset:2048
  s_lshr_b32 s82, s4, 2
  v_mfma_f32_32x32x16_bf16 a[208:223], a[144:147], v[160:163], a[208:223]
  buffer_load_dwordx4 v228, s[8:11], s76 offen offset:3072 lds
  ds_read_b64_tr_b16 a[182:183], v216 offset:2560
  s_mul_i32 s82, s82, 373760
  v_mfma_f32_32x32x16_bf16 a[224:239], a[144:147], v[164:167], a[224:239]
  ds_read_b64_tr_b16 a[184:185], v217 offset:2048
  s_and_b32 s83, s4, 3
  s_add_u32 m0, s77, 32768
  s_mov_b32 s74, 2621440
  buffer_load_dwordx4 v229, s[12:15], s74 offen lds
  s_waitcnt lgkmcnt(7)
  v_mfma_f32_32x32x16_bf16 v[48:63], a[148:151], v[160:163], v[48:63]
  s_lshl2_add_u32 s83, s83, s3
  ds_read_b64_tr_b16 a[186:187], v217 offset:2560
  s_lshl4_add_u32 s82, s83, s82
  v_mfma_f32_32x32x16_bf16 v[64:79], a[148:151], v[164:167], v[64:79]
  ds_read_b64_tr_b16 a[188:189], v218 offset:2048
  s_add_u32 s82, s82, 372736
  buffer_load_dwordx4 v230, s[12:15], s74 offen offset:1024 lds
  v_mfma_f32_32x32x16_bf16 v[80:95], a[152:155], v[160:163], v[80:95]
  ds_read_b64_tr_b16 a[190:191], v218 offset:2560
  ds_read_b64_tr_b16 a[192:193], v219 offset:2048
  v_lshlrev_b32 v42, 3, v39
  v_add_u32 v42, s82, v42
  v_mfma_f32_32x32x16_bf16 v[96:111], a[152:155], v[164:167], v[96:111]
  buffer_load_dwordx4 v231, s[12:15], s74 offen offset:2048 lds
  ds_read_b64_tr_b16 a[194:195], v219 offset:2560
  v_mov_b32 v44, 0x40000000
  v_cmp_eq_u32 vcc, 0, v38
  s_nop 1
  v_cndmask_b32 v42, v44, v42, vcc
  v_mfma_f32_32x32x16_bf16 a[240:255], a[156:159], v[160:163], a[240:255]
  ds_read_b64_tr_b16 a[196:197], v220 offset:2048
  buffer_load_dwordx4 v232, s[12:15], s74 offen offset:3072 lds
  v_cmp_eq_u32 vcc, 0, v0
  s_nop 1
  v_cndmask_b32 v43, v44, 0, vcc
  v_mfma_f32_16x16x32_bf16 v[204:207], a[200:203], a[128:131], v[204:207]
  v_mfma_f32_16x16x32_bf16 v[208:211], a[200:203], a[160:163], v[208:211]
  ds_read_b64_tr_b16 a[198:199], v220 offset:2560
  v_mov_b32 v44, 1
  v_mfma_f32_32x32x16_bf16 a[0:15], a[164:167], v[168:171], a[0:15]
  ds_read_b64_tr_b16 a[128:129], v212 offset:8192
  ds_read_b64_tr_b16 a[130:131], v212 offset:9216
  v_mfma_f32_32x32x16_bf16 a[16:31], a[164:167], v[172:175], a[16:31]
  ds_read_b64_tr_b16 a[132:133], v213 offset:8192
  ds_read_b64_tr_b16 a[134:135], v213 offset:9216
  v_mfma_f32_32x32x16_bf16 a[32:47], a[168:171], v[168:171], a[32:47]
  ds_read_b64_tr_b16 a[136:137], v214 offset:8192
  v_mfma_f32_32x32x16_bf16 a[48:63], a[168:171], v[172:175], a[48:63]
  s_add_u32 m0, s79, 12288
  s_add_u32 s76, s73, 640
  buffer_load_dwordx4 v225, s[8:11], s76 offen lds
  s_waitcnt lgkmcnt(7)
  v_mfma_f32_32x32x16_bf16 a[64:79], a[172:175], v[168:171], a[64:79]
  v_mfma_f32_32x32x16_bf16 a[80:95], a[172:175], v[172:175], a[80:95]
  ds_read_b64_tr_b16 a[138:139], v214 offset:9216
  ds_read_b64_tr_b16 a[140:141], v215 offset:8192
  v_mfma_f32_32x32x16_bf16 a[96:111], a[176:179], v[168:171], a[96:111]
  ds_read_b64_tr_b16 a[142:143], v215 offset:9216
  ds_read_b64_tr_b16 a[144:145], v216 offset:4096
  v_mfma_f32_32x32x16_bf16 a[112:127], a[176:179], v[172:175], a[112:127]
  buffer_load_dwordx4 v226, s[8:11], s76 offen offset:1024 lds
  v_mfma_f32_32x32x16_bf16 a[208:223], a[180:183], v[168:171], a[208:223]
  ds_read_b64_tr_b16 a[146:147], v216 offset:4608
  v_mfma_f32_32x32x16_bf16 a[224:239], a[180:183], v[172:175], a[224:239]
  ds_read_b64_tr_b16 a[148:149], v217 offset:4096
  ds_read_b64_tr_b16 a[150:151], v217 offset:4608
  ds_read_b64_tr_b16 a[152:153], v218 offset:4096
  v_mfma_f32_32x32x16_bf16 v[48:63], a[184:187], v[168:171], v[48:63]
  v_mfma_f32_32x32x16_bf16 v[64:79], a[184:187], v[172:175], v[64:79]
  buffer_load_dwordx4 v227, s[8:11], s76 offen offset:2048 lds
  v_mfma_f32_32x32x16_bf16 v[80:95], a[188:191], v[168:171], v[80:95]
  ds_read_b64_tr_b16 a[154:155], v218 offset:4608
  ds_read_b64_tr_b16 a[156:157], v219 offset:4096
  ds_read_b64_tr_b16 a[158:159], v219 offset:4608
  v_mfma_f32_32x32x16_bf16 v[96:111], a[188:191], v[172:175], v[96:111]
  buffer_load_dwordx4 v228, s[8:11], s76 offen offset:3072 lds
  v_mfma_f32_32x32x16_bf16 a[240:255], a[192:195], v[168:171], a[240:255]
  v_mfma_f32_16x16x32_bf16 v[204:207], a[200:203], a[164:167], v[204:207]
  ds_read_b64_tr_b16 a[160:161], v220 offset:4096
  s_waitcnt lgkmcnt(12)
  v_mfma_f32_16x16x32_bf16 v[208:211], a[200:203], a[196:199], v[208:211]
  ds_read_b64_tr_b16 a[162:163], v220 offset:4608
  v_mfma_f32_32x32x16_bf16 a[0:15], a[128:131], v[176:179], a[0:15]
  ds_read_b64_tr_b16 a[164:165], v212 offset:12288
  ds_read_b64_tr_b16 a[166:167], v212 offset:13312
  v_mfma_f32_32x32x16_bf16 a[16:31], a[128:131], v[180:183], a[16:31]
  ds_read_b64_tr_b16 a[168:169], v213 offset:12288
  v_mfma_f32_32x32x16_bf16 a[32:47], a[132:135], v[176:179], a[32:47]
  s_add_u32 m0, s78, 32768
  s_mov_b32 s75, 1105920
  buffer_load_dwordx4 v233, s[16:19], s75 offen lds
  v_mfma_f32_32x32x16_bf16 a[48:63], a[132:135], v[180:183], a[48:63]
  s_waitcnt lgkmcnt(10)
  v_mfma_f32_32x32x16_bf16 a[64:79], a[136:139], v[176:179], a[64:79]
  ds_read_b64_tr_b16 a[170:171], v213 offset:13312
  ds_read_b64_tr_b16 a[172:173], v214 offset:12288
  ds_read_b64_tr_b16 a[174:175], v214 offset:13312
  v_mfma_f32_32x32x16_bf16 a[80:95], a[136:139], v[180:183], a[80:95]
  ds_read_b64_tr_b16 a[176:177], v215 offset:12288
  ds_read_b64_tr_b16 a[178:179], v215 offset:13312
  v_mfma_f32_32x32x16_bf16 a[96:111], a[140:143], v[176:179], a[96:111]
  ds_read_b64_tr_b16 a[180:181], v216 offset:6144
  v_mfma_f32_32x32x16_bf16 a[112:127], a[140:143], v[180:183], a[112:127]
  buffer_load_dwordx4 v234, s[16:19], s75 offen offset:1024 lds
  v_mfma_f32_32x32x16_bf16 a[208:223], a[144:147], v[176:179], a[208:223]
  ds_read_b64_tr_b16 a[182:183], v216 offset:6656
  ds_read_b64_tr_b16 a[184:185], v217 offset:6144
  v_mfma_f32_32x32x16_bf16 a[224:239], a[144:147], v[180:183], a[224:239]
  ds_read_b64_tr_b16 a[186:187], v217 offset:6656
  ds_read_b64_tr_b16 a[188:189], v218 offset:6144
  ds_read_b64_tr_b16 a[190:191], v218 offset:6656
  s_waitcnt lgkmcnt(13)
  v_mfma_f32_32x32x16_bf16 v[48:63], a[148:151], v[176:179], v[48:63]
  ds_read_b64_tr_b16 a[192:193], v219 offset:6144
  v_mfma_f32_32x32x16_bf16 v[64:79], a[148:151], v[180:183], v[64:79]
  s_add_u32 m0, s78, 40960
  s_nop 0
  buffer_load_dwordx4 v235, s[20:23], s75 offen lds
  v_mfma_f32_32x32x16_bf16 v[80:95], a[152:155], v[176:179], v[80:95]
  ds_read_b64_tr_b16 a[194:195], v219 offset:6656
  v_mfma_f32_32x32x16_bf16 v[96:111], a[152:155], v[180:183], v[96:111]
  ds_read_b64_tr_b16 a[196:197], v220 offset:6144
  ds_read_b64_tr_b16 a[198:199], v220 offset:6656
  v_mfma_f32_32x32x16_bf16 a[240:255], a[156:159], v[176:179], a[240:255]
  buffer_load_dwordx4 v236, s[20:23], s75 offen offset:1024 lds
  v_mfma_f32_16x16x32_bf16 v[204:207], a[200:203], a[128:131], v[204:207]
  v_mfma_f32_16x16x32_bf16 v[208:211], a[200:203], a[160:163], v[208:211]
  s_waitcnt lgkmcnt(10)
  v_mfma_f32_32x32x16_bf16 a[0:15], a[164:167], v[184:187], a[0:15]
  s_waitcnt vmcnt(27) lgkmcnt(0)
  s_barrier
  v_mfma_f32_32x32x16_bf16 a[16:31], a[164:167], v[188:191], a[16:31]
  ds_read_b64_tr_b16 a[128:129], v212 offset:16384
  v_mfma_f32_32x32x16_bf16 a[32:47], a[168:171], v[184:187], a[32:47]
  s_add_u32 m0, s77, 0
  s_mov_b32 s74, 3145728
  buffer_load_dwordx4 v229, s[12:15], s74 offen lds
  v_mfma_f32_32x32x16_bf16 a[48:63], a[168:171], v[188:191], a[48:63]
  ds_read_b64_tr_b16 a[130:131], v212 offset:17408
  v_mfma_f32_32x32x16_bf16 a[64:79], a[172:175], v[184:187], a[64:79]
  buffer_load_dwordx4 v230, s[12:15], s74 offen offset:1024 lds
  v_mfma_f32_32x32x16_bf16 a[80:95], a[172:175], v[188:191], a[80:95]
  ds_read_b64_tr_b16 a[132:133], v213 offset:16384
  buffer_load_dwordx4 v231, s[12:15], s74 offen offset:2048 lds
  v_mfma_f32_32x32x16_bf16 a[96:111], a[176:179], v[184:187], a[96:111]
  ds_read_b64_tr_b16 a[134:135], v213 offset:17408
  v_mfma_f32_32x32x16_bf16 a[112:127], a[176:179], v[188:191], a[112:127]
  ds_read_b64_tr_b16 a[136:137], v214 offset:16384
  buffer_load_dwordx4 v232, s[12:15], s74 offen offset:3072 lds
  v_mfma_f32_32x32x16_bf16 a[208:223], a[180:183], v[184:187], a[208:223]
  ds_read_b64_tr_b16 a[138:139], v214 offset:17408
  s_waitcnt vmcnt(23)
  v_mfma_f32_32x32x16_bf16 a[224:239], a[180:183], v[188:191], a[224:239]
  ds_read_b64_tr_b16 a[140:141], v215 offset:16384
  ds_read_b64_tr_b16 a[142:143], v215 offset:17408
  ds_read_b128 v[128:131], v221 offset:0
  v_mfma_f32_32x32x16_bf16 v[48:63], a[184:187], v[184:187], v[48:63]
  ds_read_b64_tr_b16 a[144:145], v216 offset:16384
  ds_read_b128 v[132:135], v221 offset:4096
  ds_read_b64_tr_b16 a[146:147], v216 offset:16896
  v_mfma_f32_32x32x16_bf16 v[64:79], a[184:187], v[188:191], v[64:79]
  ds_read_b128 v[136:139], v222 offset:0
  ds_read_b64_tr_b16 a[148:149], v217 offset:16384
  ds_read_b64_tr_b16 a[150:151], v217 offset:16896
  v_mfma_f32_32x32x16_bf16 v[80:95], a[188:191], v[184:187], v[80:95]
  ds_read_b128 v[140:143], v222 offset:4096
  ds_read_b64_tr_b16 a[152:153], v218 offset:16384
  ds_read_b128 v[144:147], v223 offset:0
  v_mfma_f32_32x32x16_bf16 v[96:111], a[188:191], v[188:191], v[96:111]
  ds_read_b64_tr_b16 a[154:155], v218 offset:16896
  ds_read_b64_tr_b16 a[156:157], v219 offset:16384
  ds_read_b128 v[148:151], v223 offset:4096
  v_mfma_f32_32x32x16_bf16 a[240:255], a[192:195], v[184:187], a[240:255]
  ds_read_b64_tr_b16 a[158:159], v219 offset:16896
  ds_read_b128 v[152:155], v224 offset:0
  ds_read_b64_tr_b16 a[160:161], v220 offset:16384
  v_mfma_f32_16x16x32_bf16 v[204:207], a[200:203], a[164:167], v[204:207]
  ds_read_b128 v[156:159], v224 offset:4096
  v_mfma_f32_16x16x32_bf16 v[208:211], a[200:203], a[196:199], v[208:211]
  ds_read_b64_tr_b16 a[162:163], v220 offset:16896
  s_waitcnt lgkmcnt(15)
  v_mfma_f32_32x32x16_bf16 a[0:15], a[128:131], v[128:131], a[0:15]
  ds_read_b64_tr_b16 a[164:165], v212 offset:20480
  s_waitcnt vmcnt(20)
  v_lshlrev_b32 v200, 16, v16
  v_and_b32 v201, s80, v16
  v_add_f32 v192, v192, v200
  v_mfma_f32_32x32x16_bf16 a[16:31], a[128:131], v[132:135], a[16:31]
  ds_read_b64_tr_b16 a[166:167], v212 offset:21504
  s_waitcnt lgkmcnt(3)
  ds_read_b64_tr_b16 a[168:169], v213 offset:20480
  v_fmac_f32 v196, v200, v200
  v_add_f32 v193, v193, v201
  v_mfma_f32_32x32x16_bf16 a[32:47], a[132:135], v[128:131], a[32:47]
  ds_read_b64_tr_b16 a[170:171], v213 offset:21504
  v_fmac_f32 v197, v201, v201
  v_lshlrev_b32 v202, 16, v17
  v_and_b32 v203, s80, v17
  v_mfma_f32_32x32x16_bf16 a[48:63], a[132:135], v[132:135], a[48:63]
  ds_read_b64_tr_b16 a[172:173], v214 offset:20480
  v_add_f32 v192, v192, v202
  v_mfma_f32_32x32x16_bf16 a[64:79], a[136:139], v[128:131], a[64:79]
  s_add_u32 m0, s79, 0
  s_add_u32 s76, s72, 768
  buffer_load_dwordx4 v225, s[8:11], s76 offen lds
  ds_read_b64_tr_b16 a[174:175], v214 offset:21504
  v_mfma_f32_32x32x16_bf16 a[80:95], a[136:139], v[132:135], a[80:95]
  ds_read_b64_tr_b16 a[176:177], v215 offset:20480
  v_fmac_f32 v196, v202, v202
  v_add_f32 v193, v193, v203
  v_fmac_f32 v197, v203, v203
  v_mfma_f32_32x32x16_bf16 a[96:111], a[140:143], v[128:131], a[96:111]
  ds_read_b64_tr_b16 a[178:179], v215 offset:21504
  v_lshlrev_b32 v200, 16, v18
  v_and_b32 v201, s80, v18
  v_add_f32 v192, v192, v200
  v_mfma_f32_32x32x16_bf16 a[112:127], a[140:143], v[132:135], a[112:127]
  ds_read_b64_tr_b16 a[180:181], v216 offset:18432
  buffer_load_dwordx4 v226, s[8:11], s76 offen offset:1024 lds
  v_fmac_f32 v196, v200, v200
  v_mfma_f32_32x32x16_bf16 a[208:223], a[144:147], v[128:131], a[208:223]
  ds_read_b64_tr_b16 a[182:183], v216 offset:18944
  v_add_f32 v193, v193, v201
  v_fmac_f32 v197, v201, v201
  v_mfma_f32_32x32x16_bf16 a[224:239], a[144:147], v[132:135], a[224:239]
  ds_read_b64_tr_b16 a[184:185], v217 offset:18432
  ds_read_b64_tr_b16 a[186:187], v217 offset:18944
  v_lshlrev_b32 v202, 16, v19
  v_and_b32 v203, s80, v19
  v_mfma_f32_32x32x16_bf16 v[48:63], a[148:151], v[128:131], v[48:63]
  ds_read_b64_tr_b16 a[188:189], v218 offset:18432
  v_add_f32 v192, v192, v202
  v_fmac_f32 v196, v202, v202
  v_mfma_f32_32x32x16_bf16 v[64:79], a[148:151], v[132:135], v[64:79]
  buffer_load_dwordx4 v227, s[8:11], s76 offen offset:2048 lds
  ds_read_b64_tr_b16 a[190:191], v218 offset:18944
  v_add_f32 v193, v193, v203
  v_mfma_f32_32x32x16_bf16 v[80:95], a[152:155], v[128:131], v[80:95]
  ds_read_b64_tr_b16 a[192:193], v219 offset:18432
  v_fmac_f32 v197, v203, v203
  s_waitcnt vmcnt(21)
  v_lshlrev_b32 v200, 16, v20
  v_and_b32 v201, s80, v20
  v_mfma_f32_32x32x16_bf16 v[96:111], a[152:155], v[132:135], v[96:111]
  ds_read_b64_tr_b16 a[194:195], v219 offset:18944
  v_add_f32 v192, v192, v200
  v_fmac_f32 v196, v200, v200
  v_mfma_f32_32x32x16_bf16 a[240:255], a[156:159], v[128:131], a[240:255]
  buffer_load_dwordx4 v228, s[8:11], s76 offen offset:3072 lds
  ds_read_b64_tr_b16 a[196:197], v220 offset:18432
  v_add_f32 v193, v193, v201
  v_mfma_f32_16x16x32_bf16 v[204:207], a[200:203], a[128:131], v[204:207]
  ds_read_b64_tr_b16 a[198:199], v220 offset:18944
  v_fmac_f32 v197, v201, v201
  s_waitcnt lgkmcnt(6)
  v_mfma_f32_16x16x32_bf16 v[208:211], a[200:203], a[160:163], v[208:211]
  v_lshlrev_b32 v202, 16, v21
  v_mfma_f32_32x32x16_bf16 a[0:15], a[164:167], v[136:139], a[0:15]
  ds_read_b64_tr_b16 a[128:129], v212 offset:24576
  v_and_b32 v203, s80, v21
  v_add_f32 v192, v192, v202
  v_fmac_f32 v196, v202, v202
  v_mfma_f32_32x32x16_bf16 a[16:31], a[164:167], v[140:143], a[16:31]
  ds_read_b64_tr_b16 a[130:131], v212 offset:25600
  ds_read_b64_tr_b16 a[132:133], v213 offset:24576
  v_add_f32 v193, v193, v203
  v_fmac_f32 v197, v203, v203
  v_mfma_f32_32x32x16_bf16 a[32:47], a[168:171], v[136:139], a[32:47]
  ds_read_b64_tr_b16 a[134:135], v213 offset:25600
  v_lshlrev_b32 v200, 16, v22
  v_and_b32 v201, s80, v22
  v_add_f32 v192, v192, v200
  v_mfma_f32_32x32x16_bf16 a[48:63], a[168:171], v[140:143], a[48:63]
  ds_read_b64_tr_b16 a[136:137], v214 offset:24576
  v_fmac_f32 v196, v200, v200
  v_mfma_f32_32x32x16_bf16 a[64:79], a[172:175], v[136:139], a[64:79]
  s_add_u32 m0, s79, 4096
  s_add_u32 s76, s73, 768
  buffer_load_dwordx4 v225, s[8:11], s76 offen lds
  ds_read_b64_tr_b16 a[138:139], v214 offset:25600
  v_mfma_f32_32x32x16_bf16 a[80:95], a[172:175], v[140:143], a[80:95]
  ds_read_b64_tr_b16 a[140:141], v215 offset:24576
  v_add_f32 v193, v193, v201
  v_fmac_f32 v197, v201, v201
  v_lshlrev_b32 v202, 16, v23
  v_mfma_f32_32x32x16_bf16 a[96:111], a[176:179], v[136:139], a[96:111]
  ds_read_b64_tr_b16 a[142:143], v215 offset:25600
  v_and_b32 v203, s80, v23
  v_add_f32 v192, v192, v202
  v_fmac_f32 v196, v202, v202
  v_mfma_f32_32x32x16_bf16 a[112:127], a[176:179], v[140:143], a[112:127]
  ds_read_b64_tr_b16 a[144:145], v216 offset:20480
  buffer_load_dwordx4 v226, s[8:11], s76 offen offset:1024 lds
  v_add_f32 v193, v193, v203
  v_mfma_f32_32x32x16_bf16 a[208:223], a[180:183], v[136:139], a[208:223]
  ds_read_b64_tr_b16 a[146:147], v216 offset:20992
  v_fmac_f32 v197, v203, v203
  s_waitcnt vmcnt(23)
  v_lshlrev_b32 v200, 16, v24
  v_mfma_f32_32x32x16_bf16 a[224:239], a[180:183], v[140:143], a[224:239]
  ds_read_b64_tr_b16 a[148:149], v217 offset:20480
  ds_read_b64_tr_b16 a[150:151], v217 offset:20992
  v_and_b32 v201, s80, v24
  v_add_f32 v192, v192, v200
  v_mfma_f32_32x32x16_bf16 v[48:63], a[184:187], v[136:139], v[48:63]
  ds_read_b64_tr_b16 a[152:153], v218 offset:20480
  v_fmac_f32 v196, v200, v200
  v_add_f32 v193, v193, v201
  v_mfma_f32_32x32x16_bf16 v[64:79], a[184:187], v[140:143], v[64:79]
  buffer_load_dwordx4 v227, s[8:11], s76 offen offset:2048 lds
  ds_read_b64_tr_b16 a[154:155], v218 offset:20992
  v_fmac_f32 v197, v201, v201
  s_waitcnt lgkmcnt(7)
  v_mfma_f32_32x32x16_bf16 v[80:95], a[188:191], v[136:139], v[80:95]
  ds_read_b64_tr_b16 a[156:157], v219 offset:20480
  v_lshlrev_b32 v202, 16, v25
  v_and_b32 v203, s80, v25
  v_add_f32 v192, v192, v202
  v_mfma_f32_32x32x16_bf16 v[96:111], a[188:191], v[140:143], v[96:111]
  ds_read_b64_tr_b16 a[158:159], v219 offset:20992
  v_fmac_f32 v196, v202, v202
  v_add_f32 v193, v193, v203
  v_mfma_f32_32x32x16_bf16 a[240:255], a[192:195], v[136:139], a[240:255]
  buffer_load_dwordx4 v228, s[8:11], s76 offen offset:3072 lds
  ds_read_b64_tr_b16 a[160:161], v220 offset:20480
  v_fmac_f32 v197, v203, v203
  v_mfma_f32_16x16x32_bf16 v[204:207], a[200:203], a[164:167], v[204:207]
  ds_read_b64_tr_b16 a[162:163], v220 offset:20992
  v_add_f32 v26, v192, v193
  v_mfma_f32_16x16x32_bf16 v[208:211], a[200:203], a[196:199], v[208:211]
  v_add_f32 v27, v196, v197
  v_mfma_f32_32x32x16_bf16 a[0:15], a[128:131], v[144:147], a[0:15]
  ds_read_b64_tr_b16 a[164:165], v212 offset:28672
  ds_swizzle_b32 v28, v26 offset:1055
  ds_swizzle_b32 v29, v27 offset:1055
  v_mfma_f32_32x32x16_bf16 a[16:31], a[128:131], v[148:151], a[16:31]
  ds_read_b64_tr_b16 a[166:167], v212 offset:29696
  ds_read_b64_tr_b16 a[168:169], v213 offset:28672
  v_mfma_f32_32x32x16_bf16 a[32:47], a[132:135], v[144:147], a[32:47]
  s_add_u32 m0, s78, 0
  s_mov_b32 s75, 1327104
  buffer_load_dwordx4 v233, s[16:19], s75 offen lds
  v_mfma_f32_32x32x16_bf16 a[48:63], a[132:135], v[148:151], a[48:63]
  ds_read_b64_tr_b16 a[170:171], v213 offset:29696
  v_mfma_f32_32x32x16_bf16 a[64:79], a[136:139], v[144:147], a[64:79]
  ds_read_b64_tr_b16 a[172:173], v214 offset:28672
  ds_read_b64_tr_b16 a[174:175], v214 offset:29696
  ds_read_b64_tr_b16 a[176:177], v215 offset:28672
  v_mfma_f32_32x32x16_bf16 a[80:95], a[136:139], v[148:151], a[80:95]
  ds_read_b64_tr_b16 a[178:179], v215 offset:29696
  s_waitcnt lgkmcnt(8)
  v_add_f32 v26, v26, v28
  s_waitcnt lgkmcnt(7)
  v_add_f32 v27, v27, v29
  v_mfma_f32_32x32x16_bf16 a[96:111], a[140:143], v[144:147], a[96:111]
  ds_read_b64_tr_b16 a[180:181], v216 offset:22528
  buffer_load_dwordx4 v234, s[16:19], s75 offen offset:1024 lds
  v_mfma_f32_32x32x16_bf16 a[112:127], a[140:143], v[148:151], a[112:127]
  ds_read_b64_tr_b16 a[182:183], v216 offset:23040
  v_mfma_f32_32x32x16_bf16 a[208:223], a[144:147], v[144:147], a[208:223]
  ds_read_b64_tr_b16 a[184:185], v217 offset:22528
  ds_swizzle_b32 v28, v26 offset:2079
  ds_swizzle_b32 v29, v27 offset:2079
  v_mfma_f32_32x32x16_bf16 a[224:239], a[144:147], v[148:151], a[224:239]
  ds_read_b64_tr_b16 a[186:187], v217 offset:23040
  ds_read_b64_tr_b16 a[188:189], v218 offset:22528
  ds_read_b64_tr_b16 a[190:191], v218 offset:23040
  v_mfma_f32_32x32x16_bf16 v[48:63], a[148:151], v[144:147], v[48:63]
  ds_read_b64_tr_b16 a[192:193], v219 offset:22528
  v_mfma_f32_32x32x16_bf16 v[64:79], a[148:151], v[148:151], v[64:79]
  s_add_u32 m0, s78, 8192
  s_nop 0
  buffer_load_dwordx4 v235, s[20:23], s75 offen lds
  v_mfma_f32_32x32x16_bf16 v[80:95], a[152:155], v[144:147], v[80:95]
  ds_read_b64_tr_b16 a[194:195], v219 offset:23040
  ds_read_b64_tr_b16 a[196:197], v220 offset:22528
  ds_read_b64_tr_b16 a[198:199], v220 offset:23040
  v_mfma_f32_32x32x16_bf16 v[96:111], a[152:155], v[148:151], v[96:111]
  s_waitcnt lgkmcnt(8)
  v_add_f32 v26, v26, v28
  s_waitcnt lgkmcnt(7)
  v_add_f32 v27, v27, v29
  v_mfma_f32_32x32x16_bf16 a[240:255], a[156:159], v[144:147], a[240:255]
  ds_swizzle_b32 v28, v26 offset:4127
  ds_swizzle_b32 v29, v27 offset:4127
  buffer_load_dwordx4 v236, s[20:23], s75 offen offset:1024 lds
  v_mfma_f32_16x16x32_bf16 v[204:207], a[200:203], a[128:131], v[204:207]
  v_mfma_f32_16x16x32_bf16 v[208:211], a[200:203], a[160:163], v[208:211]
  v_mfma_f32_32x32x16_bf16 a[0:15], a[164:167], v[152:155], a[0:15]
  s_waitcnt vmcnt(16) lgkmcnt(0)
  s_barrier
  v_mfma_f32_32x32x16_bf16 a[16:31], a[164:167], v[156:159], a[16:31]
  ds_read_b64_tr_b16 a[128:129], v212 offset:32768
  s_add_u32 m0, s77, 16384
  s_mov_b32 s74, 3670016
  buffer_load_dwordx4 v229, s[12:15], s74 offen lds
  v_mfma_f32_32x32x16_bf16 a[32:47], a[168:171], v[152:155], a[32:47]
  ds_read_b64_tr_b16 a[130:131], v212 offset:33792
  v_mfma_f32_32x32x16_bf16 a[48:63], a[168:171], v[156:159], a[48:63]
  buffer_load_dwordx4 v230, s[12:15], s74 offen offset:1024 lds
  v_mfma_f32_32x32x16_bf16 a[64:79], a[172:175], v[152:155], a[64:79]
  ds_read_b64_tr_b16 a[132:133], v213 offset:32768
  v_add_f32 v26, v26, v28
  v_add_f32 v27, v27, v29
  v_mfma_f32_32x32x16_bf16 a[80:95], a[172:175], v[156:159], a[80:95]
  buffer_load_dwordx4 v231, s[12:15], s74 offen offset:2048 lds
  ds_read_b64_tr_b16 a[134:135], v213 offset:33792
  v_mfma_f32_32x32x16_bf16 a[96:111], a[176:179], v[152:155], a[96:111]
  ds_swizzle_b32 v28, v26 offset:8223
  ds_swizzle_b32 v29, v27 offset:8223
  ds_read_b64_tr_b16 a[136:137], v214 offset:32768
  v_mfma_f32_32x32x16_bf16 a[112:127], a[176:179], v[156:159], a[112:127]
  buffer_load_dwordx4 v232, s[12:15], s74 offen offset:3072 lds
  ds_read_b64_tr_b16 a[138:139], v214 offset:33792
  v_mfma_f32_32x32x16_bf16 a[208:223], a[180:183], v[152:155], a[208:223]
  ds_read_b64_tr_b16 a[140:141], v215 offset:32768
  ds_read_b64_tr_b16 a[142:143], v215 offset:33792
  ds_read_b128 v[160:163], v221 offset:8192
  v_mfma_f32_32x32x16_bf16 a[224:239], a[180:183], v[156:159], a[224:239]
  ds_read_b64_tr_b16 a[144:145], v216 offset:32768
  ds_read_b128 v[164:167], v221 offset:12288
  s_waitcnt lgkmcnt(8)
  v_add_f32 v26, v26, v28
  s_waitcnt lgkmcnt(7)
  v_add_f32 v27, v27, v29
  v_mfma_f32_32x32x16_bf16 v[48:63], a[184:187], v[152:155], v[48:63]
  ds_read_b64_tr_b16 a[146:147], v216 offset:33280
  ds_read_b128 v[168:171], v222 offset:8192
  ds_read_b64_tr_b16 a[148:149], v217 offset:32768
  ds_swizzle_b32 v28, v26 offset:16415
  ds_swizzle_b32 v29, v27 offset:16415
  v_mfma_f32_32x32x16_bf16 v[64:79], a[184:187], v[156:159], v[64:79]
  ds_read_b64_tr_b16 a[150:151], v217 offset:33280
  ds_read_b128 v[172:175], v222 offset:12288
  ds_read_b64_tr_b16 a[152:153], v218 offset:32768
  v_mfma_f32_32x32x16_bf16 v[80:95], a[188:191], v[152:155], v[80:95]
  ds_read_b128 v[176:179], v223 offset:8192
  ds_read_b64_tr_b16 a[154:155], v218 offset:33280
  ds_read_b64_tr_b16 a[156:157], v219 offset:32768
  ds_read_b128 v[180:183], v223 offset:12288
  v_mfma_f32_32x32x16_bf16 v[96:111], a[188:191], v[156:159], v[96:111]
  ds_read_b64_tr_b16 a[158:159], v219 offset:33280
  ds_read_b128 v[184:187], v224 offset:8192
  s_waitcnt lgkmcnt(10)
  v_add_f32 v26, v26, v28
  s_waitcnt lgkmcnt(9)
  v_add_f32 v27, v27, v29
  v_mfma_f32_32x32x16_bf16 a[240:255], a[192:195], v[152:155], a[240:255]
  ds_read_b64_tr_b16 a[160:161], v220 offset:32768
  buffer_store_dwordx2 v[26:27], v42, s[32:35], 0 offen sc1
  v_mfma_f32_16x16x32_bf16 v[204:207], a[200:203], a[164:167], v[204:207]
  ds_read_b128 v[188:191], v224 offset:12288
  v_mfma_f32_16x16x32_bf16 v[208:211], a[200:203], a[196:199], v[208:211]
  ds_read_b64_tr_b16 a[162:163], v220 offset:33280
  v_mfma_f32_32x32x16_bf16 a[0:15], a[128:131], v[160:163], a[0:15]
  ds_read_b64_tr_b16 a[164:165], v212 offset:36864
  ds_read_b64_tr_b16 a[166:167], v212 offset:37888
  v_mfma_f32_32x32x16_bf16 a[16:31], a[128:131], v[164:167], a[16:31]
  s_waitcnt lgkmcnt(3)
  ds_read_b64_tr_b16 a[168:169], v213 offset:36864
  ds_read_b64_tr_b16 a[170:171], v213 offset:37888
  v_mfma_f32_32x32x16_bf16 a[32:47], a[132:135], v[160:163], a[32:47]
  ds_read_b64_tr_b16 a[172:173], v214 offset:36864
  v_mfma_f32_32x32x16_bf16 a[48:63], a[132:135], v[164:167], a[48:63]
  s_add_u32 m0, s79, 8192
  s_add_u32 s76, s72, 896
  buffer_load_dwordx4 v225, s[8:11], s76 offen lds
  v_mfma_f32_32x32x16_bf16 a[64:79], a[136:139], v[160:163], a[64:79]
  v_mfma_f32_32x32x16_bf16 a[80:95], a[136:139], v[164:167], a[80:95]
  ds_read_b64_tr_b16 a[174:175], v214 offset:37888
  ds_read_b64_tr_b16 a[176:177], v215 offset:36864
  v_mfma_f32_32x32x16_bf16 a[96:111], a[140:143], v[160:163], a[96:111]
  ds_read_b64_tr_b16 a[178:179], v215 offset:37888
  ds_read_b64_tr_b16 a[180:181], v216 offset:34816
  v_mfma_f32_32x32x16_bf16 a[112:127], a[140:143], v[164:167], a[112:127]
  buffer_load_dwordx4 v226, s[8:11], s76 offen offset:1024 lds
  v_mfma_f32_32x32x16_bf16 a[208:223], a[144:147], v[160:163], a[208:223]
  ds_read_b64_tr_b16 a[182:183], v216 offset:35328
  v_mfma_f32_32x32x16_bf16 a[224:239], a[144:147], v[164:167], a[224:239]
  ds_read_b64_tr_b16 a[184:185], v217 offset:34816
  ds_read_b64_tr_b16 a[186:187], v217 offset:35328
  ds_read_b64_tr_b16 a[188:189], v218 offset:34816
  v_mfma_f32_32x32x16_bf16 v[48:63], a[148:151], v[160:163], v[48:63]
  v_mfma_f32_32x32x16_bf16 v[64:79], a[148:151], v[164:167], v[64:79]
  buffer_load_dwordx4 v227, s[8:11], s76 offen offset:2048 lds
  v_mfma_f32_32x32x16_bf16 v[80:95], a[152:155], v[160:163], v[80:95]
  ds_read_b64_tr_b16 a[190:191], v218 offset:35328
  ds_read_b64_tr_b16 a[192:193], v219 offset:34816
  ds_read_b64_tr_b16 a[194:195], v219 offset:35328
  v_mfma_f32_32x32x16_bf16 v[96:111], a[152:155], v[164:167], v[96:111]
  buffer_load_dwordx4 v228, s[8:11], s76 offen offset:3072 lds
  v_mfma_f32_32x32x16_bf16 a[240:255], a[156:159], v[160:163], a[240:255]
  v_mfma_f32_16x16x32_bf16 v[204:207], a[200:203], a[128:131], v[204:207]
  ds_read_b64_tr_b16 a[196:197], v220 offset:34816
  s_waitcnt lgkmcnt(12)
  v_mfma_f32_16x16x32_bf16 v[208:211], a[200:203], a[160:163], v[208:211]
  ds_read_b64_tr_b16 a[198:199], v220 offset:35328
  v_mfma_f32_32x32x16_bf16 a[0:15], a[164:167], v[168:171], a[0:15]
  ds_read_b64_tr_b16 a[128:129], v212 offset:40960
  ds_read_b64_tr_b16 a[130:131], v212 offset:41984
  v_mfma_f32_32x32x16_bf16 a[16:31], a[164:167], v[172:175], a[16:31]
  ds_read_b64_tr_b16 a[132:133], v213 offset:40960
  ds_read_b64_tr_b16 a[134:135], v213 offset:41984
  v_mfma_f32_32x32x16_bf16 a[32:47], a[168:171], v[168:171], a[32:47]
  ds_read_b64_tr_b16 a[136:137], v214 offset:40960
  v_mfma_f32_32x32x16_bf16 a[48:63], a[168:171], v[172:175], a[48:63]
  s_add_u32 m0, s79, 12288
  s_add_u32 s76, s73, 896
  buffer_load_dwordx4 v225, s[8:11], s76 offen lds
  s_waitcnt lgkmcnt(10)
  v_mfma_f32_32x32x16_bf16 a[64:79], a[172:175], v[168:171], a[64:79]
  v_mfma_f32_32x32x16_bf16 a[80:95], a[172:175], v[172:175], a[80:95]
  ds_read_b64_tr_b16 a[138:139], v214 offset:41984
  ds_read_b64_tr_b16 a[140:141], v215 offset:40960
  v_mfma_f32_32x32x16_bf16 a[96:111], a[176:179], v[168:171], a[96:111]
  ds_read_b64_tr_b16 a[142:143], v215 offset:41984
  ds_read_b64_tr_b16 a[144:145], v216 offset:36864
  v_mfma_f32_32x32x16_bf16 a[112:127], a[176:179], v[172:175], a[112:127]
  buffer_load_dwordx4 v226, s[8:11], s76 offen offset:1024 lds
  v_mfma_f32_32x32x16_bf16 a[208:223], a[180:183], v[168:171], a[208:223]
  ds_read_b64_tr_b16 a[146:147], v216 offset:37376
  v_mfma_f32_32x32x16_bf16 a[224:239], a[180:183], v[172:175], a[224:239]
  ds_read_b64_tr_b16 a[148:149], v217 offset:36864
  ds_read_b64_tr_b16 a[150:151], v217 offset:37376
  ds_read_b64_tr_b16 a[152:153], v218 offset:36864
  v_mfma_f32_32x32x16_bf16 v[48:63], a[184:187], v[168:171], v[48:63]
  v_mfma_f32_32x32x16_bf16 v[64:79], a[184:187], v[172:175], v[64:79]
  buffer_load_dwordx4 v227, s[8:11], s76 offen offset:2048 lds
  s_waitcnt lgkmcnt(11)
  v_mfma_f32_32x32x16_bf16 v[80:95], a[188:191], v[168:171], v[80:95]
  ds_read_b64_tr_b16 a[154:155], v218 offset:37376
  ds_read_b64_tr_b16 a[156:157], v219 offset:36864
  ds_read_b64_tr_b16 a[158:159], v219 offset:37376
  v_mfma_f32_32x32x16_bf16 v[96:111], a[188:191], v[172:175], v[96:111]
  buffer_load_dwordx4 v228, s[8:11], s76 offen offset:3072 lds
  v_mfma_f32_32x32x16_bf16 a[240:255], a[192:195], v[168:171], a[240:255]
  v_mfma_f32_16x16x32_bf16 v[204:207], a[200:203], a[164:167], v[204:207]
  ds_read_b64_tr_b16 a[160:161], v220 offset:36864
  v_mfma_f32_16x16x32_bf16 v[208:211], a[200:203], a[196:199], v[208:211]
  ds_read_b64_tr_b16 a[162:163], v220 offset:37376
  v_mfma_f32_32x32x16_bf16 a[0:15], a[128:131], v[176:179], a[0:15]
  ds_read_b64_tr_b16 a[164:165], v212 offset:45056
  ds_read_b64_tr_b16 a[166:167], v212 offset:46080
  v_mfma_f32_32x32x16_bf16 a[16:31], a[128:131], v[180:183], a[16:31]
  ds_read_b64_tr_b16 a[168:169], v213 offset:45056
  s_waitcnt lgkmcnt(12)
  v_mfma_f32_32x32x16_bf16 a[32:47], a[132:135], v[176:179], a[32:47]
  s_add_u32 m0, s78, 16384
  s_mov_b32 s75, 1548288
  buffer_load_dwordx4 v233, s[16:19], s75 offen lds
  v_mfma_f32_32x32x16_bf16 a[48:63], a[132:135], v[180:183], a[48:63]
  v_mfma_f32_32x32x16_bf16 a[64:79], a[136:139], v[176:179], a[64:79]
  ds_read_b64_tr_b16 a[170:171], v213 offset:46080
  ds_read_b64_tr_b16 a[172:173], v214 offset:45056
  ds_read_b64_tr_b16 a[174:175], v214 offset:46080
  v_mfma_f32_32x32x16_bf16 a[80:95], a[136:139], v[180:183], a[80:95]
  ds_read_b64_tr_b16 a[176:177], v215 offset:45056
  ds_read_b64_tr_b16 a[178:179], v215 offset:46080
  v_mfma_f32_32x32x16_bf16 a[96:111], a[140:143], v[176:179], a[96:111]
  ds_read_b64_tr_b16 a[180:181], v216 offset:38912
  v_mfma_f32_32x32x16_bf16 a[112:127], a[140:143], v[180:183], a[112:127]
  buffer_load_dwordx4 v234, s[16:19], s75 offen offset:1024 lds
  s_waitcnt lgkmcnt(11)
  v_mfma_f32_32x32x16_bf16 a[208:223], a[144:147], v[176:179], a[208:223]
  ds_read_b64_tr_b16 a[182:183], v216 offset:39424
  ds_read_b64_tr_b16 a[184:185], v217 offset:38912
  v_mfma_f32_32x32x16_bf16 a[224:239], a[144:147], v[180:183], a[224:239]
  ds_read_b64_tr_b16 a[186:187], v217 offset:39424
  ds_read_b64_tr_b16 a[188:189], v218 offset:38912
  ds_read_b64_tr_b16 a[190:191], v218 offset:39424
  v_mfma_f32_32x32x16_bf16 v[48:63], a[148:151], v[176:179], v[48:63]
  ds_read_b64_tr_b16 a[192:193], v219 offset:38912
  v_mfma_f32_32x32x16_bf16 v[64:79], a[148:151], v[180:183], v[64:79]
  s_add_u32 m0, s78, 24576
  s_nop 0
  buffer_load_dwordx4 v235, s[20:23], s75 offen lds
  v_mfma_f32_32x32x16_bf16 v[80:95], a[152:155], v[176:179], v[80:95]
  ds_read_b64_tr_b16 a[194:195], v219 offset:39424
  v_mfma_f32_32x32x16_bf16 v[96:111], a[152:155], v[180:183], v[96:111]
  ds_read_b64_tr_b16 a[196:197], v220 offset:38912
  ds_read_b64_tr_b16 a[198:199], v220 offset:39424
  v_mfma_f32_32x32x16_bf16 a[240:255], a[156:159], v[176:179], a[240:255]
  buffer_load_dwordx4 v236, s[20:23], s75 offen offset:1024 lds
  v_mfma_f32_16x16x32_bf16 v[204:207], a[200:203], a[128:131], v[204:207]
  s_waitcnt lgkmcnt(11)
  v_mfma_f32_16x16x32_bf16 v[208:211], a[200:203], a[160:163], v[208:211]
  v_mfma_f32_32x32x16_bf16 a[0:15], a[164:167], v[184:187], a[0:15]
  s_waitcnt vmcnt(12)
  s_waitcnt lgkmcnt(0)
  s_barrier
  v_mfma_f32_32x32x16_bf16 a[16:31], a[164:167], v[188:191], a[16:31]
  ds_read_b64_tr_b16 a[128:129], v212 offset:0
  v_mfma_f32_32x32x16_bf16 a[32:47], a[168:171], v[184:187], a[32:47]
  s_add_u32 m0, s77, 32768
  s_mov_b32 s74, 4194304
  buffer_load_dwordx4 v229, s[12:15], s74 offen lds
  v_mfma_f32_32x32x16_bf16 a[48:63], a[168:171], v[188:191], a[48:63]
  ds_read_b64_tr_b16 a[130:131], v212 offset:1024
  v_mfma_f32_32x32x16_bf16 a[64:79], a[172:175], v[184:187], a[64:79]
  buffer_load_dwordx4 v230, s[12:15], s74 offen offset:1024 lds
  v_mfma_f32_32x32x16_bf16 a[80:95], a[172:175], v[188:191], a[80:95]
  ds_read_b64_tr_b16 a[132:133], v213 offset:0
  buffer_load_dwordx4 v231, s[12:15], s74 offen offset:2048 lds
  v_mfma_f32_32x32x16_bf16 a[96:111], a[176:179], v[184:187], a[96:111]
  ds_read_b64_tr_b16 a[134:135], v213 offset:1024
  v_mfma_f32_32x32x16_bf16 a[112:127], a[176:179], v[188:191], a[112:127]
  ds_read_b64_tr_b16 a[136:137], v214 offset:0
  buffer_load_dwordx4 v232, s[12:15], s74 offen offset:3072 lds
  v_mfma_f32_32x32x16_bf16 a[208:223], a[180:183], v[184:187], a[208:223]
  ds_read_b64_tr_b16 a[138:139], v214 offset:1024
  v_mfma_f32_32x32x16_bf16 a[224:239], a[180:183], v[188:191], a[224:239]
  ds_read_b64_tr_b16 a[140:141], v215 offset:0
  ds_read_b64_tr_b16 a[142:143], v215 offset:1024
  ds_read_b128 v[128:131], v221 offset:0
  v_mfma_f32_32x32x16_bf16 v[48:63], a[184:187], v[184:187], v[48:63]
  ds_read_b64_tr_b16 a[144:145], v216 offset:0
  ds_read_b128 v[132:135], v221 offset:4096
  ds_read_b64_tr_b16 a[146:147], v216 offset:512
  v_mfma_f32_32x32x16_bf16 v[64:79], a[184:187], v[188:191], v[64:79]
  ds_read_b128 v[136:139], v222 offset:0
  ds_read_b64_tr_b16 a[148:149], v217 offset:0
  ds_read_b64_tr_b16 a[150:151], v217 offset:512
  v_mfma_f32_32x32x16_bf16 v[80:95], a[188:191], v[184:187], v[80:95]
  ds_read_b128 v[140:143], v222 offset:4096
  ds_read_b64_tr_b16 a[152:153], v218 offset:0
  ds_read_b128 v[144:147], v223 offset:0
  v_mfma_f32_32x32x16_bf16 v[96:111], a[188:191], v[188:191], v[96:111]
  ds_read_b64_tr_b16 a[154:155], v218 offset:512
  ds_read_b64_tr_b16 a[156:157], v219 offset:0
  ds_read_b128 v[148:151], v223 offset:4096
  v_mfma_f32_32x32x16_bf16 a[240:255], a[192:195], v[184:187], a[240:255]
  ds_read_b64_tr_b16 a[158:159], v219 offset:512
  ds_read_b128 v[152:155], v224 offset:0
  ds_read_b64_tr_b16 a[160:161], v220 offset:0
  v_mfma_f32_16x16x32_bf16 v[204:207], a[200:203], a[164:167], v[204:207]
  ds_read_b128 v[156:159], v224 offset:4096
  v_mfma_f32_16x16x32_bf16 v[208:211], a[200:203], a[196:199], v[208:211]
  ds_read_b64_tr_b16 a[162:163], v220 offset:512
  s_waitcnt lgkmcnt(15)
  v_mfma_f32_32x32x16_bf16 a[0:15], a[128:131], v[128:131], a[0:15]
  ds_read_b64_tr_b16 a[164:165], v212 offset:4096
  ds_read_b64_tr_b16 a[166:167], v212 offset:5120
  s_waitcnt lgkmcnt(3)
  v_mfma_f32_32x32x16_bf16 a[16:31], a[128:131], v[132:135], a[16:31]
  ds_read_b64_tr_b16 a[168:169], v213 offset:4096
  ds_read_b64_tr_b16 a[170:171], v213 offset:5120
  v_mfma_f32_32x32x16_bf16 a[32:47], a[132:135], v[128:131], a[32:47]
  ds_read_b64_tr_b16 a[172:173], v214 offset:4096
  v_mfma_f32_32x32x16_bf16 a[48:63], a[132:135], v[132:135], a[48:63]
  s_add_u32 m0, s79, 0
  s_add_u32 s76, s72, 1024
  buffer_load_dwordx4 v225, s[8:11], s76 offen lds
  v_mfma_f32_32x32x16_bf16 a[64:79], a[136:139], v[128:131], a[64:79]
  ds_read_b64_tr_b16 a[174:175], v214 offset:5120
  v_mfma_f32_32x32x16_bf16 a[80:95], a[136:139], v[132:135], a[80:95]
  ds_read_b64_tr_b16 a[176:177], v215 offset:4096
  ds_read_b64_tr_b16 a[178:179], v215 offset:5120
  ds_read_b64_tr_b16 a[180:181], v216 offset:2048
  v_mfma_f32_32x32x16_bf16 a[96:111], a[140:143], v[128:131], a[96:111]
  buffer_atomic_add v44, v43, s[60:63], s86 offen offset:16 sc1
  v_mfma_f32_32x32x16_bf16 a[112:127], a[140:143], v[132:135], a[112:127]
  v_mfma_f32_32x32x16_bf16 a[208:223], a[144:147], v[128:131], a[208:223]
  buffer_load_dwordx4 v226, s[8:11], s76 offen offset:1024 lds
  v_mfma_f32_32x32x16_bf16 a[224:239], a[144:147], v[132:135], a[224:239]
  ds_read_b64_tr_b16 a[182:183], v216 offset:2560
  ds_read_b64_tr_b16 a[184:185], v217 offset:2048
  v_mfma_f32_32x32x16_bf16 v[48:63], a[148:151], v[128:131], v[48:63]
  ds_read_b64_tr_b16 a[186:187], v217 offset:2560
  ds_read_b64_tr_b16 a[188:189], v218 offset:2048
  v_mfma_f32_32x32x16_bf16 v[64:79], a[148:151], v[132:135], v[64:79]
  buffer_load_dwordx4 v227, s[8:11], s76 offen offset:2048 lds
  v_mfma_f32_32x32x16_bf16 v[80:95], a[152:155], v[128:131], v[80:95]
  ds_read_b64_tr_b16 a[190:191], v218 offset:2560
  ds_read_b64_tr_b16 a[192:193], v219 offset:2048
  v_mfma_f32_32x32x16_bf16 v[96:111], a[152:155], v[132:135], v[96:111]
  ds_read_b64_tr_b16 a[194:195], v219 offset:2560
  v_mfma_f32_32x32x16_bf16 a[240:255], a[156:159], v[128:131], a[240:255]
  buffer_load_dwordx4 v228, s[8:11], s76 offen offset:3072 lds
  v_mfma_f32_16x16x32_bf16 v[204:207], a[200:203], a[128:131], v[204:207]
  ds_read_b64_tr_b16 a[196:197], v220 offset:2048
  s_waitcnt lgkmcnt(12)
  v_mfma_f32_16x16x32_bf16 v[208:211], a[200:203], a[160:163], v[208:211]
  ds_read_b64_tr_b16 a[198:199], v220 offset:2560
  v_mfma_f32_32x32x16_bf16 a[0:15], a[164:167], v[136:139], a[0:15]
  ds_read_b64_tr_b16 a[128:129], v212 offset:8192
  ds_read_b64_tr_b16 a[130:131], v212 offset:9216
  v_mfma_f32_32x32x16_bf16 a[16:31], a[164:167], v[140:143], a[16:31]
  ds_read_b64_tr_b16 a[132:133], v213 offset:8192
  ds_read_b64_tr_b16 a[134:135], v213 offset:9216
  v_mfma_f32_32x32x16_bf16 a[32:47], a[168:171], v[136:139], a[32:47]
  ds_read_b64_tr_b16 a[136:137], v214 offset:8192
  v_mfma_f32_32x32x16_bf16 a[48:63], a[168:171], v[140:143], a[48:63]
  s_add_u32 m0, s79, 4096
  s_add_u32 s76, s73, 1024
  buffer_load_dwordx4 v225, s[8:11], s76 offen lds
  s_waitcnt lgkmcnt(11)
  v_mfma_f32_32x32x16_bf16 a[64:79], a[172:175], v[136:139], a[64:79]
  v_mfma_f32_32x32x16_bf16 a[80:95], a[172:175], v[140:143], a[80:95]
  ds_read_b64_tr_b16 a[138:139], v214 offset:9216
  ds_read_b64_tr_b16 a[140:141], v215 offset:8192
  v_mfma_f32_32x32x16_bf16 a[96:111], a[176:179], v[136:139], a[96:111]
  ds_read_b64_tr_b16 a[142:143], v215 offset:9216
  ds_read_b64_tr_b16 a[144:145], v216 offset:4096
  v_mfma_f32_32x32x16_bf16 a[112:127], a[176:179], v[140:143], a[112:127]
  buffer_load_dwordx4 v226, s[8:11], s76 offen offset:1024 lds
  v_mfma_f32_32x32x16_bf16 a[208:223], a[180:183], v[136:139], a[208:223]
  ds_read_b64_tr_b16 a[146:147], v216 offset:4608
  v_mfma_f32_32x32x16_bf16 a[224:239], a[180:183], v[140:143], a[224:239]
  ds_read_b64_tr_b16 a[148:149], v217 offset:4096
  ds_read_b64_tr_b16 a[150:151], v217 offset:4608
  ds_read_b64_tr_b16 a[152:153], v218 offset:4096
  v_mfma_f32_32x32x16_bf16 v[48:63], a[184:187], v[136:139], v[48:63]
  v_mfma_f32_32x32x16_bf16 v[64:79], a[184:187], v[140:143], v[64:79]
  buffer_load_dwordx4 v227, s[8:11], s76 offen offset:2048 lds
  s_waitcnt lgkmcnt(11)
  v_mfma_f32_32x32x16_bf16 v[80:95], a[188:191], v[136:139], v[80:95]
  ds_read_b64_tr_b16 a[154:155], v218 offset:4608
  ds_read_b64_tr_b16 a[156:157], v219 offset:4096
  ds_read_b64_tr_b16 a[158:159], v219 offset:4608
  v_mfma_f32_32x32x16_bf16 v[96:111], a[188:191], v[140:143], v[96:111]
  buffer_load_dwordx4 v228, s[8:11], s76 offen offset:3072 lds
  v_mfma_f32_32x32x16_bf16 a[240:255], a[192:195], v[136:139], a[240:255]
  v_mfma_f32_16x16x32_bf16 v[204:207], a[200:203], a[164:167], v[204:207]
  ds_read_b64_tr_b16 a[160:161], v220 offset:4096
  v_mfma_f32_16x16x32_bf16 v[208:211], a[200:203], a[196:199], v[208:211]
  ds_read_b64_tr_b16 a[162:163], v220 offset:4608
  v_mfma_f32_32x32x16_bf16 a[0:15], a[128:131], v[144:147], a[0:15]
  ds_read_b64_tr_b16 a[164:165], v212 offset:12288
  ds_read_b64_tr_b16 a[166:167], v212 offset:13312
  v_mfma_f32_32x32x16_bf16 a[16:31], a[128:131], v[148:151], a[16:31]
  ds_read_b64_tr_b16 a[168:169], v213 offset:12288
  s_waitcnt lgkmcnt(12)
  v_mfma_f32_32x32x16_bf16 a[32:47], a[132:135], v[144:147], a[32:47]
  s_add_u32 m0, s78, 32768
  s_mov_b32 s75, 1769472
  buffer_load_dwordx4 v233, s[16:19], s75 offen lds
  v_mfma_f32_32x32x16_bf16 a[48:63], a[132:135], v[148:151], a[48:63]
  v_mfma_f32_32x32x16_bf16 a[64:79], a[136:139], v[144:147], a[64:79]
  ds_read_b64_tr_b16 a[170:171], v213 offset:13312
  ds_read_b64_tr_b16 a[172:173], v214 offset:12288
  ds_read_b64_tr_b16 a[174:175], v214 offset:13312
  v_mfma_f32_32x32x16_bf16 a[80:95], a[136:139], v[148:151], a[80:95]
  ds_read_b64_tr_b16 a[176:177], v215 offset:12288
  ds_read_b64_tr_b16 a[178:179], v215 offset:13312
  v_mfma_f32_32x32x16_bf16 a[96:111], a[140:143], v[144:147], a[96:111]
  ds_read_b64_tr_b16 a[180:181], v216 offset:6144
  v_mfma_f32_32x32x16_bf16 a[112:127], a[140:143], v[148:151], a[112:127]
  buffer_load_dwordx4 v234, s[16:19], s75 offen offset:1024 lds
  s_waitcnt lgkmcnt(11)
  v_mfma_f32_32x32x16_bf16 a[208:223], a[144:147], v[144:147], a[208:223]
  ds_read_b64_tr_b16 a[182:183], v216 offset:6656
  ds_read_b64_tr_b16 a[184:185], v217 offset:6144
  v_mfma_f32_32x32x16_bf16 a[224:239], a[144:147], v[148:151], a[224:239]
  ds_read_b64_tr_b16 a[186:187], v217 offset:6656
  ds_read_b64_tr_b16 a[188:189], v218 offset:6144
  ds_read_b64_tr_b16 a[190:191], v218 offset:6656
  v_mfma_f32_32x32x16_bf16 v[48:63], a[148:151], v[144:147], v[48:63]
  ds_read_b64_tr_b16 a[192:193], v219 offset:6144
  v_mfma_f32_32x32x16_bf16 v[64:79], a[148:151], v[148:151], v[64:79]
  s_add_u32 m0, s78, 40960
  s_nop 0
  buffer_load_dwordx4 v235, s[20:23], s75 offen lds
  v_mfma_f32_32x32x16_bf16 v[80:95], a[152:155], v[144:147], v[80:95]
  ds_read_b64_tr_b16 a[194:195], v219 offset:6656
  v_mfma_f32_32x32x16_bf16 v[96:111], a[152:155], v[148:151], v[96:111]
  ds_read_b64_tr_b16 a[196:197], v220 offset:6144
  ds_read_b64_tr_b16 a[198:199], v220 offset:6656
  v_mfma_f32_32x32x16_bf16 a[240:255], a[156:159], v[144:147], a[240:255]
  buffer_load_dwordx4 v236, s[20:23], s75 offen offset:1024 lds
  v_mfma_f32_16x16x32_bf16 v[204:207], a[200:203], a[128:131], v[204:207]
  s_waitcnt lgkmcnt(11)
  v_mfma_f32_16x16x32_bf16 v[208:211], a[200:203], a[160:163], v[208:211]
  v_mfma_f32_32x32x16_bf16 a[0:15], a[164:167], v[152:155], a[0:15]
  s_waitcnt vmcnt(17) lgkmcnt(0)
  s_barrier
  v_mfma_f32_32x32x16_bf16 a[16:31], a[164:167], v[156:159], a[16:31]
  ds_read_b64_tr_b16 a[128:129], v212 offset:16384
  v_mfma_f32_32x32x16_bf16 a[32:47], a[168:171], v[152:155], a[32:47]
  s_add_u32 m0, s77, 0
  s_mov_b32 s74, 4718592
  buffer_load_dwordx4 v229, s[12:15], s74 offen lds
  v_mfma_f32_32x32x16_bf16 a[48:63], a[168:171], v[156:159], a[48:63]
  ds_read_b64_tr_b16 a[130:131], v212 offset:17408
  v_mfma_f32_32x32x16_bf16 a[64:79], a[172:175], v[152:155], a[64:79]
  buffer_load_dwordx4 v230, s[12:15], s74 offen offset:1024 lds
  v_mfma_f32_32x32x16_bf16 a[80:95], a[172:175], v[156:159], a[80:95]
  ds_read_b64_tr_b16 a[132:133], v213 offset:16384
  buffer_load_dwordx4 v231, s[12:15], s74 offen offset:2048 lds
  v_mfma_f32_32x32x16_bf16 a[96:111], a[176:179], v[152:155], a[96:111]
  ds_read_b64_tr_b16 a[134:135], v213 offset:17408
  v_mfma_f32_32x32x16_bf16 a[112:127], a[176:179], v[156:159], a[112:127]
  ds_read_b64_tr_b16 a[136:137], v214 offset:16384
  buffer_load_dwordx4 v232, s[12:15], s74 offen offset:3072 lds
  v_mfma_f32_32x32x16_bf16 a[208:223], a[180:183], v[152:155], a[208:223]
  ds_read_b64_tr_b16 a[138:139], v214 offset:17408
  v_mfma_f32_32x32x16_bf16 a[224:239], a[180:183], v[156:159], a[224:239]
  ds_read_b64_tr_b16 a[140:141], v215 offset:16384
  ds_read_b64_tr_b16 a[142:143], v215 offset:17408
  ds_read_b128 v[160:163], v221 offset:8192
  v_mfma_f32_32x32x16_bf16 v[48:63], a[184:187], v[152:155], v[48:63]
  ds_read_b64_tr_b16 a[144:145], v216 offset:16384
  ds_read_b128 v[164:167], v221 offset:12288
  ds_read_b64_tr_b16 a[146:147], v216 offset:16896
  v_mfma_f32_32x32x16_bf16 v[64:79], a[184:187], v[156:159], v[64:79]
  ds_read_b128 v[168:171], v222 offset:8192
  ds_read_b64_tr_b16 a[148:149], v217 offset:16384
  ds_read_b64_tr_b16 a[150:151], v217 offset:16896
  v_mfma_f32_32x32x16_bf16 v[80:95], a[188:191], v[152:155], v[80:95]
  ds_read_b128 v[172:175], v222 offset:12288
  ds_read_b64_tr_b16 a[152:153], v218 offset:16384
  ds_read_b128 v[176:179], v223 offset:8192
  v_mfma_f32_32x32x16_bf16 v[96:111], a[188:191], v[156:159], v[96:111]
  ds_read_b64_tr_b16 a[154:155], v218 offset:16896
  ds_read_b64_tr_b16 a[156:157], v219 offset:16384
  ds_read_b128 v[180:183], v223 offset:12288
  v_mfma_f32_32x32x16_bf16 a[240:255], a[192:195], v[152:155], a[240:255]
  ds_read_b64_tr_b16 a[158:159], v219 offset:16896
  ds_read_b128 v[184:187], v224 offset:8192
  ds_read_b64_tr_b16 a[160:161], v220 offset:16384
  v_mfma_f32_16x16x32_bf16 v[204:207], a[200:203], a[164:167], v[204:207]
  ds_read_b128 v[188:191], v224 offset:12288
  v_mfma_f32_16x16x32_bf16 v[208:211], a[200:203], a[196:199], v[208:211]
  ds_read_b64_tr_b16 a[162:163], v220 offset:16896
  s_waitcnt lgkmcnt(15)
  v_mfma_f32_32x32x16_bf16 a[0:15], a[128:131], v[160:163], a[0:15]
  ds_read_b64_tr_b16 a[164:165], v212 offset:20480
  ds_read_b64_tr_b16 a[166:167], v212 offset:21504
  v_mfma_f32_32x32x16_bf16 a[16:31], a[128:131], v[164:167], a[16:31]
  s_waitcnt lgkmcnt(3)
  ds_read_b64_tr_b16 a[168:169], v213 offset:20480
  ds_read_b64_tr_b16 a[170:171], v213 offset:21504
  v_mfma_f32_32x32x16_bf16 a[32:47], a[132:135], v[160:163], a[32:47]
  ds_read_b64_tr_b16 a[172:173], v214 offset:20480
  v_mfma_f32_32x32x16_bf16 a[48:63], a[132:135], v[164:167], a[48:63]
  s_add_u32 m0, s79, 8192
  s_add_u32 s76, s72, 1152
  buffer_load_dwordx4 v225, s[8:11], s76 offen lds
  v_mfma_f32_32x32x16_bf16 a[64:79], a[136:139], v[160:163], a[64:79]
  v_mfma_f32_32x32x16_bf16 a[80:95], a[136:139], v[164:167], a[80:95]
  ds_read_b64_tr_b16 a[174:175], v214 offset:21504
  ds_read_b64_tr_b16 a[176:177], v215 offset:20480
  v_mfma_f32_32x32x16_bf16 a[96:111], a[140:143], v[160:163], a[96:111]
  ds_read_b64_tr_b16 a[178:179], v215 offset:21504
  ds_read_b64_tr_b16 a[180:181], v216 offset:18432
  v_mfma_f32_32x32x16_bf16 a[112:127], a[140:143], v[164:167], a[112:127]
  buffer_load_dwordx4 v226, s[8:11], s76 offen offset:1024 lds
  v_mfma_f32_32x32x16_bf16 a[208:223], a[144:147], v[160:163], a[208:223]
  ds_read_b64_tr_b16 a[182:183], v216 offset:18944
  v_mfma_f32_32x32x16_bf16 a[224:239], a[144:147], v[164:167], a[224:239]
  ds_read_b64_tr_b16 a[184:185], v217 offset:18432
  ds_read_b64_tr_b16 a[186:187], v217 offset:18944
  ds_read_b64_tr_b16 a[188:189], v218 offset:18432
  v_mfma_f32_32x32x16_bf16 v[48:63], a[148:151], v[160:163], v[48:63]
  v_mfma_f32_32x32x16_bf16 v[64:79], a[148:151], v[164:167], v[64:79]
  buffer_load_dwordx4 v227, s[8:11], s76 offen offset:2048 lds
  v_mfma_f32_32x32x16_bf16 v[80:95], a[152:155], v[160:163], v[80:95]
  ds_read_b64_tr_b16 a[190:191], v218 offset:18944
  ds_read_b64_tr_b16 a[192:193], v219 offset:18432
  ds_read_b64_tr_b16 a[194:195], v219 offset:18944
  v_mfma_f32_32x32x16_bf16 v[96:111], a[152:155], v[164:167], v[96:111]
  buffer_load_dwordx4 v228, s[8:11], s76 offen offset:3072 lds
  v_mfma_f32_32x32x16_bf16 a[240:255], a[156:159], v[160:163], a[240:255]
  v_mfma_f32_16x16x32_bf16 v[204:207], a[200:203], a[128:131], v[204:207]
  ds_read_b64_tr_b16 a[196:197], v220 offset:18432
  s_waitcnt lgkmcnt(12)
  v_mfma_f32_16x16x32_bf16 v[208:211], a[200:203], a[160:163], v[208:211]
  ds_read_b64_tr_b16 a[198:199], v220 offset:18944
  v_mfma_f32_32x32x16_bf16 a[0:15], a[164:167], v[168:171], a[0:15]
  ds_read_b64_tr_b16 a[128:129], v212 offset:24576
  v_mfma_f32_32x32x16_bf16 a[16:31], a[164:167], v[172:175], a[16:31]
  s_add_u32 m0, s79, 12288
  s_add_u32 s76, s73, 1152
  buffer_load_dwordx4 v225, s[8:11], s76 offen lds
  v_mfma_f32_32x32x16_bf16 a[32:47], a[168:171], v[168:171], a[32:47]
  ds_read_b64_tr_b16 a[130:131], v212 offset:25600
  v_mfma_f32_32x32x16_bf16 a[48:63], a[168:171], v[172:175], a[48:63]
  buffer_load_dwordx4 v226, s[8:11], s76 offen offset:1024 lds
  ds_read_b64_tr_b16 a[132:133], v213 offset:24576
  s_waitcnt lgkmcnt(9)
  v_mfma_f32_32x32x16_bf16 a[64:79], a[172:175], v[168:171], a[64:79]
  buffer_load_dwordx4 v227, s[8:11], s76 offen offset:2048 lds
  v_mfma_f32_32x32x16_bf16 a[80:95], a[172:175], v[172:175], a[80:95]
  buffer_load_dwordx4 v228, s[8:11], s76 offen offset:3072 lds
  v_mfma_f32_32x32x16_bf16 a[96:111], a[176:179], v[168:171], a[96:111]
  ds_read_b64_tr_b16 a[134:135], v213 offset:25600
  ds_read_b64_tr_b16 a[136:137], v214 offset:24576
  v_lshrrev_b32 v1, 5, v6
  v_mfma_f32_32x32x16_bf16 a[112:127], a[176:179], v[172:175], a[112:127]
  ds_read_b64_tr_b16 a[138:139], v214 offset:25600
  v_and_b32 v13, 31, v6
  v_lshlrev_b32 v15, 8, v13
  v_and_b32 v14, 15, v6
  v_mfma_f32_32x32x16_bf16 a[208:223], a[180:183], v[168:171], a[208:223]
  ds_read_b64_tr_b16 a[140:141], v215 offset:24576
  ds_read_b64_tr_b16 a[142:143], v215 offset:25600
  s_lshl_b32 s83, s3, 1
  v_xor_b32 v14, v14, v1
  v_mfma_f32_32x32x16_bf16 a[224:239], a[180:183], v[172:175], a[224:239]
  s_add_u32 s83, s83, 0
  ds_read_b64_tr_b16 a[144:145], v216 offset:20480
  s_and_b32 s83, s83, 7
  v_mfma_f32_32x32x16_bf16 v[48:63], a[184:187], v[168:171], v[48:63]
  ds_read_b64_tr_b16 a[146:147], v216 offset:20992
  s_lshl_b32 s83, s83, 1
  ds_read_b64_tr_b16 a[148:149], v217 offset:20480
  v_xor_b32 v10, s83, v14
  v_mfma_f32_32x32x16_bf16 v[64:79], a[184:187], v[172:175], v[64:79]
  ds_read_b64_tr_b16 a[150:151], v217 offset:20992
  s_lshl_b32 s83, s3, 1
  ds_read_b64_tr_b16 a[152:153], v218 offset:20480
  v_lshl_add_u32 v242, v10, 4, v15
  s_waitcnt lgkmcnt(10)
  v_mfma_f32_32x32x16_bf16 v[80:95], a[188:191], v[168:171], v[80:95]
  s_add_u32 s83, s83, 1
  s_and_b32 s83, s83, 7
  ds_read_b64_tr_b16 a[154:155], v218 offset:20992
  v_mfma_f32_32x32x16_bf16 v[96:111], a[188:191], v[172:175], v[96:111]
  s_lshl_b32 s83, s83, 1
  ds_read_b64_tr_b16 a[156:157], v219 offset:20480
  v_xor_b32 v10, s83, v14
  v_lshl_add_u32 v243, v10, 4, v15
  v_mfma_f32_32x32x16_bf16 a[240:255], a[192:195], v[168:171], a[240:255]
  ds_read_b64_tr_b16 a[158:159], v219 offset:20992
  s_lshl_b32 s83, s3, 1
  ds_read_b64_tr_b16 a[160:161], v220 offset:20480
  s_add_u32 s83, s83, 2
  v_mfma_f32_16x16x32_bf16 v[204:207], a[200:203], a[164:167], v[204:207]
  ds_read_b64_tr_b16 a[162:163], v220 offset:20992
  v_mfma_f32_16x16x32_bf16 v[208:211], a[200:203], a[196:199], v[208:211]
  s_and_b32 s83, s83, 7
  v_mfma_f32_32x32x16_bf16 a[0:15], a[128:131], v[176:179], a[0:15]
  s_add_u32 m0, s78, 0
  s_mov_b32 s75, 1990656
  buffer_load_dwordx4 v233, s[16:19], s75 offen lds
  v_mfma_f32_32x32x16_bf16 a[16:31], a[128:131], v[180:183], a[16:31]
  ds_read_b64_tr_b16 a[164:165], v212 offset:28672
  s_waitcnt lgkmcnt(7)
  v_mfma_f32_32x32x16_bf16 a[32:47], a[132:135], v[176:179], a[32:47]
  buffer_load_dwordx4 v234, s[16:19], s75 offen offset:1024 lds
  ds_read_b64_tr_b16 a[166:167], v212 offset:29696
  v_mfma_f32_32x32x16_bf16 a[48:63], a[132:135], v[180:183], a[48:63]
  s_add_u32 m0, s78, 8192
  s_nop 0
  buffer_load_dwordx4 v235, s[20:23], s75 offen lds
  v_mfma_f32_32x32x16_bf16 a[64:79], a[136:139], v[176:179], a[64:79]
  ds_read_b64_tr_b16 a[168:169], v213 offset:28672
  v_mfma_f32_32x32x16_bf16 a[80:95], a[136:139], v[180:183], a[80:95]
  buffer_load_dwordx4 v236, s[20:23], s75 offen offset:1024 lds
  ds_read_b64_tr_b16 a[170:171], v213 offset:29696
  s_lshl_b32 s83, s83, 1
  v_mfma_f32_32x32x16_bf16 a[96:111], a[140:143], v[176:179], a[96:111]
  ds_read_b64_tr_b16 a[172:173], v214 offset:28672
  ds_read_b64_tr_b16 a[174:175], v214 offset:29696
  v_xor_b32 v10, s83, v14
  v_lshl_add_u32 v244, v10, 4, v15
  v_mfma_f32_32x32x16_bf16 a[112:127], a[140:143], v[180:183], a[112:127]
  ds_read_b64_tr_b16 a[176:177], v215 offset:28672
  s_lshl_b32 s83, s3, 1
  ds_read_b64_tr_b16 a[178:179], v215 offset:29696
  s_add_u32 s83, s83, 3
  v_mfma_f32_32x32x16_bf16 a[208:223], a[144:147], v[176:179], a[208:223]
  ds_read_b64_tr_b16 a[180:181], v216 offset:22528
  s_and_b32 s83, s83, 7
  ds_read_b64_tr_b16 a[182:183], v216 offset:23040
  s_lshl_b32 s83, s83, 1
  v_mfma_f32_32x32x16_bf16 a[224:239], a[144:147], v[180:183], a[224:239]
  ds_read_b64_tr_b16 a[184:185], v217 offset:22528
  ds_read_b64_tr_b16 a[186:187], v217 offset:23040
  v_xor_b32 v10, s83, v14
  v_mfma_f32_32x32x16_bf16 v[48:63], a[148:151], v[176:179], v[48:63]
  buffer_load_dword v45, off, s[60:63], s86 offset:16 sc1
  v_lshl_add_u32 v245, v10, 4, v15
  v_mfma_f32_32x32x16_bf16 v[64:79], a[148:151], v[180:183], v[64:79]
  ds_read_b64_tr_b16 a[188:189], v218 offset:22528
  s_lshl_b32 s83, s3, 1
  ds_read_b64_tr_b16 a[190:191], v218 offset:23040
  s_waitcnt lgkmcnt(10)
  v_mfma_f32_32x32x16_bf16 v[80:95], a[152:155], v[176:179], v[80:95]
  s_add_u32 s83, s83, 4
  ds_read_b64_tr_b16 a[192:193], v219 offset:22528
  s_and_b32 s83, s83, 7
  ds_read_b64_tr_b16 a[194:195], v219 offset:23040
  v_mfma_f32_32x32x16_bf16 v[96:111], a[152:155], v[180:183], v[96:111]
  s_lshl_b32 s83, s83, 1
  ds_read_b64_tr_b16 a[196:197], v220 offset:22528
  ds_read_b64_tr_b16 a[198:199], v220 offset:23040
  v_xor_b32 v10, s83, v14
  v_mfma_f32_32x32x16_bf16 a[240:255], a[156:159], v[176:179], a[240:255]
  s_lshl_b32 s83, s3, 1
  s_add_u32 s83, s83, 5
  s_and_b32 s83, s83, 7
  v_lshl_add_u32 v246, v10, 4, v15
  v_mfma_f32_16x16x32_bf16 v[204:207], a[200:203], a[128:131], v[204:207]
  s_lshl_b32 s83, s83, 1
  v_xor_b32 v10, s83, v14
  v_mfma_f32_16x16x32_bf16 v[208:211], a[200:203], a[160:163], v[208:211]
  v_lshl_add_u32 v247, v10, 4, v15
  v_mfma_f32_32x32x16_bf16 a[0:15], a[164:167], v[184:187], a[0:15]
  s_waitcnt vmcnt(17) lgkmcnt(0)
  s_barrier
  v_mfma_f32_32x32x16_bf16 a[16:31], a[164:167], v[188:191], a[16:31]
  ds_read_b64_tr_b16 a[128:129], v212 offset:32768
  ds_read_b64_tr_b16 a[130:131], v212 offset:33792
  v_mfma_f32_32x32x16_bf16 a[32:47], a[168:171], v[184:187], a[32:47]
  ds_read_b128 v[128:131], v221 offset:0
  ds_read_b64_tr_b16 a[132:133], v213 offset:32768
  ds_read_b128 v[132:135], v221 offset:4096
  v_mfma_f32_32x32x16_bf16 a[48:63], a[168:171], v[188:191], a[48:63]
  ds_read_b64_tr_b16 a[134:135], v213 offset:33792
  ds_read_b64_tr_b16 a[136:137], v214 offset:32768
  ds_read_b128 v[136:139], v222 offset:0
  v_mfma_f32_32x32x16_bf16 a[64:79], a[172:175], v[184:187], a[64:79]
  ds_read_b64_tr_b16 a[138:139], v214 offset:33792
  ds_read_b128 v[140:143], v222 offset:4096
  ds_read_b64_tr_b16 a[140:141], v215 offset:32768
  v_mfma_f32_32x32x16_bf16 a[80:95], a[172:175], v[188:191], a[80:95]
  ds_read_b64_tr_b16 a[142:143], v215 offset:33792
  ds_read_b128 v[144:147], v223 offset:0
  ds_read_b64_tr_b16 a[144:145], v216 offset:32768
  v_mfma_f32_32x32x16_bf16 a[96:111], a[176:179], v[184:187], a[96:111]
  ds_read_b128 v[148:151], v223 offset:4096
  ds_read_b64_tr_b16 a[146:147], v216 offset:33280
  ds_read_b128 v[152:155], v224 offset:0
  v_mfma_f32_32x32x16_bf16 a[112:127], a[176:179], v[188:191], a[112:127]
  ds_read_b64_tr_b16 a[148:149], v217 offset:32768
  ds_read_b64_tr_b16 a[150:151], v217 offset:33280
  ds_read_b128 v[156:159], v224 offset:4096
  v_mfma_f32_32x32x16_bf16 a[208:223], a[180:183], v[184:187], a[208:223]
  ds_read_b64_tr_b16 a[152:153], v218 offset:32768
  v_mfma_f32_32x32x16_bf16 a[224:239], a[180:183], v[188:191], a[224:239]
  s_add_u32 m0, s77, 16384
  s_mov_b32 s76, 0
  buffer_load_dwordx4 v237, s[24:27], s76 offen lds
  v_mfma_f32_32x32x16_bf16 v[48:63], a[184:187], v[184:187], v[48:63]
  ds_read_b64_tr_b16 a[154:155], v218 offset:33280
  ds_read_b64_tr_b16 a[156:157], v219 offset:32768
  v_mfma_f32_32x32x16_bf16 v[64:79], a[184:187], v[188:191], v[64:79]
  buffer_load_dwordx4 v238, s[24:27], s76 offen offset:1024 lds
  v_mfma_f32_32x32x16_bf16 v[80:95], a[188:191], v[184:187], v[80:95]
  ds_read_b64_tr_b16 a[158:159], v219 offset:33280
  v_mfma_f32_32x32x16_bf16 v[96:111], a[188:191], v[188:191], v[96:111]
  buffer_load_dwordx4 v239, s[24:27], s76 offen offset:2048 lds
  ds_read_b64_tr_b16 a[160:161], v220 offset:32768
  v_mfma_f32_32x32x16_bf16 a[240:255], a[192:195], v[184:187], a[240:255]
  buffer_load_dwordx4 v240, s[24:27], s76 offen offset:3072 lds
  v_mfma_f32_16x16x32_bf16 v[204:207], a[200:203], a[164:167], v[204:207]
  v_mfma_f32_16x16x32_bf16 v[208:211], a[200:203], a[196:199], v[208:211]
  ds_read_b64_tr_b16 a[162:163], v220 offset:33280
  s_waitcnt lgkmcnt(11)
  v_mfma_f32_32x32x16_bf16 a[0:15], a[128:131], v[128:131], a[0:15]
  ds_read_b64_tr_b16 a[164:165], v212 offset:36864
  ds_read_b64_tr_b16 a[166:167], v212 offset:37888
  v_mfma_f32_32x32x16_bf16 a[16:31], a[128:131], v[132:135], a[16:31]
  v_mfma_f32_32x32x16_bf16 a[32:47], a[132:135], v[128:131], a[32:47]
  s_add_u32 m0, s77, 65536
  s_mov_b32 s76, 0
  buffer_load_dwordx4 v241, s[28:31], s76 offen lds
  v_mfma_f32_32x32x16_bf16 a[48:63], a[132:135], v[132:135], a[48:63]
  ds_read_b64_tr_b16 a[168:169], v213 offset:36864
  v_mfma_f32_32x32x16_bf16 a[64:79], a[136:139], v[128:131], a[64:79]
  ds_read_b64_tr_b16 a[170:171], v213 offset:37888
  ds_read_b64_tr_b16 a[172:173], v214 offset:36864
  v_mfma_f32_32x32x16_bf16 a[80:95], a[136:139], v[132:135], a[80:95]
  ds_read_b64_tr_b16 a[174:175], v214 offset:37888
  ds_read_b64_tr_b16 a[176:177], v215 offset:36864
  v_mfma_f32_32x32x16_bf16 a[96:111], a[140:143], v[128:131], a[96:111]
  buffer_load_dwordx4 v241, s[28:31], s76 offen offset:1024 lds
  v_mfma_f32_32x32x16_bf16 a[112:127], a[140:143], v[132:135], a[112:127]
  ds_read_b64_tr_b16 a[178:179], v215 offset:37888
  s_waitcnt lgkmcnt(10)
  v_mfma_f32_32x32x16_bf16 a[208:223], a[144:147], v[128:131], a[208:223]
  ds_read_b64_tr_b16 a[180:181], v216 offset:34816
  ds_read_b64_tr_b16 a[182:183], v216 offset:35328
  ds_read_b64_tr_b16 a[184:185], v217 offset:34816
  v_mfma_f32_32x32x16_bf16 a[224:239], a[144:147], v[132:135], a[224:239]
  v_mfma_f32_32x32x16_bf16 v[48:63], a[148:151], v[128:131], v[48:63]
  buffer_load_dwordx4 v241, s[28:31], s76 offen offset:2048 lds
  v_mfma_f32_32x32x16_bf16 v[64:79], a[148:151], v[132:135], v[64:79]
  ds_read_b64_tr_b16 a[186:187], v217 offset:35328
  ds_read_b64_tr_b16 a[188:189], v218 offset:34816
  ds_read_b64_tr_b16 a[190:191], v218 offset:35328
  v_mfma_f32_32x32x16_bf16 v[80:95], a[152:155], v[128:131], v[80:95]
  ds_read_b64_tr_b16 a[192:193], v219 offset:34816
  ds_read_b64_tr_b16 a[194:195], v219 offset:35328
  v_mfma_f32_32x32x16_bf16 v[96:111], a[152:155], v[132:135], v[96:111]
  buffer_load_dwordx4 v241, s[28:31], s76 offen offset:3072 lds
  v_mfma_f32_32x32x16_bf16 a[240:255], a[156:159], v[128:131], a[240:255]
  v_mfma_f32_16x16x32_bf16 v[204:207], a[200:203], a[128:131], v[204:207]
  ds_read_b64_tr_b16 a[196:197], v220 offset:34816
  s_waitcnt lgkmcnt(12)
  v_mfma_f32_16x16x32_bf16 v[208:211], a[200:203], a[160:163], v[208:211]
  ds_read_b64_tr_b16 a[198:199], v220 offset:35328
  v_mfma_f32_32x32x16_bf16 a[0:15], a[164:167], v[136:139], a[0:15]
  s_lshl_b32 s83, s3, 1
  ds_read_b64_tr_b16 a[128:129], v212 offset:40960
  v_mfma_f32_32x32x16_bf16 a[16:31], a[164:167], v[140:143], a[16:31]
  s_add_u32 s83, s83, 6
  ds_read_b64_tr_b16 a[130:131], v212 offset:41984
  s_and_b32 s83, s83, 7
  v_mfma_f32_32x32x16_bf16 a[32:47], a[168:171], v[136:139], a[32:47]
  ds_read_b64_tr_b16 a[132:133], v213 offset:40960
  s_lshl_b32 s83, s83, 1
  v_mfma_f32_32x32x16_bf16 a[48:63], a[168:171], v[140:143], a[48:63]
  ds_read_b64_tr_b16 a[134:135], v213 offset:41984
  ds_read_b64_tr_b16 a[136:137], v214 offset:40960
  v_xor_b32 v10, s83, v14
  s_waitcnt lgkmcnt(11)
  v_mfma_f32_32x32x16_bf16 a[64:79], a[172:175], v[136:139], a[64:79]
  ds_read_b64_tr_b16 a[138:139], v214 offset:41984
  v_lshl_add_u32 v248, v10, 4, v15
  v_mfma_f32_32x32x16_bf16 a[80:95], a[172:175], v[140:143], a[80:95]
  s_lshl_b32 s83, s3, 1
  ds_read_b64_tr_b16 a[140:141], v215 offset:40960
  s_add_u32 s83, s83, 7
  v_mfma_f32_32x32x16_bf16 a[96:111], a[176:179], v[136:139], a[96:111]
  ds_read_b64_tr_b16 a[142:143], v215 offset:41984
  s_and_b32 s83, s83, 7
  v_mfma_f32_32x32x16_bf16 a[112:127], a[176:179], v[140:143], a[112:127]
  ds_read_b64_tr_b16 a[144:145], v216 offset:36864
  s_lshl_b32 s83, s83, 1
  v_mfma_f32_32x32x16_bf16 a[208:223], a[180:183], v[136:139], a[208:223]
  ds_read_b64_tr_b16 a[146:147], v216 offset:37376
  v_xor_b32 v10, s83, v14
  v_lshl_add_u32 v249, v10, 4, v15
  v_mfma_f32_32x32x16_bf16 a[224:239], a[180:183], v[140:143], a[224:239]
  ds_read_b64_tr_b16 a[148:149], v217 offset:36864
  v_lshlrev_b32 v10, 4, v6
  v_mfma_f32_32x32x16_bf16 v[48:63], a[184:187], v[136:139], v[48:63]
  ds_read_b64_tr_b16 a[150:151], v217 offset:37376
  s_lshl2_add_u32 s84, s6, s3
  ds_read_b64_tr_b16 a[152:153], v218 offset:36864
  v_mfma_f32_32x32x16_bf16 v[64:79], a[184:187], v[140:143], v[64:79]
  s_mul_i32 s85, s84, 373760
  ds_read_b64_tr_b16 a[154:155], v218 offset:37376
  s_waitcnt lgkmcnt(9)
  v_mfma_f32_32x32x16_bf16 v[80:95], a[188:191], v[136:139], v[80:95]
  ds_read_b64_tr_b16 a[156:157], v219 offset:36864
  s_xor_b32 s84, s84, 4
  v_add_u32 v4, s85, v10
  v_mfma_f32_32x32x16_bf16 v[96:111], a[188:191], v[140:143], v[96:111]
  ds_read_b64_tr_b16 a[158:159], v219 offset:37376
  s_mul_i32 s85, s84, 373760
  v_mfma_f32_32x32x16_bf16 a[240:255], a[192:195], v[136:139], a[240:255]
  ds_read_b64_tr_b16 a[160:161], v220 offset:36864
  v_add_u32 v5, s85, v10
  v_mfma_f32_16x16x32_bf16 v[204:207], a[200:203], a[164:167], v[204:207]
  ds_read_b64_tr_b16 a[162:163], v220 offset:37376
  v_mfma_f32_16x16x32_bf16 v[208:211], a[200:203], a[196:199], v[208:211]
  v_lshlrev_b32 v225, 7, v6
  v_mfma_f32_32x32x16_bf16 a[0:15], a[128:131], v[144:147], a[0:15]
  s_waitcnt vmcnt(13)
  ds_read_b64_tr_b16 a[164:165], v212 offset:45056
  ds_read_b128 v[160:163], v221 offset:8192
  ds_read_b64_tr_b16 a[166:167], v212 offset:46080
  v_mfma_f32_32x32x16_bf16 a[16:31], a[128:131], v[148:151], a[16:31]
  ds_read_b128 v[164:167], v221 offset:12288
  ds_read_b64_tr_b16 a[168:169], v213 offset:45056
  ds_read_b128 v[168:171], v222 offset:8192
  ds_read_b64_tr_b16 a[170:171], v213 offset:46080
  v_mfma_f32_32x32x16_bf16 a[32:47], a[132:135], v[144:147], a[32:47]
  ds_read_b128 v[172:175], v222 offset:12288
  ds_read_b128 v[176:179], v223 offset:8192
  ds_read_b64_tr_b16 a[172:173], v214 offset:45056
  v_mfma_f32_32x32x16_bf16 a[48:63], a[132:135], v[148:151], a[48:63]
  ds_read_b128 v[180:183], v223 offset:12288
  ds_read_b64_tr_b16 a[174:175], v214 offset:46080
  ds_read_b128 v[184:187], v224 offset:8192
  ds_read_b64_tr_b16 a[176:177], v215 offset:45056
  s_waitcnt lgkmcnt(15)
  v_mfma_f32_32x32x16_bf16 a[64:79], a[136:139], v[144:147], a[64:79]
  ds_read_b128 v[188:191], v224 offset:12288
  ds_read_b64_tr_b16 a[178:179], v215 offset:46080
  v_mov_b32 v10, 0x40000000
  v_add_u32 v227, 0, v225
  v_mfma_f32_32x32x16_bf16 a[80:95], a[136:139], v[148:151], a[80:95]
  ds_read_b64_tr_b16 a[180:181], v216 offset:38912
  ds_read_b64_tr_b16 a[182:183], v216 offset:39424
  v_cmp_gt_u32 vcc, 16, v6
  s_nop 1
  v_cndmask_b32 v227, v10, v227, vcc
  v_mfma_f32_32x32x16_bf16 a[96:111], a[140:143], v[144:147], a[96:111]
  ds_read_b64_tr_b16 a[184:185], v217 offset:38912
  s_lshr_b32 s85, s4, 3
  v_cmp_gt_u32 vcc, 34, v6
  s_nop 1
  v_cndmask_b32 v226, v10, v225, vcc
  v_mfma_f32_32x32x16_bf16 a[112:127], a[140:143], v[148:151], a[112:127]
  ds_read_b64_tr_b16 a[186:187], v217 offset:39424
  s_lshl2_add_u32 s85, s85, s3
  s_lshl4_add_u32 s84, s5, s85
  ds_read_b64_tr_b16 a[188:189], v218 offset:38912
  v_mfma_f32_32x32x16_bf16 a[208:223], a[144:147], v[144:147], a[208:223]
  s_mul_i32 s84, s84, 4352
  ds_read_b64_tr_b16 a[190:191], v218 offset:39424
  s_min_u32 s84, s84, 546816
  v_mfma_f32_32x32x16_bf16 a[224:239], a[144:147], v[148:151], a[224:239]
  ds_read_b64_tr_b16 a[192:193], v219 offset:38912
  s_mul_i32 s83, s7, 552960
  ds_read_b64_tr_b16 a[194:195], v219 offset:39424
  s_add_u32 s72, s84, s83
  v_mfma_f32_32x32x16_bf16 v[48:63], a[148:151], v[144:147], v[48:63]
  s_lshl2_add_u32 s84, s5, s7
  ds_read_b64_tr_b16 a[196:197], v220 offset:38912
  s_lshl4_add_u32 s84, s84, s85
  ds_read_b64_tr_b16 a[198:199], v220 offset:39424
  v_mfma_f32_32x32x16_bf16 v[64:79], a[148:151], v[148:151], v[64:79]
  s_mul_i32 s73, s84, 10240
  v_mov_b32 v10, 0x40000000
  v_cmp_eq_u32 vcc, 0, v0
  s_nop 1
  v_cndmask_b32 v254, v10, 0, vcc
  v_mfma_f32_32x32x16_bf16 v[80:95], a[152:155], v[144:147], v[80:95]
  v_mov_b32 v255, 0
  v_mfma_f32_32x32x16_bf16 v[96:111], a[152:155], v[148:151], v[96:111]
  buffer_store_dword v255, v254, s[64:67], s68 offen sc1
  buffer_store_dword v255, v254, s[64:67], s68 offen offset:32 sc1
  v_mfma_f32_32x32x16_bf16 a[240:255], a[156:159], v[144:147], a[240:255]
  buffer_store_dword v255, v254, s[64:67], s69 offen sc1
  v_mfma_f32_16x16x32_bf16 v[204:207], a[200:203], a[128:131], v[204:207]
  s_waitcnt lgkmcnt(5)
  v_mfma_f32_16x16x32_bf16 v[208:211], a[200:203], a[160:163], v[208:211]
  v_mov_b32 v255, 1
  v_mfma_f32_32x32x16_bf16 a[0:15], a[164:167], v[152:155], a[0:15]
  s_waitcnt vmcnt(12) lgkmcnt(0)
  s_barrier
  s_waitcnt vmcnt(11)
  v_lshlrev_b32 v36, 4, v6
  v_lshlrev_b32 v37, 3, v38
  v_sub_u32 v36, v37, v36
  v_add_u32 v36, 372736, v36
  v_add_u32 v37, v4, v36
  v_add_u32 v36, v5, v36
  v_readfirstlane_b32 s82, v45
  s_nop 1
  s_cmp_ge_u32 s82, 32
  s_cbranch_scc0 L_spinS
L_backS:
  buffer_load_dwordx2 v[32:33], v37, s[32:35], 0 offen sc1
  buffer_load_dwordx2 v[34:35], v36, s[32:35], 0 offen sc1
  v_mfma_f32_32x32x16_bf16 a[16:31], a[164:167], v[156:159], a[16:31]
  ds_read_b64_tr_b16 a[128:129], v212 offset:0
  ds_read_b64_tr_b16 a[130:131], v212 offset:1024
  v_mfma_f32_32x32x16_bf16 a[32:47], a[168:171], v[152:155], a[32:47]
  v_mfma_f32_32x32x16_bf16 a[48:63], a[168:171], v[156:159], a[48:63]
  s_add_u32 m0, s77, 32768
  s_mov_b32 s76, 16384
  buffer_load_dwordx4 v237, s[24:27], s76 offen lds
  v_mfma_f32_32x32x16_bf16 a[64:79], a[172:175], v[152:155], a[64:79]
  ds_read_b64_tr_b16 a[132:133], v213 offset:0
  ds_read_b64_tr_b16 a[134:135], v213 offset:1024
  v_mfma_f32_32x32x16_bf16 a[80:95], a[172:175], v[156:159], a[80:95]
  ds_read_b64_tr_b16 a[136:137], v214 offset:0
  ds_read_b64_tr_b16 a[138:139], v214 offset:1024
  v_mfma_f32_32x32x16_bf16 a[96:111], a[176:179], v[152:155], a[96:111]
  ds_read_b64_tr_b16 a[140:141], v215 offset:0
  v_mfma_f32_32x32x16_bf16 a[112:127], a[176:179], v[156:159], a[112:127]
  buffer_load_dwordx4 v238, s[24:27], s76 offen offset:1024 lds
  v_mfma_f32_32x32x16_bf16 a[208:223], a[180:183], v[152:155], a[208:223]
  ds_read_b64_tr_b16 a[142:143], v215 offset:1024
  ds_read_b64_tr_b16 a[144:145], v216 offset:0
  ds_read_b64_tr_b16 a[146:147], v216 offset:512
  v_mfma_f32_32x32x16_bf16 a[224:239], a[180:183], v[156:159], a[224:239]
  ds_read_b64_tr_b16 a[148:149], v217 offset:0
  v_mfma_f32_32x32x16_bf16 v[48:63], a[184:187], v[152:155], v[48:63]
  buffer_load_dwordx4 v239, s[24:27], s76 offen offset:2048 lds
  v_mfma_f32_32x32x16_bf16 v[64:79], a[184:187], v[156:159], v[64:79]
  ds_read_b64_tr_b16 a[150:151], v217 offset:512
  ds_read_b64_tr_b16 a[152:153], v218 offset:0
  v_mfma_f32_32x32x16_bf16 v[80:95], a[188:191], v[152:155], v[80:95]
  ds_read_b64_tr_b16 a[154:155], v218 offset:512
  ds_read_b64_tr_b16 a[156:157], v219 offset:0
  v_mfma_f32_32x32x16_bf16 v[96:111], a[188:191], v[156:159], v[96:111]
  ds_read_b64_tr_b16 a[158:159], v219 offset:512
  v_mfma_f32_32x32x16_bf16 a[240:255], a[192:195], v[152:155], a[240:255]
  buffer_load_dwordx4 v240, s[24:27], s76 offen offset:3072 lds
  v_mfma_f32_16x16x32_bf16 v[204:207], a[200:203], a[164:167], v[204:207]
  ds_read_b64_tr_b16 a[160:161], v220 offset:0
  v_mfma_f32_16x16x32_bf16 v[208:211], a[200:203], a[196:199], v[208:211]
  ds_read_b64_tr_b16 a[162:163], v220 offset:512
  s_waitcnt lgkmcnt(13)
  v_mfma_f32_32x32x16_bf16 a[0:15], a[128:131], v[160:163], a[0:15]
  ds_read_b64_tr_b16 a[164:165], v212 offset:4096
  ds_read_b64_tr_b16 a[166:167], v212 offset:5120
  v_mfma_f32_32x32x16_bf16 a[16:31], a[128:131], v[164:167], a[16:31]
  v_mfma_f32_32x32x16_bf16 a[32:47], a[132:135], v[160:163], a[32:47]
  s_add_u32 m0, s77, 81920
  s_mov_b32 s76, 32768
  buffer_load_dwordx4 v237, s[24:27], s76 offen lds
  v_mfma_f32_32x32x16_bf16 a[48:63], a[132:135], v[164:167], a[48:63]
  ds_read_b64_tr_b16 a[168:169], v213 offset:4096
  s_waitcnt lgkmcnt(10)
  v_mfma_f32_32x32x16_bf16 a[64:79], a[136:139], v[160:163], a[64:79]
  ds_read_b64_tr_b16 a[170:171], v213 offset:5120
  ds_read_b64_tr_b16 a[172:173], v214 offset:4096
  v_mfma_f32_32x32x16_bf16 a[80:95], a[136:139], v[164:167], a[80:95]
  ds_read_b64_tr_b16 a[174:175], v214 offset:5120
  ds_read_b64_tr_b16 a[176:177], v215 offset:4096
  v_mfma_f32_32x32x16_bf16 a[96:111], a[140:143], v[160:163], a[96:111]
  buffer_load_dwordx4 v238, s[24:27], s76 offen offset:1024 lds
  v_mfma_f32_32x32x16_bf16 a[112:127], a[140:143], v[164:167], a[112:127]
  ds_read_b64_tr_b16 a[178:179], v215 offset:5120
  v_mfma_f32_32x32x16_bf16 a[208:223], a[144:147], v[160:163], a[208:223]
  ds_read_b64_tr_b16 a[180:181], v216 offset:2048
  ds_read_b64_tr_b16 a[182:183], v216 offset:2560
  ds_read_b64_tr_b16 a[184:185], v217 offset:2048
  v_mfma_f32_32x32x16_bf16 a[224:239], a[144:147], v[164:167], a[224:239]
  s_waitcnt lgkmcnt(11)
  v_mfma_f32_32x32x16_bf16 v[48:63], a[148:151], v[160:163], v[48:63]
  buffer_load_dwordx4 v239, s[24:27], s76 offen offset:2048 lds
  v_mfma_f32_32x32x16_bf16 v[64:79], a[148:151], v[164:167], v[64:79]
  ds_read_b64_tr_b16 a[186:187], v217 offset:2560
  ds_read_b64_tr_b16 a[188:189], v218 offset:2048
  ds_read_b64_tr_b16 a[190:191], v218 offset:2560
  v_mfma_f32_32x32x16_bf16 v[80:95], a[152:155], v[160:163], v[80:95]
  ds_read_b64_tr_b16 a[192:193], v219 offset:2048
  ds_read_b64_tr_b16 a[194:195], v219 offset:2560
  v_mfma_f32_32x32x16_bf16 v[96:111], a[152:155], v[164:167], v[96:111]
  buffer_load_dwordx4 v240, s[24:27], s76 offen offset:3072 lds
  v_mfma_f32_32x32x16_bf16 a[240:255], a[156:159], v[160:163], a[240:255]
  v_mfma_f32_16x16x32_bf16 v[204:207], a[200:203], a[128:131], v[204:207]
  ds_read_b64_tr_b16 a[196:197], v220 offset:2048
  v_mfma_f32_16x16x32_bf16 v[208:211], a[200:203], a[160:163], v[208:211]
  ds_read_b64_tr_b16 a[198:199], v220 offset:2560
  s_waitcnt lgkmcnt(12)
  v_mfma_f32_32x32x16_bf16 a[0:15], a[164:167], v[168:171], a[0:15]
  ds_read_b64_tr_b16 a[128:129], v212 offset:8192
  ds_read_b64_tr_b16 a[130:131], v212 offset:9216
  v_mfma_f32_32x32x16_bf16 a[16:31], a[164:167], v[172:175], a[16:31]
  v_mfma_f32_32x32x16_bf16 a[32:47], a[168:171], v[168:171], a[32:47]
  s_add_u32 m0, s77, 98304
  s_mov_b32 s76, 49152
  buffer_load_dwordx4 v237, s[24:27], s76 offen lds
  v_mfma_f32_32x32x16_bf16 a[48:63], a[168:171], v[172:175], a[48:63]
  ds_read_b64_tr_b16 a[132:133], v213 offset:8192
  v_mfma_f32_32x32x16_bf16 a[64:79], a[172:175], v[168:171], a[64:79]
  ds_read_b64_tr_b16 a[134:135], v213 offset:9216
  ds_read_b64_tr_b16 a[136:137], v214 offset:8192
  v_mfma_f32_32x32x16_bf16 a[80:95], a[172:175], v[172:175], a[80:95]
  ds_read_b64_tr_b16 a[138:139], v214 offset:9216
  ds_read_b64_tr_b16 a[140:141], v215 offset:8192
  s_waitcnt lgkmcnt(11)
  v_mfma_f32_32x32x16_bf16 a[96:111], a[176:179], v[168:171], a[96:111]
  buffer_load_dwordx4 v238, s[24:27], s76 offen offset:1024 lds
  v_mfma_f32_32x32x16_bf16 a[112:127], a[176:179], v[172:175], a[112:127]
  ds_read_b64_tr_b16 a[142:143], v215 offset:9216
  v_mfma_f32_32x32x16_bf16 a[208:223], a[180:183], v[168:171], a[208:223]
  ds_read_b64_tr_b16 a[144:145], v216 offset:4096
  ds_read_b64_tr_b16 a[146:147], v216 offset:4608
  ds_read_b64_tr_b16 a[148:149], v217 offset:4096
  v_mfma_f32_32x32x16_bf16 a[224:239], a[180:183], v[172:175], a[224:239]
  v_mfma_f32_32x32x16_bf16 v[48:63], a[184:187], v[168:171], v[48:63]
  buffer_load_dwordx4 v239, s[24:27], s76 offen offset:2048 lds
  v_mfma_f32_32x32x16_bf16 v[64:79], a[184:187], v[172:175], v[64:79]
  ds_read_b64_tr_b16 a[150:151], v217 offset:4608
  ds_read_b64_tr_b16 a[152:153], v218 offset:4096
  ds_read_b64_tr_b16 a[154:155], v218 offset:4608
  v_mfma_f32_32x32x16_bf16 v[80:95], a[188:191], v[168:171], v[80:95]
  ds_read_b64_tr_b16 a[156:157], v219 offset:4096
  ds_read_b64_tr_b16 a[158:159], v219 offset:4608
  v_mfma_f32_32x32x16_bf16 v[96:111], a[188:191], v[172:175], v[96:111]
  buffer_load_dwordx4 v240, s[24:27], s76 offen offset:3072 lds
  s_waitcnt lgkmcnt(13)
  v_mfma_f32_32x32x16_bf16 a[240:255], a[192:195], v[168:171], a[240:255]
  v_mfma_f32_16x16x32_bf16 v[204:207], a[200:203], a[164:167], v[204:207]
  ds_read_b64_tr_b16 a[160:161], v220 offset:4096
  v_mfma_f32_16x16x32_bf16 v[208:211], a[200:203], a[196:199], v[208:211]
  ds_read_b64_tr_b16 a[162:163], v220 offset:4608
  v_mfma_f32_32x32x16_bf16 a[0:15], a[128:131], v[176:179], a[0:15]
  ds_read_b64_tr_b16 a[164:165], v212 offset:12288
  ds_read_b64_tr_b16 a[166:167], v212 offset:13312
  s_waitcnt vmcnt(13)
  v_mov_b32 v192, v32
  v_mov_b32 v196, v33
  v_mul_f32 v192, 0x3acccccd, v192
  v_mfma_f32_32x32x16_bf16 a[16:31], a[128:131], v[180:183], a[16:31]
  ds_read_b64_tr_b16 a[168:169], v213 offset:12288
  v_mul_f32 v196, 0x3acccccd, v196
  v_fma_f32 v196, -v192, v192, v196
  v_max_f32 v196, 0, v196
  s_waitcnt lgkmcnt(10)
  v_mfma_f32_32x32x16_bf16 a[32:47], a[132:135], v[176:179], a[32:47]
  s_add_u32 m0, s77, 114688
  s_mov_b32 s76, 16384
  buffer_load_dwordx4 v241, s[28:31], s76 offen lds
  v_cvt_pk_bf16_f32 v196, v196, v196
  v_mfma_f32_32x32x16_bf16 a[48:63], a[132:135], v[180:183], a[48:63]
  ds_read_b64_tr_b16 a[170:171], v213 offset:13312
  ds_read_b64_tr_b16 a[172:173], v214 offset:12288
  v_and_b32 v196, s80, v196
  v_add_f32 v196, 0x3727c5ac, v196
  v_cvt_pk_bf16_f32 v196, v196, v196
  v_mfma_f32_32x32x16_bf16 a[64:79], a[136:139], v[176:179], a[64:79]
  ds_read_b64_tr_b16 a[174:175], v214 offset:13312
  ds_read_b64_tr_b16 a[176:177], v215 offset:12288
  v_and_b32 v196, s80, v196
  v_sqrt_f32 v196, v196
  s_nop 0
  v_cvt_pk_bf16_f32 v196, v196, v196
  v_and_b32 v196, s80, v196
  v_mfma_f32_32x32x16_bf16 a[80:95], a[136:139], v[180:183], a[80:95]
  ds_read_b64_tr_b16 a[178:179], v215 offset:13312
  ds_read_b64_tr_b16 a[180:181], v216 offset:6144
  v_rcp_f32 v8, v196
  v_mul_f32 v197, v196, v196
  v_mfma_f32_32x32x16_bf16 a[96:111], a[140:143], v[176:179], a[96:111]
  buffer_load_dwordx4 v241, s[28:31], s76 offen offset:1024 lds
  v_cvt_pk_bf16_f32 v192, -v192, -v192
  v_cmp_gt_u32 vcc, 32, v6
  v_mfma_f32_32x32x16_bf16 a[112:127], a[140:143], v[180:183], a[112:127]
  ds_read_b64_tr_b16 a[182:183], v216 offset:6656
  ds_read_b64_tr_b16 a[184:185], v217 offset:6144
  v_cndmask_b32 v200, 0, v192, vcc
  v_and_b32 v201, 0xffff, v200
  v_mov_b32 v202, 0
  v_mfma_f32_32x32x16_bf16 a[208:223], a[144:147], v[176:179], a[208:223]
  ds_read_b64_tr_b16 a[186:187], v217 offset:6656
  ds_read_b64_tr_b16 a[188:189], v218 offset:6144
  v_mov_b32 v203, 0
  s_waitcnt vmcnt(14)
  v_mov_b32 v194, v34
  v_mov_b32 v198, v35
  v_mfma_f32_32x32x16_bf16 a[224:239], a[144:147], v[180:183], a[224:239]
  ds_read_b64_tr_b16 a[190:191], v218 offset:6656
  ds_read_b64_tr_b16 a[192:193], v219 offset:6144
  v_mul_f32 v194, 0x3acccccd, v194
  v_mul_f32 v198, 0x3acccccd, v198
  v_fma_f32 v198, -v194, v194, v198
  v_max_f32 v198, 0, v198
  s_waitcnt lgkmcnt(7)
  v_mfma_f32_32x32x16_bf16 v[48:63], a[148:151], v[176:179], v[48:63]
  buffer_load_dwordx4 v241, s[28:31], s76 offen offset:2048 lds
  v_cvt_pk_bf16_f32 v198, v198, v198
  v_mfma_f32_32x32x16_bf16 v[64:79], a[148:151], v[180:183], v[64:79]
  ds_read_b64_tr_b16 a[194:195], v219 offset:6656
  ds_read_b64_tr_b16 a[196:197], v220 offset:6144
  v_and_b32 v198, s80, v198
  v_add_f32 v198, 0x3727c5ac, v198
  v_cvt_pk_bf16_f32 v198, v198, v198
  v_mfma_f32_32x32x16_bf16 v[80:95], a[152:155], v[176:179], v[80:95]
  ds_read_b64_tr_b16 a[198:199], v220 offset:6656
  v_and_b32 v198, s80, v198
  v_sqrt_f32 v198, v198
  s_nop 0
  v_cvt_pk_bf16_f32 v198, v198, v198
  v_and_b32 v198, s80, v198
  v_mfma_f32_32x32x16_bf16 v[96:111], a[152:155], v[180:183], v[96:111]
  v_rcp_f32 v9, v198
  v_mul_f32 v199, v198, v198
  v_cvt_pk_bf16_f32 v194, -v194, -v194
  v_and_b32 v10, 31, v6
  v_mfma_f32_32x32x16_bf16 a[240:255], a[156:159], v[176:179], a[240:255]
  buffer_load_dwordx4 v241, s[28:31], s76 offen offset:3072 lds
  v_lshlrev_b32 v10, 4, v10
  v_add_u32 v11, 147456, v10
  v_mfma_f32_16x16x32_bf16 v[204:207], a[200:203], a[128:131], v[204:207]
  s_lshl_b32 s82, s3, 9
  v_add_u32 v10, s82, v11
  v_mfma_f32_16x16x32_bf16 v[208:211], a[200:203], a[160:163], v[208:211]
  v_mov_b32 v14, 0
  v_mov_b32 v15, 0
  v_mfma_f32_16x16x32_bf16 v[204:207], a[200:203], a[164:167], v[204:207]
  s_waitcnt lgkmcnt(0)
  v_mfma_f32_16x16x32_bf16 v[208:211], a[200:203], a[196:199], v[208:211]
  v_mfma_f32_32x32x16_bf16 a[0:15], a[164:167], v[184:187], a[0:15]
  s_add_u32 m0, s77, 131072
  s_mov_b32 s76, 32768
  buffer_load_dwordx4 v241, s[28:31], s76 offen lds
  buffer_load_dwordx4 v241, s[28:31], s76 offen offset:1024 lds
  v_mfma_f32_32x32x16_bf16 a[16:31], a[164:167], v[188:191], a[16:31]
  buffer_load_dwordx4 v241, s[28:31], s76 offen offset:2048 lds
  buffer_load_dwordx4 v241, s[28:31], s76 offen offset:3072 lds
  v_mfma_f32_32x32x16_bf16 a[32:47], a[168:171], v[184:187], a[32:47]
  v_and_b32 v1, 16, v6
  v_cmp_eq_u32 vcc, 0, v1
  s_nop 1
  v_cndmask_b32 v1, v205, v204, vcc
  v_mfma_f32_32x32x16_bf16 a[48:63], a[168:171], v[188:191], a[48:63]
  v_and_b32 v2, s80, v1
  v_sub_f32 v1, v1, v2
  v_and_b32 v3, s80, v1
  v_mfma_f32_32x32x16_bf16 a[64:79], a[172:175], v[184:187], a[64:79]
  v_sub_f32 v1, v1, v3
  v_lshrrev_b32 v13, 16, v1
  v_mfma_f32_32x32x16_bf16 a[80:95], a[172:175], v[188:191], a[80:95]
  v_lshrrev_b32 v2, 16, v2
  v_or_b32 v12, v2, v3
  v_mfma_f32_32x32x16_bf16 a[96:111], a[176:179], v[184:187], a[96:111]
  ds_write_b128 v10, v[12:15] offset:0
  v_cndmask_b32 v1, v209, v208, vcc
  v_and_b32 v2, s80, v1
  v_sub_f32 v1, v1, v2
  v_mfma_f32_32x32x16_bf16 a[112:127], a[176:179], v[188:191], a[112:127]
  v_and_b32 v3, s80, v1
  v_sub_f32 v1, v1, v3
  v_lshrrev_b32 v13, 16, v1
  v_mfma_f32_32x32x16_bf16 a[208:223], a[180:183], v[184:187], a[208:223]
  v_lshrrev_b32 v2, 16, v2
  v_or_b32 v12, v2, v3
  v_mfma_f32_32x32x16_bf16 a[224:239], a[180:183], v[188:191], a[224:239]
  ds_write_b128 v10, v[12:15] offset:2048
  v_cmp_gt_u32 vcc, 32, v6
  s_nop 1
  v_cndmask_b32 v204, 0, v194, vcc
  v_mfma_f32_32x32x16_bf16 v[48:63], a[184:187], v[184:187], v[48:63]
  v_and_b32 v205, 0xffff, v204
  v_mov_b32 v206, 0
  v_mov_b32 v207, 0
  v_mfma_f32_32x32x16_bf16 v[64:79], a[184:187], v[188:191], v[64:79]
  s_waitcnt vmcnt(16) lgkmcnt(0)
  s_barrier
  v_mfma_f32_32x32x16_bf16 v[80:95], a[188:191], v[184:187], v[80:95]
  s_add_u32 s83, s3, 0
  s_and_b32 s83, s83, 3
  s_lshl_b32 s83, s83, 9
  v_add_u32 v12, s83, v11
  s_add_u32 s83, s3, 1
  s_and_b32 s83, s83, 3
  s_lshl_b32 s83, s83, 9
  v_add_u32 v13, s83, v11
  s_add_u32 s83, s3, 2
  s_and_b32 s83, s83, 3
  s_lshl_b32 s83, s83, 9
  v_add_u32 v14, s83, v11
  s_add_u32 s83, s3, 3
  s_and_b32 s83, s83, 3
  v_mfma_f32_32x32x16_bf16 v[96:111], a[188:191], v[188:191], v[96:111]
  s_lshl_b32 s83, s83, 9
  ds_read_b128 a[128:131], v12
  ds_read_b128 a[132:135], v13
  ds_read_b128 a[136:139], v14
  v_add_u32 v15, s83, v11
  ds_read_b128 a[140:143], v15
  ds_read_b128 a[144:147], v11 offset:2048
  ds_read_b128 a[148:151], v11 offset:2560
  ds_read_b128 a[152:155], v11 offset:3072
  ds_read_b128 a[156:159], v11 offset:3584
  s_add_u32 m0, s77, 49152
  s_mov_b32 s76, 49152
  buffer_load_dwordx4 v241, s[28:31], s76 offen lds
  v_mfma_f32_32x32x16_bf16 a[240:255], a[192:195], v[184:187], a[240:255]
  buffer_load_dwordx4 v241, s[28:31], s76 offen offset:1024 lds
  buffer_load_dwordx4 v241, s[28:31], s76 offen offset:2048 lds
  buffer_load_dwordx4 v241, s[28:31], s76 offen offset:3072 lds
  s_waitcnt lgkmcnt(7)
  v_mfma_f32_32x32x16_bf16 a[0:15], a[128:131], v[200:203], a[0:15]
  v_mfma_f32_32x32x16_bf16 a[16:31], a[128:131], v[204:207], a[16:31]
  s_lshl2_add_u32 s12, s6, s81
  s_lshl_b32 s12, s12, 10
  s_add_u32 s12, s12, 259072
  s_mov_b32 s13, s81
  s_lshl_b32 s13, s13, 10
  s_add_u32 s13, s13, 262144
  v_add_u32 v212, 0x10000, v250
  v_add_u32 v213, 0x10000, v251
  v_add_u32 v214, 0x10000, v252
  v_add_u32 v215, 0x10000, v253
  v_mul_f32 v10, 0x3e0293ee, v8
  v_mul_f32 v196, 0xbfb8aa3b, v8
  v_mul_f32 v11, 0x3e0293ee, v9
  v_mul_f32 v198, 0xbfb8aa3b, v9
  s_waitcnt lgkmcnt(3)
  v_mfma_f32_32x32x16_bf16 a[32:47], a[132:135], v[200:203], a[32:47]
  v_accvgpr_read_b32 v12, a0
  v_accvgpr_read_b32 v13, a1
  v_mul_f32 v12, v10, v12
  v_mul_f32 v13, v10, v13
  v_cvt_pk_bf16_f32 v128, v12, v13
  v_accvgpr_read_b32 v14, a2
  v_accvgpr_read_b32 v15, a3
  v_mul_f32 v14, v10, v14
  v_mul_f32 v15, v10, v15
  v_cvt_pk_bf16_f32 v129, v14, v15
  v_accvgpr_read_b32 v12, a4
  v_accvgpr_read_b32 v13, a5
  v_mul_f32 v12, v10, v12
  v_mul_f32 v13, v10, v13
  v_cvt_pk_bf16_f32 v130, v12, v13
  v_accvgpr_read_b32 v14, a6
  v_accvgpr_read_b32 v15, a7
  v_mul_f32 v14, v10, v14
  v_mul_f32 v15, v10, v15
  v_cvt_pk_bf16_f32 v131, v14, v15
  v_mfma_f32_32x32x16_bf16 a[48:63], a[132:135], v[204:207], a[48:63]
  v_accvgpr_read_b32 v12, a8
  v_accvgpr_read_b32 v13, a9
  v_mul_f32 v12, v10, v12
  v_mul_f32 v13, v10, v13
  v_cvt_pk_bf16_f32 v136, v12, v13
  v_accvgpr_read_b32 v14, a10
  v_accvgpr_read_b32 v15, a11
  v_mul_f32 v14, v10, v14
  v_mul_f32 v15, v10, v15
  v_cvt_pk_bf16_f32 v137, v14, v15
  v_accvgpr_read_b32 v12, a12
  v_accvgpr_read_b32 v13, a13
  v_mul_f32 v12, v10, v12
  v_mul_f32 v13, v10, v13
  v_cvt_pk_bf16_f32 v138, v12, v13
  v_accvgpr_read_b32 v14, a14
  v_accvgpr_read_b32 v15, a15
  v_mul_f32 v14, v10, v14
  v_mul_f32 v15, v10, v15
  v_cvt_pk_bf16_f32 v139, v14, v15
  v_mfma_f32_32x32x16_bf16 a[64:79], a[136:139], v[200:203], a[64:79]
  v_accvgpr_read_b32 v12, a16
  v_accvgpr_read_b32 v13, a17
  v_mul_f32 v12, v11, v12
  v_mul_f32 v13, v11, v13
  v_cvt_pk_bf16_f32 v132, v12, v13
  v_accvgpr_read_b32 v14, a18
  v_accvgpr_read_b32 v15, a19
  v_mul_f32 v14, v11, v14
  v_mul_f32 v15, v11, v15
  v_cvt_pk_bf16_f32 v133, v14, v15
  v_accvgpr_read_b32 v12, a20
  v_accvgpr_read_b32 v13, a21
  v_mul_f32 v12, v11, v12
  v_mul_f32 v13, v11, v13
  v_cvt_pk_bf16_f32 v134, v12, v13
  v_accvgpr_read_b32 v14, a22
  v_accvgpr_read_b32 v15, a23
  v_mul_f32 v14, v11, v14
  v_mul_f32 v15, v11, v15
  v_cvt_pk_bf16_f32 v135, v14, v15
  v_mfma_f32_32x32x16_bf16 a[80:95], a[136:139], v[204:207], a[80:95]
  v_accvgpr_read_b32 v12, a24
  v_accvgpr_read_b32 v13, a25
  v_mul_f32 v12, v11, v12
  v_mul_f32 v13, v11, v13
  v_cvt_pk_bf16_f32 v140, v12, v13
  v_accvgpr_read_b32 v14, a26
  v_accvgpr_read_b32 v15, a27
  v_mul_f32 v14, v11, v14
  v_mul_f32 v15, v11, v15
  v_cvt_pk_bf16_f32 v141, v14, v15
  v_accvgpr_read_b32 v12, a28
  v_accvgpr_read_b32 v13, a29
  v_mul_f32 v12, v11, v12
  v_mul_f32 v13, v11, v13
  v_cvt_pk_bf16_f32 v142, v12, v13
  v_accvgpr_read_b32 v14, a30
  v_accvgpr_read_b32 v15, a31
  v_mul_f32 v14, v11, v14
  v_mul_f32 v15, v11, v15
  v_cvt_pk_bf16_f32 v143, v14, v15
  v_mfma_f32_32x32x16_bf16 a[96:111], a[140:143], v[200:203], a[96:111]
  v_accvgpr_read_b32 v12, a32
  v_accvgpr_read_b32 v13, a33
  v_mul_f32 v12, v10, v12
  v_mul_f32 v13, v10, v13
  v_cvt_pk_bf16_f32 v144, v12, v13
  v_accvgpr_read_b32 v14, a34
  v_accvgpr_read_b32 v15, a35
  v_mul_f32 v14, v10, v14
  v_mul_f32 v15, v10, v15
  v_cvt_pk_bf16_f32 v145, v14, v15
  v_accvgpr_read_b32 v12, a36
  v_accvgpr_read_b32 v13, a37
  v_mul_f32 v12, v10, v12
  v_mul_f32 v13, v10, v13
  v_cvt_pk_bf16_f32 v146, v12, v13
  v_accvgpr_read_b32 v14, a38
  v_accvgpr_read_b32 v15, a39
  v_mul_f32 v14, v10, v14
  v_mul_f32 v15, v10, v15
  v_cvt_pk_bf16_f32 v147, v14, v15
  v_mfma_f32_32x32x16_bf16 a[112:127], a[140:143], v[204:207], a[112:127]
  v_accvgpr_read_b32 v12, a40
  v_accvgpr_read_b32 v13, a41
  v_mul_f32 v12, v10, v12
  v_mul_f32 v13, v10, v13
  v_cvt_pk_bf16_f32 v152, v12, v13
  v_accvgpr_read_b32 v14, a42
  v_accvgpr_read_b32 v15, a43
  v_mul_f32 v14, v10, v14
  v_mul_f32 v15, v10, v15
  v_cvt_pk_bf16_f32 v153, v14, v15
  v_accvgpr_read_b32 v12, a44
  v_accvgpr_read_b32 v13, a45
  v_mul_f32 v12, v10, v12
  v_mul_f32 v13, v10, v13
  v_cvt_pk_bf16_f32 v154, v12, v13
  v_accvgpr_read_b32 v14, a46
  v_accvgpr_read_b32 v15, a47
  v_mul_f32 v14, v10, v14
  v_mul_f32 v15, v10, v15
  v_cvt_pk_bf16_f32 v155, v14, v15
  s_waitcnt lgkmcnt(0)
  v_mfma_f32_32x32x16_bf16 v[48:63], a[148:151], v[200:203], v[48:63]
  v_accvgpr_read_b32 v12, a48
  v_accvgpr_read_b32 v13, a49
  v_mul_f32 v12, v11, v12
  v_mul_f32 v13, v11, v13
  v_cvt_pk_bf16_f32 v148, v12, v13
  v_accvgpr_read_b32 v14, a50
  v_accvgpr_read_b32 v15, a51
  v_mul_f32 v14, v11, v14
  v_mul_f32 v15, v11, v15
  v_cvt_pk_bf16_f32 v149, v14, v15
  v_accvgpr_read_b32 v12, a52
  v_accvgpr_read_b32 v13, a53
  v_mul_f32 v12, v11, v12
  v_mul_f32 v13, v11, v13
  v_cvt_pk_bf16_f32 v150, v12, v13
  v_accvgpr_read_b32 v14, a54
  v_accvgpr_read_b32 v15, a55
  v_mul_f32 v14, v11, v14
  v_mul_f32 v15, v11, v15
  v_cvt_pk_bf16_f32 v151, v14, v15
  v_mfma_f32_32x32x16_bf16 v[64:79], a[148:151], v[204:207], v[64:79]
  v_accvgpr_read_b32 v12, a56
  v_accvgpr_read_b32 v13, a57
  v_mul_f32 v12, v11, v12
  v_mul_f32 v13, v11, v13
  v_cvt_pk_bf16_f32 v156, v12, v13
  v_accvgpr_read_b32 v14, a58
  v_accvgpr_read_b32 v15, a59
  v_mul_f32 v14, v11, v14
  v_mul_f32 v15, v11, v15
  v_cvt_pk_bf16_f32 v157, v14, v15
  v_accvgpr_read_b32 v12, a60
  v_accvgpr_read_b32 v13, a61
  v_mul_f32 v12, v11, v12
  v_mul_f32 v13, v11, v13
  v_cvt_pk_bf16_f32 v158, v12, v13
  v_accvgpr_read_b32 v14, a62
  v_accvgpr_read_b32 v15, a63
  v_mul_f32 v14, v11, v14
  v_mul_f32 v15, v11, v15
  v_cvt_pk_bf16_f32 v159, v14, v15
  v_mfma_f32_32x32x16_bf16 v[80:95], a[152:155], v[200:203], v[80:95]
  v_accvgpr_read_b32 v12, a64
  v_accvgpr_read_b32 v13, a65
  v_mul_f32 v12, v10, v12
  v_mul_f32 v13, v10, v13
  v_cvt_pk_bf16_f32 v160, v12, v13
  v_accvgpr_read_b32 v14, a66
  v_accvgpr_read_b32 v15, a67
  v_mul_f32 v14, v10, v14
  v_mul_f32 v15, v10, v15
  v_cvt_pk_bf16_f32 v161, v14, v15
  v_accvgpr_read_b32 v12, a68
  v_accvgpr_read_b32 v13, a69
  v_mul_f32 v12, v10, v12
  v_mul_f32 v13, v10, v13
  v_cvt_pk_bf16_f32 v162, v12, v13
  v_accvgpr_read_b32 v14, a70
  v_accvgpr_read_b32 v15, a71
  v_mul_f32 v14, v10, v14
  v_mul_f32 v15, v10, v15
  v_cvt_pk_bf16_f32 v163, v14, v15
  v_mfma_f32_32x32x16_bf16 v[96:111], a[152:155], v[204:207], v[96:111]
  v_accvgpr_read_b32 v12, a72
  v_accvgpr_read_b32 v13, a73
  v_mul_f32 v12, v10, v12
  v_mul_f32 v13, v10, v13
  v_cvt_pk_bf16_f32 v168, v12, v13
  v_accvgpr_read_b32 v14, a74
  v_accvgpr_read_b32 v15, a75
  v_mul_f32 v14, v10, v14
  v_mul_f32 v15, v10, v15
  v_cvt_pk_bf16_f32 v169, v14, v15
  v_accvgpr_read_b32 v12, a76
  v_accvgpr_read_b32 v13, a77
  v_mul_f32 v12, v10, v12
  v_mul_f32 v13, v10, v13
  v_cvt_pk_bf16_f32 v170, v12, v13
  v_accvgpr_read_b32 v14, a78
  v_accvgpr_read_b32 v15, a79
  v_mul_f32 v14, v10, v14
  v_mul_f32 v15, v10, v15
  v_cvt_pk_bf16_f32 v171, v14, v15
  v_mfma_f32_32x32x16_bf16 a[208:223], a[144:147], v[200:203], a[208:223]
  v_accvgpr_read_b32 v12, a80
  v_accvgpr_read_b32 v13, a81
  v_mul_f32 v12, v11, v12
  v_mul_f32 v13, v11, v13
  v_cvt_pk_bf16_f32 v164, v12, v13
  v_accvgpr_read_b32 v14, a82
  v_accvgpr_read_b32 v15, a83
  v_mul_f32 v14, v11, v14
  v_mul_f32 v15, v11, v15
  v_cvt_pk_bf16_f32 v165, v14, v15
  v_accvgpr_read_b32 v12, a84
  v_accvgpr_read_b32 v13, a85
  v_mul_f32 v12, v11, v12
  v_mul_f32 v13, v11, v13
  v_cvt_pk_bf16_f32 v166, v12, v13
  v_accvgpr_read_b32 v14, a86
  v_accvgpr_read_b32 v15, a87
  v_mul_f32 v14, v11, v14
  v_mul_f32 v15, v11, v15
  v_cvt_pk_bf16_f32 v167, v14, v15
  v_mfma_f32_32x32x16_bf16 a[224:239], a[144:147], v[204:207], a[224:239]
  v_accvgpr_read_b32 v12, a88
  v_accvgpr_read_b32 v13, a89
  v_mul_f32 v12, v11, v12
  v_mul_f32 v13, v11, v13
  v_cvt_pk_bf16_f32 v172, v12, v13
  v_accvgpr_read_b32 v14, a90
  v_accvgpr_read_b32 v15, a91
  v_mul_f32 v14, v11, v14
  v_mul_f32 v15, v11, v15
  v_cvt_pk_bf16_f32 v173, v14, v15
  v_accvgpr_read_b32 v12, a92
  v_accvgpr_read_b32 v13, a93
  v_mul_f32 v12, v11, v12
  v_mul_f32 v13, v11, v13
  v_cvt_pk_bf16_f32 v174, v12, v13
  v_accvgpr_read_b32 v14, a94
  v_accvgpr_read_b32 v15, a95
  v_mul_f32 v14, v11, v14
  v_mul_f32 v15, v11, v15
  v_cvt_pk_bf16_f32 v175, v14, v15
  v_mfma_f32_32x32x16_bf16 a[240:255], a[156:159], v[200:203], a[240:255]
  ds_read_b128 a[128:131], v242 offset:16384
  ds_read_b128 a[132:135], v243 offset:16384
  ds_read_b128 a[136:139], v244 offset:16384
  ds_read_b128 a[140:143], v245 offset:16384
  ds_read_b128 a[144:147], v246 offset:16384
  ds_read_b128 a[148:151], v247 offset:16384
  ds_read_b128 a[152:155], v248 offset:16384
  ds_read_b128 a[156:159], v249 offset:16384
  v_accvgpr_read_b32 v12, a96
  v_accvgpr_read_b32 v13, a97
  v_mul_f32 v12, v10, v12
  v_mul_f32 v13, v10, v13
  v_cvt_pk_bf16_f32 v176, v12, v13
  v_accvgpr_read_b32 v14, a98
  v_accvgpr_read_b32 v15, a99
  v_mul_f32 v14, v10, v14
  v_mul_f32 v15, v10, v15
  v_cvt_pk_bf16_f32 v177, v14, v15
  v_accvgpr_read_b32 v12, a100
  v_accvgpr_read_b32 v13, a101
  v_mul_f32 v12, v10, v12
  v_mul_f32 v13, v10, v13
  v_cvt_pk_bf16_f32 v178, v12, v13
  v_accvgpr_read_b32 v14, a102
  v_accvgpr_read_b32 v15, a103
  v_mul_f32 v14, v10, v14
  v_mul_f32 v15, v10, v15
  v_cvt_pk_bf16_f32 v179, v14, v15
  v_accvgpr_read_b32 v12, a104
  v_accvgpr_read_b32 v13, a105
  v_mul_f32 v12, v10, v12
  v_mul_f32 v13, v10, v13
  v_cvt_pk_bf16_f32 v184, v12, v13
  v_accvgpr_read_b32 v14, a106
  v_accvgpr_read_b32 v15, a107
  v_mul_f32 v14, v10, v14
  v_mul_f32 v15, v10, v15
  v_cvt_pk_bf16_f32 v185, v14, v15
  v_accvgpr_read_b32 v12, a108
  v_accvgpr_read_b32 v13, a109
  v_mul_f32 v12, v10, v12
  v_mul_f32 v13, v10, v13
  v_cvt_pk_bf16_f32 v186, v12, v13
  v_accvgpr_read_b32 v14, a110
  v_accvgpr_read_b32 v15, a111
  v_mul_f32 v14, v10, v14
  v_mul_f32 v15, v10, v15
  v_cvt_pk_bf16_f32 v187, v14, v15
  v_accvgpr_read_b32 v12, a112
  v_accvgpr_read_b32 v13, a113
  v_mul_f32 v12, v11, v12
  v_mul_f32 v13, v11, v13
  v_cvt_pk_bf16_f32 v180, v12, v13
  v_accvgpr_read_b32 v14, a114
  v_accvgpr_read_b32 v15, a115
  v_mul_f32 v14, v11, v14
  v_mul_f32 v15, v11, v15
  v_cvt_pk_bf16_f32 v181, v14, v15
  v_accvgpr_read_b32 v12, a116
  v_accvgpr_read_b32 v13, a117
  v_mul_f32 v12, v11, v12
  v_mul_f32 v13, v11, v13
  v_cvt_pk_bf16_f32 v182, v12, v13
  v_accvgpr_read_b32 v14, a118
  v_accvgpr_read_b32 v15, a119
  v_mul_f32 v14, v11, v14
  v_mul_f32 v15, v11, v15
  v_cvt_pk_bf16_f32 v183, v14, v15
  v_accvgpr_read_b32 v12, a120
  v_accvgpr_read_b32 v13, a121
  v_mul_f32 v12, v11, v12
  v_mul_f32 v13, v11, v13
  v_cvt_pk_bf16_f32 v188, v12, v13
  v_accvgpr_read_b32 v14, a122
  v_accvgpr_read_b32 v15, a123
  v_mul_f32 v14, v11, v14
  v_mul_f32 v15, v11, v15
  v_cvt_pk_bf16_f32 v189, v14, v15
  v_accvgpr_read_b32 v12, a124
  v_accvgpr_read_b32 v13, a125
  v_mul_f32 v12, v11, v12
  v_mul_f32 v13, v11, v13
  v_cvt_pk_bf16_f32 v190, v12, v13
  v_accvgpr_read_b32 v14, a126
  v_accvgpr_read_b32 v15, a127
  v_mul_f32 v14, v11, v14
  v_mul_f32 v15, v11, v15
  v_cvt_pk_bf16_f32 v191, v14, v15
  s_waitcnt lgkmcnt(0)
  v_mfma_f32_32x32x16_bf16 v[16:31], a[128:131], v[128:131], 0
  v_mul_f32 v56, v48, v56
  v_mul_f32 v48, v196, v48
  v_mul_f32 v57, v49, v57
  v_mul_f32 v49, v196, v49
  v_mul_f32 v58, v50, v58
  v_mul_f32 v50, v196, v50
  v_mul_f32 v59, v51, v59
  v_mul_f32 v51, v196, v51
  v_mul_f32 v60, v52, v60
  v_mfma_f32_32x32x16_bf16 v[32:47], a[128:131], v[132:135], 0
  v_mul_f32 v52, v196, v52
  v_mul_f32 v61, v53, v61
  v_mul_f32 v53, v196, v53
  v_mul_f32 v62, v54, v62
  v_mul_f32 v54, v196, v54
  v_mul_f32 v63, v55, v63
  v_mul_f32 v55, v196, v55
  v_exp_f32 v48, v48
  v_mfma_f32_32x32x16_bf16 v[16:31], a[132:135], v[136:139], v[16:31]
  v_exp_f32 v49, v49
  v_exp_f32 v50, v50
  v_exp_f32 v51, v51
  v_exp_f32 v52, v52
  v_exp_f32 v53, v53
  v_mfma_f32_32x32x16_bf16 v[32:47], a[132:135], v[140:143], v[32:47]
  v_exp_f32 v54, v54
  v_exp_f32 v55, v55
  v_fma_f32 v48, v48, v197, v197
  v_fma_f32 v49, v49, v197, v197
  v_fma_f32 v50, v50, v197, v197
  v_fma_f32 v51, v51, v197, v197
  v_fma_f32 v52, v52, v197, v197
  v_mfma_f32_32x32x16_bf16 v[16:31], a[136:139], v[144:147], v[16:31]
  v_fma_f32 v53, v53, v197, v197
  v_fma_f32 v54, v54, v197, v197
  v_fma_f32 v55, v55, v197, v197
  v_rcp_f32 v48, v48
  v_rcp_f32 v49, v49
  v_rcp_f32 v50, v50
  v_mfma_f32_32x32x16_bf16 v[32:47], a[136:139], v[148:151], v[32:47]
  v_rcp_f32 v51, v51
  v_rcp_f32 v52, v52
  v_rcp_f32 v53, v53
  v_rcp_f32 v54, v54
  v_rcp_f32 v55, v55
  v_mfma_f32_32x32x16_bf16 v[16:31], a[140:143], v[152:155], v[16:31]
  v_mul_f32 v48, v48, v56
  v_mul_f32 v49, v49, v57
  v_mul_f32 v50, v50, v58
  v_mul_f32 v51, v51, v59
  v_mul_f32 v52, v52, v60
  v_mul_f32 v53, v53, v61
  v_mul_f32 v54, v54, v62
  v_mul_f32 v55, v55, v63
  v_mfma_f32_32x32x16_bf16 v[32:47], a[140:143], v[156:159], v[32:47]
  s_lshl2_add_u32 s82, s6, s81
  s_lshl_b32 s82, s82, 10
  s_add_u32 s82, s82, 260096
  v_cvt_pk_bf16_f32 v56, v48, v49
  v_cvt_pk_bf16_f32 v57, v50, v51
  v_cvt_pk_bf16_f32 v58, v52, v53
  v_cvt_pk_bf16_f32 v59, v54, v55
  v_mfma_f32_32x32x16_bf16 v[16:31], a[144:147], v[160:163], v[16:31]
  buffer_store_dwordx4 v[56:59], v4, s[32:35], s82 offen sc1
  v_mul_f32 v72, v64, v72
  v_mul_f32 v64, v198, v64
  v_mul_f32 v73, v65, v73
  v_mul_f32 v65, v198, v65
  v_mul_f32 v74, v66, v74
  v_mul_f32 v66, v198, v66
  v_mul_f32 v75, v67, v75
  v_mul_f32 v67, v198, v67
  v_mfma_f32_32x32x16_bf16 v[32:47], a[144:147], v[164:167], v[32:47]
  v_mul_f32 v76, v68, v76
  v_mul_f32 v68, v198, v68
  v_mul_f32 v77, v69, v77
  v_mul_f32 v69, v198, v69
  v_mul_f32 v78, v70, v78
  v_mul_f32 v70, v198, v70
  v_mul_f32 v79, v71, v79
  v_mul_f32 v71, v198, v71
  v_mfma_f32_32x32x16_bf16 v[16:31], a[148:151], v[168:171], v[16:31]
  v_exp_f32 v64, v64
  v_exp_f32 v65, v65
  v_exp_f32 v66, v66
  v_exp_f32 v67, v67
  v_exp_f32 v68, v68
  v_mfma_f32_32x32x16_bf16 v[32:47], a[148:151], v[172:175], v[32:47]
  v_exp_f32 v69, v69
  v_exp_f32 v70, v70
  v_exp_f32 v71, v71
  v_fma_f32 v64, v64, v199, v199
  v_fma_f32 v65, v65, v199, v199
  v_fma_f32 v66, v66, v199, v199
  v_mfma_f32_32x32x16_bf16 v[16:31], a[152:155], v[176:179], v[16:31]
  v_fma_f32 v67, v67, v199, v199
  v_fma_f32 v68, v68, v199, v199
  v_fma_f32 v69, v69, v199, v199
  v_fma_f32 v70, v70, v199, v199
  v_fma_f32 v71, v71, v199, v199
  v_rcp_f32 v64, v64
  v_rcp_f32 v65, v65
  v_mfma_f32_32x32x16_bf16 v[32:47], a[152:155], v[180:183], v[32:47]
  v_rcp_f32 v66, v66
  v_rcp_f32 v67, v67
  v_rcp_f32 v68, v68
  v_rcp_f32 v69, v69
  v_rcp_f32 v70, v70
  v_mfma_f32_32x32x16_bf16 v[16:31], a[156:159], v[184:187], v[16:31]
  v_rcp_f32 v71, v71
  v_mul_f32 v64, v64, v72
  v_mul_f32 v65, v65, v73
  v_mul_f32 v66, v66, v74
  v_mul_f32 v67, v67, v75
  v_mul_f32 v68, v68, v76
  v_mul_f32 v69, v69, v77
  v_mul_f32 v70, v70, v78
  v_mfma_f32_32x32x16_bf16 v[32:47], a[156:159], v[188:191], v[32:47]
  v_mul_f32 v71, v71, v79
  v_cvt_pk_bf16_f32 v72, v64, v65
  v_cvt_pk_bf16_f32 v73, v66, v67
  v_cvt_pk_bf16_f32 v74, v68, v69
  v_cvt_pk_bf16_f32 v75, v70, v71
  buffer_store_dwordx4 v[72:75], v5, s[32:35], s82 offen sc1
  ds_read_b128 a[128:131], v242 offset:24576
  ds_read_b128 a[132:135], v243 offset:24576
  ds_read_b128 a[136:139], v244 offset:24576
  ds_read_b128 a[140:143], v245 offset:24576
  ds_read_b128 a[144:147], v246 offset:24576
  ds_read_b128 a[148:151], v247 offset:24576
  ds_read_b128 a[152:155], v248 offset:24576
  ds_read_b128 a[156:159], v249 offset:24576
  v_mul_f32 v88, v80, v88
  v_mul_f32 v80, v196, v80
  v_mul_f32 v89, v81, v89
  v_mul_f32 v81, v196, v81
  v_mul_f32 v90, v82, v90
  v_mul_f32 v82, v196, v82
  v_mul_f32 v91, v83, v91
  v_mul_f32 v83, v196, v83
  v_mul_f32 v92, v84, v92
  v_mul_f32 v84, v196, v84
  v_mul_f32 v93, v85, v93
  v_mul_f32 v85, v196, v85
  v_mul_f32 v94, v86, v94
  v_mul_f32 v86, v196, v86
  v_mul_f32 v95, v87, v95
  v_mul_f32 v87, v196, v87
  v_exp_f32 v80, v80
  v_exp_f32 v81, v81
  v_exp_f32 v82, v82
  v_exp_f32 v83, v83
  v_exp_f32 v84, v84
  v_exp_f32 v85, v85
  v_exp_f32 v86, v86
  v_exp_f32 v87, v87
  v_fma_f32 v80, v80, v197, v197
  v_fma_f32 v81, v81, v197, v197
  v_fma_f32 v82, v82, v197, v197
  v_fma_f32 v83, v83, v197, v197
  v_fma_f32 v84, v84, v197, v197
  v_fma_f32 v85, v85, v197, v197
  v_fma_f32 v86, v86, v197, v197
  v_fma_f32 v87, v87, v197, v197
  v_rcp_f32 v80, v80
  v_rcp_f32 v81, v81
  v_rcp_f32 v82, v82
  v_rcp_f32 v83, v83
  v_rcp_f32 v84, v84
  v_rcp_f32 v85, v85
  v_rcp_f32 v86, v86
  v_rcp_f32 v87, v87
  v_mul_f32 v80, v80, v88
  v_mul_f32 v81, v81, v89
  v_mul_f32 v82, v82, v90
  v_mul_f32 v83, v83, v91
  v_mul_f32 v84, v84, v92
  v_mul_f32 v85, v85, v93
  v_mul_f32 v86, v86, v94
  v_mul_f32 v87, v87, v95
  v_cvt_pk_bf16_f32 v88, v80, v81
  v_cvt_pk_bf16_f32 v89, v82, v83
  v_cvt_pk_bf16_f32 v90, v84, v85
  v_cvt_pk_bf16_f32 v91, v86, v87
  s_lshl2_add_u32 s82, s6, s81
  s_lshl_b32 s82, s82, 10
  s_add_u32 s82, s82, 261120
  buffer_store_dwordx4 v[88:91], v4, s[32:35], s82 offen sc1
  v_mul_f32 v104, v96, v104
  v_mul_f32 v96, v198, v96
  v_mul_f32 v105, v97, v105
  v_mul_f32 v97, v198, v97
  v_mul_f32 v106, v98, v106
  v_mul_f32 v98, v198, v98
  v_mul_f32 v107, v99, v107
  v_mul_f32 v99, v198, v99
  v_mul_f32 v108, v100, v108
  v_mul_f32 v100, v198, v100
  v_mul_f32 v109, v101, v109
  v_mul_f32 v101, v198, v101
  v_mul_f32 v110, v102, v110
  v_mul_f32 v102, v198, v102
  v_mul_f32 v111, v103, v111
  v_mul_f32 v103, v198, v103
  v_exp_f32 v96, v96
  v_exp_f32 v97, v97
  v_exp_f32 v98, v98
  v_exp_f32 v99, v99
  v_exp_f32 v100, v100
  v_exp_f32 v101, v101
  v_exp_f32 v102, v102
  v_exp_f32 v103, v103
  v_fma_f32 v96, v96, v199, v199
  v_fma_f32 v97, v97, v199, v199
  v_fma_f32 v98, v98, v199, v199
  v_fma_f32 v99, v99, v199, v199
  v_fma_f32 v100, v100, v199, v199
  v_fma_f32 v101, v101, v199, v199
  v_fma_f32 v102, v102, v199, v199
  v_fma_f32 v103, v103, v199, v199
  v_rcp_f32 v96, v96
  v_rcp_f32 v97, v97
  v_rcp_f32 v98, v98
  v_rcp_f32 v99, v99
  v_rcp_f32 v100, v100
  v_rcp_f32 v101, v101
  v_rcp_f32 v102, v102
  v_rcp_f32 v103, v103
  v_mul_f32 v96, v96, v104
  v_mul_f32 v97, v97, v105
  v_mul_f32 v98, v98, v106
  v_mul_f32 v99, v99, v107
  v_mul_f32 v100, v100, v108
  v_mul_f32 v101, v101, v109
  v_mul_f32 v102, v102, v110
  v_mul_f32 v103, v103, v111
  v_cvt_pk_bf16_f32 v104, v96, v97
  v_cvt_pk_bf16_f32 v105, v98, v99
  v_cvt_pk_bf16_f32 v106, v100, v101
  v_cvt_pk_bf16_f32 v107, v102, v103
  buffer_store_dwordx4 v[104:107], v5, s[32:35], s82 offen sc1
  s_add_u32 s16, s72, 0
  buffer_load_dword a205, v227, s[40:43], s16 offen
  v_mov_b32 v10, v227
  s_mov_b32 s14, s72
  s_mov_b32 s15, s73
  v_max3_f32 v12, v16, v17, v18
  v_max3_f32 v13, v19, v20, v21
  v_max3_f32 v12, v12, v22, v23
  v_max3_f32 v13, v13, v24, v25
  v_max3_f32 v12, v12, v26, v27
  v_max3_f32 v13, v13, v28, v29
  v_max3_f32 v12, v12, v30, v31
  v_max3_f32 v13, v13, v32, v33
  v_max3_f32 v12, v12, v34, v35
  v_max3_f32 v13, v13, v36, v37
  v_max3_f32 v12, v12, v38, v39
  v_max3_f32 v13, v13, v40, v41
  v_max3_f32 v12, v12, v42, v43
  v_max3_f32 v13, v13, v44, v45
  v_max3_f32 v12, v12, v46, v47
  v_max_f32 v12, v12, v13
  v_mov_b32 v13, v12
  s_nop 1
  v_permlane32_swap_b32 v12, v13
  v_max_f32 v12, v12, v13
  v_mul_f32 v112, -1.0, v12
  v_mul_f32 v113, -1.0, v12
  v_mul_f32 v114, -1.0, v12
  v_mul_f32 v115, -1.0, v12
  v_mul_f32 v116, -1.0, v12
  v_mul_f32 v117, -1.0, v12
  v_mul_f32 v118, -1.0, v12
  v_mul_f32 v119, -1.0, v12
  v_mul_f32 v120, -1.0, v12
  v_mul_f32 v121, -1.0, v12
  v_mul_f32 v122, -1.0, v12
  v_mul_f32 v123, -1.0, v12
  v_mul_f32 v124, -1.0, v12
  v_mul_f32 v125, -1.0, v12
  v_mul_f32 v126, -1.0, v12
  v_mul_f32 v127, -1.0, v12
  s_waitcnt lgkmcnt(0)
  s_nop 0
  v_mfma_f32_32x32x16_bf16 v[48:63], a[128:131], v[128:131], v[112:127]
  v_add_f32 v16, v112, v16
  v_add_f32 v17, v112, v17
  v_exp_f32 v16, v16
  v_exp_f32 v17, v17
  v_add_f32 v18, v112, v18
  v_add_f32 v19, v112, v19
  v_exp_f32 v18, v18
  v_mfma_f32_32x32x16_bf16 v[64:79], a[128:131], v[132:135], v[112:127]
  v_mov_b32 v192, v16
  v_mov_b32 v193, v17
  v_exp_f32 v19, v19
  v_cvt_pk_bf16_f32 v80, v16, v17
  v_add_f32 v20, v112, v20
  v_add_f32 v21, v112, v21
  v_exp_f32 v20, v20
  v_mfma_f32_32x32x16_bf16 v[48:63], a[132:135], v[136:139], v[48:63]
  v_add_f32 v192, v192, v18
  v_add_f32 v193, v193, v19
  v_exp_f32 v21, v21
  v_cvt_pk_bf16_f32 v81, v18, v19
  v_add_f32 v22, v112, v22
  v_add_f32 v23, v112, v23
  v_exp_f32 v22, v22
  v_mfma_f32_32x32x16_bf16 v[64:79], a[132:135], v[140:143], v[64:79]
  v_add_f32 v192, v192, v20
  v_add_f32 v193, v193, v21
  v_exp_f32 v23, v23
  v_cvt_pk_bf16_f32 v82, v20, v21
  v_add_f32 v24, v112, v24
  v_add_f32 v25, v112, v25
  v_exp_f32 v24, v24
  v_mfma_f32_32x32x16_bf16 v[48:63], a[136:139], v[144:147], v[48:63]
  v_add_f32 v192, v192, v22
  v_add_f32 v193, v193, v23
  v_exp_f32 v25, v25
  v_cvt_pk_bf16_f32 v83, v22, v23
  v_add_f32 v26, v112, v26
  v_add_f32 v27, v112, v27
  v_exp_f32 v26, v26
  v_add_f32 v192, v192, v24
  v_mfma_f32_32x32x16_bf16 v[64:79], a[136:139], v[148:151], v[64:79]
  v_add_f32 v193, v193, v25
  v_exp_f32 v27, v27
  v_cvt_pk_bf16_f32 v84, v24, v25
  v_add_f32 v28, v112, v28
  v_add_f32 v29, v112, v29
  v_exp_f32 v28, v28
  v_add_f32 v192, v192, v26
  v_mfma_f32_32x32x16_bf16 v[48:63], a[140:143], v[152:155], v[48:63]
  v_add_f32 v193, v193, v27
  v_exp_f32 v29, v29
  v_cvt_pk_bf16_f32 v85, v26, v27
  v_add_f32 v30, v112, v30
  v_add_f32 v31, v112, v31
  v_exp_f32 v30, v30
  v_add_f32 v192, v192, v28
  v_mfma_f32_32x32x16_bf16 v[64:79], a[140:143], v[156:159], v[64:79]
  v_add_f32 v193, v193, v29
  v_exp_f32 v31, v31
  v_cvt_pk_bf16_f32 v86, v28, v29
  v_add_f32 v32, v112, v32
  v_add_f32 v33, v112, v33
  v_exp_f32 v32, v32
  v_mfma_f32_32x32x16_bf16 v[48:63], a[144:147], v[160:163], v[48:63]
  s_add_u32 s16, s14, 2048
  buffer_load_dword a205, v10, s[40:43], s16 offen
  v_add_f32 v192, v192, v30
  v_add_f32 v193, v193, v31
  v_exp_f32 v33, v33
  v_cvt_pk_bf16_f32 v87, v30, v31
  v_add_f32 v34, v112, v34
  v_mfma_f32_32x32x16_bf16 v[64:79], a[144:147], v[164:167], v[64:79]
  v_add_f32 v35, v112, v35
  v_exp_f32 v34, v34
  v_mov_b32 v194, v32
  v_mov_b32 v195, v33
  v_exp_f32 v35, v35
  v_cvt_pk_bf16_f32 v88, v32, v33
  v_add_f32 v36, v112, v36
  v_mfma_f32_32x32x16_bf16 v[48:63], a[148:151], v[168:171], v[48:63]
  v_add_f32 v37, v112, v37
  v_exp_f32 v36, v36
  v_add_f32 v194, v194, v34
  v_add_f32 v195, v195, v35
  v_exp_f32 v37, v37
  v_cvt_pk_bf16_f32 v89, v34, v35
  v_add_f32 v38, v112, v38
  v_mfma_f32_32x32x16_bf16 v[64:79], a[148:151], v[172:175], v[64:79]
  v_add_f32 v39, v112, v39
  v_exp_f32 v38, v38
  v_add_f32 v194, v194, v36
  v_add_f32 v195, v195, v37
  v_exp_f32 v39, v39
  v_cvt_pk_bf16_f32 v90, v36, v37
  v_add_f32 v40, v112, v40
  v_add_f32 v41, v112, v41
  v_mfma_f32_32x32x16_bf16 v[48:63], a[152:155], v[176:179], v[48:63]
  v_exp_f32 v40, v40
  v_add_f32 v194, v194, v38
  v_add_f32 v195, v195, v39
  v_exp_f32 v41, v41
  v_cvt_pk_bf16_f32 v91, v38, v39
  v_add_f32 v42, v112, v42
  v_add_f32 v43, v112, v43
  v_mfma_f32_32x32x16_bf16 v[64:79], a[152:155], v[180:183], v[64:79]
  v_exp_f32 v42, v42
  v_add_f32 v194, v194, v40
  v_add_f32 v195, v195, v41
  v_exp_f32 v43, v43
  v_cvt_pk_bf16_f32 v92, v40, v41
  v_add_f32 v44, v112, v44
  v_add_f32 v45, v112, v45
  v_mfma_f32_32x32x16_bf16 v[48:63], a[156:159], v[184:187], v[48:63]
  v_exp_f32 v44, v44
  v_add_f32 v194, v194, v42
  v_add_f32 v195, v195, v43
  v_exp_f32 v45, v45
  v_cvt_pk_bf16_f32 v93, v42, v43
  v_add_f32 v46, v112, v46
  v_add_f32 v47, v112, v47
  v_mfma_f32_32x32x16_bf16 v[64:79], a[156:159], v[188:191], v[64:79]
  ds_read_b128 a[128:131], v242 offset:32768
  ds_read_b128 a[132:135], v243 offset:32768
  ds_read_b128 a[136:139], v244 offset:32768
  ds_read_b128 a[140:143], v245 offset:32768
  ds_read_b128 a[144:147], v246 offset:32768
  ds_read_b128 a[148:151], v247 offset:32768
  ds_read_b128 a[152:155], v248 offset:32768
  ds_read_b128 a[156:159], v249 offset:32768
  v_exp_f32 v46, v46
  v_add_f32 v194, v194, v44
  v_add_f32 v195, v195, v45
  v_exp_f32 v47, v47
  v_cvt_pk_bf16_f32 v94, v44, v45
  v_add_f32 v194, v194, v46
  v_add_f32 v195, v195, v47
  v_cvt_pk_bf16_f32 v95, v46, v47
  s_waitcnt lgkmcnt(7)
  v_mfma_f32_32x32x16_bf16 v[16:31], a[128:131], v[128:131], v[112:127]
  ds_read_b64_tr_b16 a[160:161], v250 offset:16384
  v_exp_f32 v48, v48
  v_accvgpr_read_b32 v204, a208
  v_exp_f32 v49, v49
  v_mfma_f32_32x32x16_bf16 v[32:47], a[128:131], v[132:135], v[112:127]
  ds_read_b64_tr_b16 a[162:163], v250 offset:18432
  v_accvgpr_read_b32 v208, a216
  v_exp_f32 v50, v50
  v_add_f32 v192, v192, v48
  v_accvgpr_read_b32 v205, a209
  v_add_f32 v193, v193, v49
  s_waitcnt lgkmcnt(8)
  v_mfma_f32_32x32x16_bf16 v[16:31], a[132:135], v[136:139], v[16:31]
  ds_read_b64_tr_b16 a[164:165], v250 offset:20480
  ds_read_b64_tr_b16 a[166:167], v250 offset:22528
  v_accvgpr_read_b32 v209, a217
  v_exp_f32 v51, v51
  v_cvt_pk_bf16_f32 v96, v48, v49
  v_mfma_f32_32x32x16_bf16 v[32:47], a[132:135], v[140:143], v[32:47]
  ds_read_b64_tr_b16 a[168:169], v251 offset:16384
  v_accvgpr_read_b32 v206, a210
  v_exp_f32 v52, v52
  v_add_f32 v192, v192, v50
  v_accvgpr_read_b32 v210, a218
  s_waitcnt lgkmcnt(5)
  v_mfma_f32_32x32x16_bf16 v[16:31], a[136:139], v[144:147], v[16:31]
  ds_read_b64_tr_b16 a[170:171], v251 offset:18432
  v_add_f32 v193, v193, v51
  v_accvgpr_read_b32 v207, a211
  v_exp_f32 v53, v53
  v_cvt_pk_bf16_f32 v97, v50, v51
  v_mfma_f32_32x32x16_bf16 v[32:47], a[136:139], v[148:151], v[32:47]
  ds_read_b64_tr_b16 a[172:173], v251 offset:20480
  ds_read_b64_tr_b16 a[174:175], v251 offset:22528
  v_accvgpr_read_b32 v211, a219
  v_exp_f32 v54, v54
  v_mul_f32 v208, v204, v208
  v_add_f32 v192, v192, v52
  v_mfma_f32_32x32x16_bf16 v[16:31], a[140:143], v[152:155], v[16:31]
  ds_read_b64_tr_b16 a[176:177], v252 offset:16384
  v_add_f32 v193, v193, v53
  v_mul_f32 v204, v196, v204
  v_exp_f32 v55, v55
  v_mul_f32 v209, v205, v209
  v_mfma_f32_32x32x16_bf16 v[32:47], a[140:143], v[156:159], v[32:47]
  ds_read_b64_tr_b16 a[178:179], v252 offset:18432
  v_cvt_pk_bf16_f32 v98, v52, v53
  v_exp_f32 v56, v56
  v_mfma_f32_32x32x16_bf16 v[16:31], a[144:147], v[160:163], v[16:31]
  s_add_u32 s16, s14, 4096
  buffer_load_dword a205, v10, s[40:43], s16 offen
  v_mul_f32 v205, v196, v205
  v_add_f32 v192, v192, v54
  v_add_f32 v193, v193, v55
  v_mfma_f32_32x32x16_bf16 v[32:47], a[144:147], v[164:167], v[32:47]
  ds_read_b64_tr_b16 a[180:181], v252 offset:20480
  ds_read_b64_tr_b16 a[182:183], v252 offset:22528
  v_mul_f32 v210, v206, v210
  v_exp_f32 v57, v57
  v_mul_f32 v206, v196, v206
  v_cvt_pk_bf16_f32 v99, v54, v55
  v_mfma_f32_32x32x16_bf16 v[16:31], a[148:151], v[168:171], v[16:31]
  ds_read_b64_tr_b16 a[184:185], v253 offset:16384
  v_exp_f32 v58, v58
  v_mul_f32 v211, v207, v211
  v_add_f32 v192, v192, v56
  v_mul_f32 v207, v196, v207
  v_mfma_f32_32x32x16_bf16 v[32:47], a[148:151], v[172:175], v[32:47]
  ds_read_b64_tr_b16 a[186:187], v253 offset:18432
  v_add_f32 v193, v193, v57
  v_exp_f32 v59, v59
  v_exp_f32 v204, v204
  v_mfma_f32_32x32x16_bf16 v[16:31], a[152:155], v[176:179], v[16:31]
  ds_read_b64_tr_b16 a[188:189], v253 offset:20480
  v_cvt_pk_bf16_f32 v100, v56, v57
  v_exp_f32 v205, v205
  v_exp_f32 v60, v60
  v_mfma_f32_32x32x16_bf16 v[32:47], a[152:155], v[180:183], v[32:47]
  ds_read_b64_tr_b16 a[190:191], v253 offset:22528
  v_add_f32 v192, v192, v58
  v_exp_f32 v206, v206
  v_add_f32 v193, v193, v59
  v_exp_f32 v61, v61
  v_mfma_f32_32x32x16_bf16 v[16:31], a[156:159], v[184:187], v[16:31]
  v_exp_f32 v207, v207
  v_cvt_pk_bf16_f32 v101, v58, v59
  v_fma_f32 v204, v204, v197, v197
  v_exp_f32 v62, v62
  v_mfma_f32_32x32x16_bf16 v[32:47], a[156:159], v[188:191], v[32:47]
  v_add_f32 v192, v192, v60
  v_fma_f32 v205, v205, v197, v197
  v_add_f32 v193, v193, v61
  v_fma_f32 v206, v206, v197, v197
  v_exp_f32 v63, v63
  s_waitcnt lgkmcnt(3)
  v_mfma_f32_32x32x16_bf16 a[0:15], a[160:163], v[80:83], 0
  ds_read_b128 a[128:131], v242 offset:40960
  v_cvt_pk_bf16_f32 v102, v60, v61
  v_fma_f32 v207, v207, v197, v197
  v_exp_f32 v64, v64
  v_add_f32 v192, v192, v62
  v_mfma_f32_32x32x16_bf16 a[16:31], a[160:163], v[88:91], 0
  v_rcp_f32 v204, v204
  v_add_f32 v193, v193, v63
  v_exp_f32 v65, v65
  v_mfma_f32_32x32x16_bf16 a[0:15], a[164:167], v[84:87], a[0:15]
  v_rcp_f32 v205, v205
  v_cvt_pk_bf16_f32 v103, v62, v63
  v_exp_f32 v66, v66
  v_rcp_f32 v206, v206
  v_mfma_f32_32x32x16_bf16 a[16:31], a[164:167], v[92:95], a[16:31]
  ds_read_b128 a[132:135], v243 offset:40960
  v_add_f32 v194, v194, v64
  v_add_f32 v195, v195, v65
  v_rcp_f32 v207, v207
  v_mfma_f32_32x32x16_bf16 a[32:47], a[168:171], v[80:83], 0
  v_exp_f32 v67, v67
  v_cvt_pk_bf16_f32 v104, v64, v65
  v_mul_f32 v204, v204, v208
  v_exp_f32 v68, v68
  v_mul_f32 v205, v205, v209
  v_mfma_f32_32x32x16_bf16 a[48:63], a[168:171], v[88:91], 0
  ds_read_b128 a[136:139], v244 offset:40960
  v_add_f32 v194, v194, v66
  v_add_f32 v195, v195, v67
  v_mul_f32 v206, v206, v210
  v_exp_f32 v69, v69
  v_mfma_f32_32x32x16_bf16 a[32:47], a[172:175], v[84:87], a[32:47]
  v_cvt_pk_bf16_f32 v105, v66, v67
  v_mul_f32 v207, v207, v211
  v_exp_f32 v70, v70
  v_add_f32 v194, v194, v68
  v_cvt_pk_bf16_f32 v200, v204, v205
  v_mfma_f32_32x32x16_bf16 a[48:63], a[172:175], v[92:95], a[48:63]
  ds_read_b128 a[140:143], v245 offset:40960
  v_add_f32 v195, v195, v69
  v_exp_f32 v71, v71
  v_cvt_pk_bf16_f32 v201, v206, v207
  v_cvt_pk_bf16_f32 v106, v68, v69
  v_mfma_f32_32x32x16_bf16 a[64:79], a[176:179], v[80:83], 0
  v_exp_f32 v72, v72
  v_accvgpr_read_b32 v204, a212
  v_add_f32 v194, v194, v70
  v_add_f32 v195, v195, v71
  v_mfma_f32_32x32x16_bf16 a[80:95], a[176:179], v[88:91], 0
  ds_read_b128 a[144:147], v246 offset:40960
  v_accvgpr_read_b32 v208, a220
  v_exp_f32 v73, v73
  v_cvt_pk_bf16_f32 v107, v70, v71
  v_accvgpr_read_b32 v205, a213
  v_mfma_f32_32x32x16_bf16 a[64:79], a[180:183], v[84:87], a[64:79]
  v_exp_f32 v74, v74
  v_add_f32 v194, v194, v72
  v_accvgpr_read_b32 v209, a221
  v_add_f32 v195, v195, v73
  v_exp_f32 v75, v75
  v_mfma_f32_32x32x16_bf16 a[80:95], a[180:183], v[92:95], a[80:95]
  ds_read_b128 a[148:151], v247 offset:40960
  v_accvgpr_read_b32 v206, a214
  v_cvt_pk_bf16_f32 v108, v72, v73
  v_exp_f32 v76, v76
  s_waitcnt lgkmcnt(3)
  v_mfma_f32_32x32x16_bf16 a[96:111], a[184:187], v[80:83], 0
  v_accvgpr_read_b32 v210, a222
  v_add_f32 v194, v194, v74
  v_accvgpr_read_b32 v207, a215
  v_add_f32 v195, v195, v75
  v_exp_f32 v77, v77
  v_mfma_f32_32x32x16_bf16 a[112:127], a[184:187], v[88:91], 0
  ds_read_b128 a[152:155], v248 offset:40960
  v_accvgpr_read_b32 v211, a223
  v_cvt_pk_bf16_f32 v109, v74, v75
  v_exp_f32 v78, v78
  v_mul_f32 v208, v204, v208
  v_mfma_f32_32x32x16_bf16 a[96:111], a[188:191], v[84:87], a[96:111]
  v_add_f32 v194, v194, v76
  v_add_f32 v195, v195, v77
  v_mul_f32 v204, v196, v204
  v_exp_f32 v79, v79
  v_cvt_pk_bf16_f32 v110, v76, v77
  v_mfma_f32_32x32x16_bf16 a[112:127], a[188:191], v[92:95], a[112:127]
  ds_read_b128 a[156:159], v249 offset:40960
  v_mul_f32 v209, v205, v209
  v_add_f32 v194, v194, v78
  v_add_f32 v195, v195, v79
  v_mul_f32 v205, v196, v205
  v_cvt_pk_bf16_f32 v111, v78, v79
  v_mfma_f32_32x32x16_bf16 v[48:63], a[128:131], v[128:131], v[112:127]
  ds_read_b64_tr_b16 a[160:161], v250 offset:24576
  v_exp_f32 v16, v16
  v_mul_f32 v210, v206, v210
  v_exp_f32 v17, v17
  v_mul_f32 v206, v196, v206
  v_mfma_f32_32x32x16_bf16 v[64:79], a[128:131], v[132:135], v[112:127]
  ds_read_b64_tr_b16 a[162:163], v250 offset:26624
  v_exp_f32 v18, v18
  v_add_f32 v192, v192, v16
  v_mul_f32 v211, v207, v211
  v_add_f32 v193, v193, v17
  v_mfma_f32_32x32x16_bf16 v[48:63], a[132:135], v[136:139], v[48:63]
  ds_read_b64_tr_b16 a[164:165], v250 offset:28672
  ds_read_b64_tr_b16 a[166:167], v250 offset:30720
  v_mul_f32 v207, v196, v207
  v_exp_f32 v19, v19
  v_cvt_pk_bf16_f32 v80, v16, v17
  v_exp_f32 v204, v204
  v_mfma_f32_32x32x16_bf16 v[64:79], a[132:135], v[140:143], v[64:79]
  ds_read_b64_tr_b16 a[168:169], v251 offset:24576
  v_exp_f32 v20, v20
  v_add_f32 v192, v192, v18
  v_exp_f32 v205, v205
  v_mfma_f32_32x32x16_bf16 v[48:63], a[136:139], v[144:147], v[48:63]
  ds_read_b64_tr_b16 a[170:171], v251 offset:26624
  v_add_f32 v193, v193, v19
  v_exp_f32 v206, v206
  v_exp_f32 v21, v21
  v_mfma_f32_32x32x16_bf16 v[64:79], a[136:139], v[148:151], v[64:79]
  ds_read_b64_tr_b16 a[172:173], v251 offset:28672
  v_cvt_pk_bf16_f32 v81, v18, v19
  v_exp_f32 v207, v207
  v_exp_f32 v22, v22
  v_fma_f32 v204, v204, v197, v197
  s_waitcnt lgkmcnt(5)
  v_mfma_f32_32x32x16_bf16 v[48:63], a[140:143], v[152:155], v[48:63]
  ds_read_b64_tr_b16 a[174:175], v251 offset:30720
  ds_read_b64_tr_b16 a[176:177], v252 offset:24576
  v_add_f32 v192, v192, v20
  v_add_f32 v193, v193, v21
  v_fma_f32 v205, v205, v197, v197
  v_exp_f32 v23, v23
  v_mfma_f32_32x32x16_bf16 v[64:79], a[140:143], v[156:159], v[64:79]
  ds_read_b64_tr_b16 a[178:179], v252 offset:26624
  v_fma_f32 v206, v206, v197, v197
  v_cvt_pk_bf16_f32 v82, v20, v21
  v_exp_f32 v24, v24
  v_mfma_f32_32x32x16_bf16 v[48:63], a[144:147], v[160:163], v[48:63]
  s_add_u32 s16, s15, 0
  buffer_load_dword a205, v10, s[36:39], s16 offen
  v_fma_f32 v207, v207, v197, v197
  v_add_f32 v192, v192, v22
  v_add_f32 v193, v193, v23
  v_mfma_f32_32x32x16_bf16 v[64:79], a[144:147], v[164:167], v[64:79]
  ds_read_b64_tr_b16 a[180:181], v252 offset:28672
  v_rcp_f32 v204, v204
  v_exp_f32 v25, v25
  v_rcp_f32 v205, v205
  v_mfma_f32_32x32x16_bf16 v[48:63], a[148:151], v[168:171], v[48:63]
  ds_read_b64_tr_b16 a[182:183], v252 offset:30720
  v_cvt_pk_bf16_f32 v83, v22, v23
  v_exp_f32 v26, v26
  v_rcp_f32 v206, v206
  v_add_f32 v192, v192, v24
  v_mfma_f32_32x32x16_bf16 v[64:79], a[148:151], v[172:175], v[64:79]
  ds_read_b64_tr_b16 a[184:185], v253 offset:24576
  v_rcp_f32 v207, v207
  v_add_f32 v193, v193, v25
  v_exp_f32 v27, v27
  v_mfma_f32_32x32x16_bf16 v[48:63], a[152:155], v[176:179], v[48:63]
  ds_read_b64_tr_b16 a[186:187], v253 offset:26624
  ds_read_b64_tr_b16 a[188:189], v253 offset:28672
  v_mul_f32 v204, v204, v208
  v_cvt_pk_bf16_f32 v84, v24, v25
  v_mul_f32 v205, v205, v209
  v_exp_f32 v28, v28
  v_mfma_f32_32x32x16_bf16 v[64:79], a[152:155], v[180:183], v[64:79]
  ds_read_b64_tr_b16 a[190:191], v253 offset:30720
  v_add_f32 v192, v192, v26
  v_mul_f32 v206, v206, v210
  v_add_f32 v193, v193, v27
  v_exp_f32 v29, v29
  v_mul_f32 v207, v207, v211
  v_mfma_f32_32x32x16_bf16 v[48:63], a[156:159], v[184:187], v[48:63]
  v_cvt_pk_bf16_f32 v85, v26, v27
  v_cvt_pk_bf16_f32 v202, v204, v205
  v_exp_f32 v30, v30
  v_add_f32 v192, v192, v28
  v_cvt_pk_bf16_f32 v203, v206, v207
  v_mfma_f32_32x32x16_bf16 v[64:79], a[156:159], v[188:191], v[64:79]
  buffer_store_dwordx4 v[200:203], v4, s[32:35], s12 offen sc1
  v_add_f32 v193, v193, v29
  v_exp_f32 v31, v31
  v_mfma_f32_32x32x16_bf16 a[0:15], a[160:163], v[96:99], a[0:15]
  s_waitcnt vmcnt(13) lgkmcnt(0)
  s_barrier
  v_mfma_f32_32x32x16_bf16 a[16:31], a[160:163], v[104:107], a[16:31]
  v_cvt_pk_bf16_f32 v86, v28, v29
  v_accvgpr_read_b32 v204, a224
  v_exp_f32 v32, v32
  v_add_f32 v192, v192, v30
  v_xor_b32 v242, 0x10000, v242
  v_accvgpr_read_b32 v208, a232
  v_mfma_f32_32x32x16_bf16 a[0:15], a[164:167], v[100:103], a[0:15]
  ds_read_b128 a[128:131], v242 offset:16384
  s_add_u32 m0, s77, 16384
  s_mov_b32 s76, 65536
  buffer_load_dwordx4 v237, s[24:27], s76 offen lds
  v_add_f32 v193, v193, v31
  v_exp_f32 v33, v33
  v_accvgpr_read_b32 v205, a225
  v_cvt_pk_bf16_f32 v87, v30, v31
  v_mfma_f32_32x32x16_bf16 a[16:31], a[164:167], v[108:111], a[16:31]
  v_exp_f32 v34, v34
  v_accvgpr_read_b32 v209, a233
  v_add_f32 v194, v194, v32
  v_xor_b32 v243, 0x10000, v243
  v_mfma_f32_32x32x16_bf16 a[32:47], a[168:171], v[96:99], a[32:47]
  ds_read_b128 a[132:135], v243 offset:16384
  v_add_f32 v195, v195, v33
  v_accvgpr_read_b32 v206, a226
  v_exp_f32 v35, v35
  v_cvt_pk_bf16_f32 v88, v32, v33
  v_accvgpr_read_b32 v210, a234
  v_exp_f32 v36, v36
  v_mfma_f32_32x32x16_bf16 a[48:63], a[168:171], v[104:107], a[48:63]
  v_accvgpr_read_b32 v207, a227
  v_add_f32 v194, v194, v34
  v_add_f32 v195, v195, v35
  v_xor_b32 v244, 0x10000, v244
  v_accvgpr_read_b32 v211, a235
  v_exp_f32 v37, v37
  v_mfma_f32_32x32x16_bf16 a[32:47], a[172:175], v[100:103], a[32:47]
  ds_read_b128 a[136:139], v244 offset:16384
  buffer_load_dwordx4 v238, s[24:27], s76 offen offset:1024 lds
  v_cvt_pk_bf16_f32 v89, v34, v35
  v_mul_f32 v208, v204, v208
  v_exp_f32 v38, v38
  v_mfma_f32_32x32x16_bf16 a[48:63], a[172:175], v[108:111], a[48:63]
  v_add_f32 v194, v194, v36
  v_mul_f32 v204, v198, v204
  v_add_f32 v195, v195, v37
  v_xor_b32 v245, 0x10000, v245
  v_exp_f32 v39, v39
  v_mfma_f32_32x32x16_bf16 a[64:79], a[176:179], v[96:99], a[64:79]
  ds_read_b128 a[140:143], v245 offset:16384
  v_mul_f32 v209, v205, v209
  v_cvt_pk_bf16_f32 v90, v36, v37
  v_exp_f32 v40, v40
  v_mul_f32 v205, v198, v205
  v_add_f32 v194, v194, v38
  v_add_f32 v195, v195, v39
  v_mul_f32 v210, v206, v210
  v_mfma_f32_32x32x16_bf16 a[80:95], a[176:179], v[104:107], a[80:95]
  v_exp_f32 v41, v41
  v_xor_b32 v246, 0x10000, v246
  v_cvt_pk_bf16_f32 v91, v38, v39
  v_mul_f32 v206, v198, v206
  v_exp_f32 v42, v42
  v_add_f32 v194, v194, v40
  v_mfma_f32_32x32x16_bf16 a[64:79], a[180:183], v[100:103], a[64:79]
  ds_read_b128 a[144:147], v246 offset:16384
  buffer_load_dwordx4 v239, s[24:27], s76 offen offset:2048 lds
  v_mul_f32 v211, v207, v211
  v_add_f32 v195, v195, v41
  v_exp_f32 v43, v43
  v_mfma_f32_32x32x16_bf16 a[80:95], a[180:183], v[108:111], a[80:95]
  v_mul_f32 v207, v198, v207
  v_xor_b32 v247, 0x10000, v247
  v_cvt_pk_bf16_f32 v92, v40, v41
  v_exp_f32 v44, v44
  v_exp_f32 v204, v204
  v_mfma_f32_32x32x16_bf16 a[96:111], a[184:187], v[96:99], a[96:111]
  ds_read_b128 a[148:151], v247 offset:16384
  v_add_f32 v194, v194, v42
  v_exp_f32 v205, v205
  v_add_f32 v195, v195, v43
  v_exp_f32 v45, v45
  v_exp_f32 v206, v206
  v_mfma_f32_32x32x16_bf16 a[112:127], a[184:187], v[104:107], a[112:127]
  v_cvt_pk_bf16_f32 v93, v42, v43
  v_xor_b32 v248, 0x10000, v248
  v_exp_f32 v46, v46
  v_exp_f32 v207, v207
  v_add_f32 v194, v194, v44
  v_mfma_f32_32x32x16_bf16 a[96:111], a[188:191], v[100:103], a[96:111]
  ds_read_b128 a[152:155], v248 offset:16384
  buffer_load_dwordx4 v240, s[24:27], s76 offen offset:3072 lds
  v_add_f32 v195, v195, v45
  v_fma_f32 v204, v204, v199, v199
  v_exp_f32 v47, v47
  v_mfma_f32_32x32x16_bf16 a[112:127], a[188:191], v[108:111], a[112:127]
  v_cvt_pk_bf16_f32 v94, v44, v45
  v_fma_f32 v205, v205, v199, v199
  v_xor_b32 v249, 0x10000, v249
  v_add_f32 v194, v194, v46
  v_add_f32 v195, v195, v47
  v_fma_f32 v206, v206, v199, v199
  v_cvt_pk_bf16_f32 v95, v46, v47
  s_waitcnt lgkmcnt(2)
  v_mfma_f32_32x32x16_bf16 v[16:31], a[128:131], v[128:131], v[112:127]
  ds_read_b128 a[156:159], v249 offset:16384
  ds_read_b64_tr_b16 a[160:161], v212 offset:0
  v_exp_f32 v48, v48
  v_fma_f32 v207, v207, v199, v199
  v_exp_f32 v49, v49
  v_rcp_f32 v204, v204
  v_mfma_f32_32x32x16_bf16 v[32:47], a[128:131], v[132:135], v[112:127]
  ds_read_b64_tr_b16 a[162:163], v212 offset:2048
  v_exp_f32 v50, v50
  v_add_f32 v192, v192, v48
  v_rcp_f32 v205, v205
  v_mfma_f32_32x32x16_bf16 v[16:31], a[132:135], v[136:139], v[16:31]
  s_add_u32 m0, s77, 32768
  s_mov_b32 s76, 81920
  buffer_load_dwordx4 v237, s[24:27], s76 offen lds
  v_add_f32 v193, v193, v49
  v_mfma_f32_32x32x16_bf16 v[32:47], a[132:135], v[140:143], v[32:47]
  ds_read_b64_tr_b16 a[164:165], v212 offset:4096
  ds_read_b64_tr_b16 a[166:167], v212 offset:6144
  v_rcp_f32 v206, v206
  v_exp_f32 v51, v51
  v_cvt_pk_bf16_f32 v96, v48, v49
  v_mfma_f32_32x32x16_bf16 v[16:31], a[136:139], v[144:147], v[16:31]
  ds_read_b64_tr_b16 a[168:169], v213 offset:0
  v_rcp_f32 v207, v207
  v_exp_f32 v52, v52
  v_add_f32 v192, v192, v50
  v_mul_f32 v204, v204, v208
  v_mfma_f32_32x32x16_bf16 v[32:47], a[136:139], v[148:151], v[32:47]
  ds_read_b64_tr_b16 a[170:171], v213 offset:2048
  v_add_f32 v193, v193, v51
  v_mul_f32 v205, v205, v209
  v_exp_f32 v53, v53
  v_cvt_pk_bf16_f32 v97, v50, v51
  v_mul_f32 v206, v206, v210
  v_mfma_f32_32x32x16_bf16 v[16:31], a[140:143], v[152:155], v[16:31]
  ds_read_b64_tr_b16 a[172:173], v213 offset:4096
  buffer_load_dwordx4 v238, s[24:27], s76 offen offset:1024 lds
  v_exp_f32 v54, v54
  v_mul_f32 v207, v207, v211
  v_add_f32 v192, v192, v52
  v_mfma_f32_32x32x16_bf16 v[32:47], a[140:143], v[156:159], v[32:47]
  ds_read_b64_tr_b16 a[174:175], v213 offset:6144
  ds_read_b64_tr_b16 a[176:177], v214 offset:0
  v_add_f32 v193, v193, v53
  v_cvt_pk_bf16_f32 v200, v204, v205
  v_exp_f32 v55, v55
  v_mfma_f32_32x32x16_bf16 v[16:31], a[144:147], v[160:163], v[16:31]
  ds_read_b64_tr_b16 a[178:179], v214 offset:2048
  v_cvt_pk_bf16_f32 v201, v206, v207
  v_cvt_pk_bf16_f32 v98, v52, v53
  v_exp_f32 v56, v56
  v_accvgpr_read_b32 v204, a228
  v_add_f32 v192, v192, v54
  v_mfma_f32_32x32x16_bf16 v[32:47], a[144:147], v[164:167], v[32:47]
  ds_read_b64_tr_b16 a[180:181], v214 offset:4096
  v_add_f32 v193, v193, v55
  v_accvgpr_read_b32 v208, a236
  v_exp_f32 v57, v57
  v_accvgpr_read_b32 v205, a229
  v_cvt_pk_bf16_f32 v99, v54, v55
  s_waitcnt lgkmcnt(5)
  v_mfma_f32_32x32x16_bf16 v[16:31], a[148:151], v[168:171], v[16:31]
  ds_read_b64_tr_b16 a[182:183], v214 offset:6144
  buffer_load_dwordx4 v239, s[24:27], s76 offen offset:2048 lds
  v_exp_f32 v58, v58
  v_mfma_f32_32x32x16_bf16 v[32:47], a[148:151], v[172:175], v[32:47]
  ds_read_b64_tr_b16 a[184:185], v215 offset:0
  v_accvgpr_read_b32 v209, a237
  v_add_f32 v192, v192, v56
  v_accvgpr_read_b32 v206, a230
  v_add_f32 v193, v193, v57
  v_exp_f32 v59, v59
  v_mfma_f32_32x32x16_bf16 v[16:31], a[152:155], v[176:179], v[16:31]
  ds_read_b64_tr_b16 a[186:187], v215 offset:2048
  ds_read_b64_tr_b16 a[188:189], v215 offset:4096
  v_accvgpr_read_b32 v210, a238
  v_cvt_pk_bf16_f32 v100, v56, v57
  v_accvgpr_read_b32 v207, a231
  v_exp_f32 v60, v60
  v_mfma_f32_32x32x16_bf16 v[32:47], a[152:155], v[180:183], v[32:47]
  ds_read_b64_tr_b16 a[190:191], v215 offset:6144
  v_add_f32 v192, v192, v58
  v_accvgpr_read_b32 v211, a239
  v_add_f32 v193, v193, v59
  v_exp_f32 v61, v61
  v_mul_f32 v208, v204, v208
  v_mfma_f32_32x32x16_bf16 v[16:31], a[156:159], v[184:187], v[16:31]
  buffer_load_dwordx4 v240, s[24:27], s76 offen offset:3072 lds
  v_cvt_pk_bf16_f32 v101, v58, v59
  v_mul_f32 v204, v198, v204
  v_mfma_f32_32x32x16_bf16 v[32:47], a[156:159], v[188:191], v[32:47]
  v_exp_f32 v62, v62
  v_add_f32 v192, v192, v60
  v_mul_f32 v209, v205, v209
  v_add_f32 v193, v193, v61
  v_mul_f32 v205, v198, v205
  v_exp_f32 v63, v63
  v_mfma_f32_32x32x16_bf16 a[0:15], a[160:163], v[80:83], a[0:15]
  ds_read_b128 a[128:131], v242 offset:24576
  v_cvt_pk_bf16_f32 v102, v60, v61
  v_mul_f32 v210, v206, v210
  v_exp_f32 v64, v64
  v_add_f32 v192, v192, v62
  v_mul_f32 v206, v198, v206
  v_add_f32 v193, v193, v63
  v_mfma_f32_32x32x16_bf16 a[16:31], a[160:163], v[88:91], a[16:31]
  s_add_u32 m0, s77, 65536
  s_mov_b32 s76, 65536
  buffer_load_dwordx4 v241, s[28:31], s76 offen lds
  v_exp_f32 v65, v65
  v_mul_f32 v211, v207, v211
  v_cvt_pk_bf16_f32 v103, v62, v63
  v_mfma_f32_32x32x16_bf16 a[0:15], a[164:167], v[84:87], a[0:15]
  ds_read_b128 a[132:135], v243 offset:24576
  v_exp_f32 v66, v66
  v_mul_f32 v207, v198, v207
  v_add_f32 v194, v194, v64
  v_mfma_f32_32x32x16_bf16 a[16:31], a[164:167], v[92:95], a[16:31]
  v_add_f32 v195, v195, v65
  v_exp_f32 v204, v204
  v_exp_f32 v67, v67
  v_cvt_pk_bf16_f32 v104, v64, v65
  v_exp_f32 v205, v205
  v_mfma_f32_32x32x16_bf16 a[32:47], a[168:171], v[80:83], a[32:47]
  ds_read_b128 a[136:139], v244 offset:24576
  v_exp_f32 v68, v68
  v_exp_f32 v206, v206
  v_add_f32 v194, v194, v66
  v_add_f32 v195, v195, v67
  v_mfma_f32_32x32x16_bf16 a[48:63], a[168:171], v[88:91], a[48:63]
  v_exp_f32 v207, v207
  v_exp_f32 v69, v69
  v_cvt_pk_bf16_f32 v105, v66, v67
  v_fma_f32 v204, v204, v199, v199
  v_exp_f32 v70, v70
  s_waitcnt lgkmcnt(2)
  v_mfma_f32_32x32x16_bf16 a[32:47], a[172:175], v[84:87], a[32:47]
  buffer_load_dwordx4 v241, s[28:31], s76 offen offset:1024 lds
  v_add_f32 v194, v194, v68
  v_fma_f32 v205, v205, v199, v199
  v_add_f32 v195, v195, v69
  v_mfma_f32_32x32x16_bf16 a[48:63], a[172:175], v[92:95], a[48:63]
  ds_read_b128 a[140:143], v245 offset:24576
  v_exp_f32 v71, v71
  v_fma_f32 v206, v206, v199, v199
  v_cvt_pk_bf16_f32 v106, v68, v69
  v_exp_f32 v72, v72
  v_mfma_f32_32x32x16_bf16 a[64:79], a[176:179], v[80:83], a[64:79]
  ds_read_b128 a[144:147], v246 offset:24576
  v_fma_f32 v207, v207, v199, v199
  v_add_f32 v194, v194, v70
  v_add_f32 v195, v195, v71
  v_rcp_f32 v204, v204
  v_exp_f32 v73, v73
  v_mfma_f32_32x32x16_bf16 a[80:95], a[176:179], v[88:91], a[80:95]
  v_cvt_pk_bf16_f32 v107, v70, v71
  v_rcp_f32 v205, v205
  v_exp_f32 v74, v74
  v_add_f32 v194, v194, v72
  v_mfma_f32_32x32x16_bf16 a[64:79], a[180:183], v[84:87], a[64:79]
  buffer_load_dwordx4 v241, s[28:31], s76 offen offset:2048 lds
  v_rcp_f32 v206, v206
  v_add_f32 v195, v195, v73
  v_exp_f32 v75, v75
  v_mfma_f32_32x32x16_bf16 a[80:95], a[180:183], v[92:95], a[80:95]
  ds_read_b128 a[148:151], v247 offset:24576
  v_rcp_f32 v207, v207
  v_cvt_pk_bf16_f32 v108, v72, v73
  v_exp_f32 v76, v76
  v_mul_f32 v204, v204, v208
  v_mfma_f32_32x32x16_bf16 a[96:111], a[184:187], v[80:83], a[96:111]
  ds_read_b128 a[152:155], v248 offset:24576
  v_add_f32 v194, v194, v74
  v_mul_f32 v205, v205, v209
  v_add_f32 v195, v195, v75
  v_exp_f32 v77, v77
  v_mul_f32 v206, v206, v210
  v_cvt_pk_bf16_f32 v109, v74, v75
  v_mfma_f32_32x32x16_bf16 a[112:127], a[184:187], v[88:91], a[112:127]
  buffer_load_dwordx4 v241, s[28:31], s76 offen offset:3072 lds
  v_exp_f32 v78, v78
  v_mul_f32 v207, v207, v211
  v_add_f32 v194, v194, v76
  v_add_f32 v195, v195, v77
  v_mfma_f32_32x32x16_bf16 a[96:111], a[188:191], v[84:87], a[96:111]
  ds_read_b128 a[156:159], v249 offset:24576
  v_cvt_pk_bf16_f32 v202, v204, v205
  v_exp_f32 v79, v79
  v_cvt_pk_bf16_f32 v110, v76, v77
  v_cvt_pk_bf16_f32 v203, v206, v207
  v_mfma_f32_32x32x16_bf16 a[112:127], a[188:191], v[92:95], a[112:127]
  buffer_store_dwordx4 v[200:203], v5, s[32:35], s12 offen sc1
  v_add_f32 v194, v194, v78
  v_add_f32 v195, v195, v79
  v_cvt_pk_bf16_f32 v111, v78, v79
  v_mfma_f32_32x32x16_bf16 v[48:63], a[128:131], v[128:131], v[112:127]
  ds_read_b64_tr_b16 a[160:161], v212 offset:8192
  v_exp_f32 v16, v16
  v_accvgpr_read_b32 v204, a240
  v_exp_f32 v17, v17
  v_accvgpr_read_b32 v208, a248
  v_mfma_f32_32x32x16_bf16 v[64:79], a[128:131], v[132:135], v[112:127]
  ds_read_b64_tr_b16 a[162:163], v212 offset:10240
  v_exp_f32 v18, v18
  v_add_f32 v192, v192, v16
  v_accvgpr_read_b32 v205, a241
  v_add_f32 v193, v193, v17
  s_waitcnt lgkmcnt(3)
  v_mfma_f32_32x32x16_bf16 v[48:63], a[132:135], v[136:139], v[48:63]
  s_add_u32 m0, s77, 147456
  s_mov_b32 s76, 114688
  buffer_load_dwordx4 v241, s[28:31], s76 offen lds
  ds_read_b64_tr_b16 a[164:165], v212 offset:12288
  v_accvgpr_read_b32 v209, a249
  v_mfma_f32_32x32x16_bf16 v[64:79], a[132:135], v[140:143], v[64:79]
  ds_read_b64_tr_b16 a[166:167], v212 offset:14336
  v_exp_f32 v19, v19
  v_cvt_pk_bf16_f32 v80, v16, v17
  v_accvgpr_read_b32 v206, a242
  v_exp_f32 v20, v20
  v_mfma_f32_32x32x16_bf16 v[48:63], a[136:139], v[144:147], v[48:63]
  ds_read_b64_tr_b16 a[168:169], v213 offset:8192
  ds_read_b64_tr_b16 a[170:171], v213 offset:10240
  v_add_f32 v192, v192, v18
  v_accvgpr_read_b32 v210, a250
  v_add_f32 v193, v193, v19
  v_accvgpr_read_b32 v207, a243
  v_exp_f32 v21, v21
  v_mfma_f32_32x32x16_bf16 v[64:79], a[136:139], v[148:151], v[64:79]
  ds_read_b64_tr_b16 a[172:173], v213 offset:12288
  v_cvt_pk_bf16_f32 v81, v18, v19
  v_accvgpr_read_b32 v211, a251
  v_exp_f32 v22, v22
  v_mul_f32 v208, v204, v208
  v_mfma_f32_32x32x16_bf16 v[48:63], a[140:143], v[152:155], v[48:63]
  buffer_load_dwordx4 v241, s[28:31], s76 offen offset:1024 lds
  ds_read_b64_tr_b16 a[174:175], v213 offset:14336
  v_add_f32 v192, v192, v20
  v_add_f32 v193, v193, v21
  v_mfma_f32_32x32x16_bf16 v[64:79], a[140:143], v[156:159], v[64:79]
  ds_read_b64_tr_b16 a[176:177], v214 offset:8192
  v_mul_f32 v204, v196, v204
  v_exp_f32 v23, v23
  v_mul_f32 v209, v205, v209
  v_cvt_pk_bf16_f32 v82, v20, v21
  v_exp_f32 v24, v24
  v_mfma_f32_32x32x16_bf16 v[48:63], a[144:147], v[160:163], v[48:63]
  ds_read_b64_tr_b16 a[178:179], v214 offset:10240
  ds_read_b64_tr_b16 a[180:181], v214 offset:12288
  v_mul_f32 v205, v196, v205
  v_add_f32 v192, v192, v22
  v_add_f32 v193, v193, v23
  v_mul_f32 v210, v206, v210
  v_mfma_f32_32x32x16_bf16 v[64:79], a[144:147], v[164:167], v[64:79]
  ds_read_b64_tr_b16 a[182:183], v214 offset:14336
  v_exp_f32 v25, v25
  v_mul_f32 v206, v196, v206
  v_cvt_pk_bf16_f32 v83, v22, v23
  v_exp_f32 v26, v26
  v_mfma_f32_32x32x16_bf16 v[48:63], a[148:151], v[168:171], v[48:63]
  buffer_load_dwordx4 v241, s[28:31], s76 offen offset:2048 lds
  ds_read_b64_tr_b16 a[184:185], v215 offset:8192
  v_mul_f32 v211, v207, v211
  v_add_f32 v192, v192, v24
  v_mul_f32 v207, v196, v207
  v_mfma_f32_32x32x16_bf16 v[64:79], a[148:151], v[172:175], v[64:79]
  ds_read_b64_tr_b16 a[186:187], v215 offset:10240
  v_add_f32 v193, v193, v25
  v_exp_f32 v27, v27
  v_exp_f32 v204, v204
  v_cvt_pk_bf16_f32 v84, v24, v25
  v_mfma_f32_32x32x16_bf16 v[48:63], a[152:155], v[176:179], v[48:63]
  ds_read_b64_tr_b16 a[188:189], v215 offset:12288
  v_exp_f32 v205, v205
  v_exp_f32 v28, v28
  v_add_f32 v192, v192, v26
  v_mfma_f32_32x32x16_bf16 v[64:79], a[152:155], v[180:183], v[64:79]
  ds_read_b64_tr_b16 a[190:191], v215 offset:14336
  v_exp_f32 v206, v206
  v_add_f32 v193, v193, v27
  v_exp_f32 v29, v29
  v_exp_f32 v207, v207
  s_waitcnt lgkmcnt(4)
  v_mfma_f32_32x32x16_bf16 v[48:63], a[156:159], v[184:187], v[48:63]
  buffer_load_dwordx4 v241, s[28:31], s76 offen offset:3072 lds
  v_cvt_pk_bf16_f32 v85, v26, v27
  v_fma_f32 v204, v204, v197, v197
  v_mfma_f32_32x32x16_bf16 v[64:79], a[156:159], v[188:191], v[64:79]
  v_exp_f32 v30, v30
  v_add_f32 v192, v192, v28
  v_fma_f32 v205, v205, v197, v197
  v_add_f32 v193, v193, v29
  v_fma_f32 v206, v206, v197, v197
  v_exp_f32 v31, v31
  v_mfma_f32_32x32x16_bf16 a[0:15], a[160:163], v[96:99], a[0:15]
  ds_read_b128 a[128:131], v242 offset:32768
  v_cvt_pk_bf16_f32 v86, v28, v29
  v_fma_f32 v207, v207, v197, v197
  v_exp_f32 v32, v32
  v_add_f32 v192, v192, v30
  v_mfma_f32_32x32x16_bf16 a[16:31], a[160:163], v[104:107], a[16:31]
  v_rcp_f32 v204, v204
  v_add_f32 v193, v193, v31
  v_exp_f32 v33, v33
  v_rcp_f32 v205, v205
  v_mfma_f32_32x32x16_bf16 a[0:15], a[164:167], v[100:103], a[0:15]
  v_cvt_pk_bf16_f32 v87, v30, v31
  v_exp_f32 v34, v34
  v_rcp_f32 v206, v206
  v_add_f32 v194, v194, v32
  v_mfma_f32_32x32x16_bf16 a[16:31], a[164:167], v[108:111], a[16:31]
  ds_read_b128 a[132:135], v243 offset:32768
  v_add_f32 v195, v195, v33
  v_rcp_f32 v207, v207
  v_exp_f32 v35, v35
  v_mfma_f32_32x32x16_bf16 a[32:47], a[168:171], v[96:99], a[32:47]
  v_cvt_pk_bf16_f32 v88, v32, v33
  v_mul_f32 v204, v204, v208
  v_exp_f32 v36, v36
  v_mul_f32 v205, v205, v209
  v_add_f32 v194, v194, v34
  v_mfma_f32_32x32x16_bf16 a[48:63], a[168:171], v[104:107], a[48:63]
  ds_read_b128 a[136:139], v244 offset:32768
  v_add_f32 v195, v195, v35
  v_mul_f32 v206, v206, v210
  v_exp_f32 v37, v37
  v_cvt_pk_bf16_f32 v89, v34, v35
  v_mul_f32 v207, v207, v211
  v_mfma_f32_32x32x16_bf16 a[32:47], a[172:175], v[100:103], a[32:47]
  ds_read_b128 a[140:143], v245 offset:32768
  v_exp_f32 v38, v38
  v_add_f32 v194, v194, v36
  v_cvt_pk_bf16_f32 v200, v204, v205
  v_add_f32 v195, v195, v37
  v_mfma_f32_32x32x16_bf16 a[48:63], a[172:175], v[108:111], a[48:63]
  v_exp_f32 v39, v39
  v_cvt_pk_bf16_f32 v201, v206, v207
  v_cvt_pk_bf16_f32 v90, v36, v37
  v_exp_f32 v40, v40
  v_mfma_f32_32x32x16_bf16 a[64:79], a[176:179], v[96:99], a[64:79]
  s_add_u32 s16, s15, 2048
  buffer_load_dword a205, v10, s[36:39], s16 offen
  v_accvgpr_read_b32 v204, a244
  v_mfma_f32_32x32x16_bf16 a[80:95], a[176:179], v[104:107], a[80:95]
  ds_read_b128 a[144:147], v246 offset:32768
  v_add_f32 v194, v194, v38
  v_add_f32 v195, v195, v39
  v_accvgpr_read_b32 v208, a252
  v_exp_f32 v41, v41
  v_cvt_pk_bf16_f32 v91, v38, v39
  v_mfma_f32_32x32x16_bf16 a[64:79], a[180:183], v[100:103], a[64:79]
  v_accvgpr_read_b32 v205, a245
  v_exp_f32 v42, v42
  v_add_f32 v194, v194, v40
  v_accvgpr_read_b32 v209, a253
  v_add_f32 v195, v195, v41
  v_mfma_f32_32x32x16_bf16 a[80:95], a[180:183], v[108:111], a[80:95]
  ds_read_b128 a[148:151], v247 offset:32768
  v_exp_f32 v43, v43
  v_accvgpr_read_b32 v206, a246
  v_cvt_pk_bf16_f32 v92, v40, v41
  v_exp_f32 v44, v44
  s_waitcnt lgkmcnt(2)
  v_mfma_f32_32x32x16_bf16 a[96:111], a[184:187], v[96:99], a[96:111]
  v_accvgpr_read_b32 v210, a254
  v_add_f32 v194, v194, v42
  v_accvgpr_read_b32 v207, a247
  v_add_f32 v195, v195, v43
  v_exp_f32 v45, v45
  v_mfma_f32_32x32x16_bf16 a[112:127], a[184:187], v[104:107], a[112:127]
  ds_read_b128 a[152:155], v248 offset:32768
  v_accvgpr_read_b32 v211, a255
  v_cvt_pk_bf16_f32 v93, v42, v43
  v_exp_f32 v46, v46
  v_mul_f32 v208, v204, v208
  v_mfma_f32_32x32x16_bf16 a[96:111], a[188:191], v[100:103], a[96:111]
  v_add_f32 v194, v194, v44
  v_add_f32 v195, v195, v45
  v_mul_f32 v204, v196, v204
  v_exp_f32 v47, v47
  v_cvt_pk_bf16_f32 v94, v44, v45
  v_mfma_f32_32x32x16_bf16 a[112:127], a[188:191], v[108:111], a[112:127]
  ds_read_b128 a[156:159], v249 offset:32768
  v_mul_f32 v209, v205, v209
  v_add_f32 v194, v194, v46
  v_add_f32 v195, v195, v47
  v_mul_f32 v205, v196, v205
  v_cvt_pk_bf16_f32 v95, v46, v47
  v_mfma_f32_32x32x16_bf16 v[16:31], a[128:131], v[128:131], v[112:127]
  ds_read_b64_tr_b16 a[160:161], v212 offset:16384
  v_exp_f32 v48, v48
  v_mul_f32 v210, v206, v210
  v_exp_f32 v49, v49
  v_mul_f32 v206, v196, v206
  v_mfma_f32_32x32x16_bf16 v[32:47], a[128:131], v[132:135], v[112:127]
  ds_read_b64_tr_b16 a[162:163], v212 offset:18432
  v_exp_f32 v50, v50
  v_add_f32 v192, v192, v48
  v_mul_f32 v211, v207, v211
  v_add_f32 v193, v193, v49
  v_mfma_f32_32x32x16_bf16 v[16:31], a[132:135], v[136:139], v[16:31]
  ds_read_b64_tr_b16 a[164:165], v212 offset:20480
  ds_read_b64_tr_b16 a[166:167], v212 offset:22528
  v_mul_f32 v207, v196, v207
  v_exp_f32 v51, v51
  v_cvt_pk_bf16_f32 v96, v48, v49
  v_exp_f32 v204, v204
  v_mfma_f32_32x32x16_bf16 v[32:47], a[132:135], v[140:143], v[32:47]
  ds_read_b64_tr_b16 a[168:169], v213 offset:16384
  v_exp_f32 v52, v52
  v_add_f32 v192, v192, v50
  v_exp_f32 v205, v205
  v_mfma_f32_32x32x16_bf16 v[16:31], a[136:139], v[144:147], v[16:31]
  ds_read_b64_tr_b16 a[170:171], v213 offset:18432
  v_add_f32 v193, v193, v51
  v_exp_f32 v206, v206
  v_exp_f32 v53, v53
  v_mfma_f32_32x32x16_bf16 v[32:47], a[136:139], v[148:151], v[32:47]
  ds_read_b64_tr_b16 a[172:173], v213 offset:20480
  v_cvt_pk_bf16_f32 v97, v50, v51
  v_exp_f32 v207, v207
  v_exp_f32 v54, v54
  v_fma_f32 v204, v204, v197, v197
  v_mfma_f32_32x32x16_bf16 v[16:31], a[140:143], v[152:155], v[16:31]
  ds_read_b64_tr_b16 a[174:175], v213 offset:22528
  ds_read_b64_tr_b16 a[176:177], v214 offset:16384
  v_add_f32 v192, v192, v52
  v_add_f32 v193, v193, v53
  v_fma_f32 v205, v205, v197, v197
  v_exp_f32 v55, v55
  v_mfma_f32_32x32x16_bf16 v[32:47], a[140:143], v[156:159], v[32:47]
  ds_read_b64_tr_b16 a[178:179], v214 offset:18432
  v_fma_f32 v206, v206, v197, v197
  v_cvt_pk_bf16_f32 v98, v52, v53
  v_exp_f32 v56, v56
  s_waitcnt lgkmcnt(6)
  v_mfma_f32_32x32x16_bf16 v[16:31], a[144:147], v[160:163], v[16:31]
  s_add_u32 s16, s15, 4096
  buffer_load_dword a205, v10, s[36:39], s16 offen
  v_fma_f32 v207, v207, v197, v197
  v_add_f32 v192, v192, v54
  v_add_f32 v193, v193, v55
  v_mfma_f32_32x32x16_bf16 v[32:47], a[144:147], v[164:167], v[32:47]
  ds_read_b64_tr_b16 a[180:181], v214 offset:20480
  v_rcp_f32 v204, v204
  v_exp_f32 v57, v57
  v_rcp_f32 v205, v205
  v_mfma_f32_32x32x16_bf16 v[16:31], a[148:151], v[168:171], v[16:31]
  ds_read_b64_tr_b16 a[182:183], v214 offset:22528
  v_cvt_pk_bf16_f32 v99, v54, v55
  v_exp_f32 v58, v58
  v_rcp_f32 v206, v206
  v_add_f32 v192, v192, v56
  v_mfma_f32_32x32x16_bf16 v[32:47], a[148:151], v[172:175], v[32:47]
  ds_read_b64_tr_b16 a[184:185], v215 offset:16384
  v_rcp_f32 v207, v207
  v_add_f32 v193, v193, v57
  v_exp_f32 v59, v59
  v_mfma_f32_32x32x16_bf16 v[16:31], a[152:155], v[176:179], v[16:31]
  ds_read_b64_tr_b16 a[186:187], v215 offset:18432
  ds_read_b64_tr_b16 a[188:189], v215 offset:20480
  v_mul_f32 v204, v204, v208
  v_cvt_pk_bf16_f32 v100, v56, v57
  v_mul_f32 v205, v205, v209
  v_exp_f32 v60, v60
  v_mfma_f32_32x32x16_bf16 v[32:47], a[152:155], v[180:183], v[32:47]
  ds_read_b64_tr_b16 a[190:191], v215 offset:22528
  v_add_f32 v192, v192, v58
  v_mul_f32 v206, v206, v210
  v_add_f32 v193, v193, v59
  v_exp_f32 v61, v61
  v_mul_f32 v207, v207, v211
  v_mfma_f32_32x32x16_bf16 v[16:31], a[156:159], v[184:187], v[16:31]
  v_cvt_pk_bf16_f32 v101, v58, v59
  v_cvt_pk_bf16_f32 v202, v204, v205
  v_exp_f32 v62, v62
  v_add_f32 v192, v192, v60
  v_cvt_pk_bf16_f32 v203, v206, v207
  v_mfma_f32_32x32x16_bf16 v[32:47], a[156:159], v[188:191], v[32:47]
  buffer_store_dwordx4 v[200:203], v4, s[32:35], s13 offen sc1
  v_add_f32 v193, v193, v61
  v_exp_f32 v63, v63
  v_mfma_f32_32x32x16_bf16 a[0:15], a[160:163], v[80:83], a[0:15]
  ds_read_b128 a[128:131], v242 offset:40960
  v_cvt_pk_bf16_f32 v102, v60, v61
  v_lshlrev_b32 v226, 4, v6
  v_exp_f32 v64, v64
  v_add_f32 v192, v192, v62
  v_mfma_f32_32x32x16_bf16 a[16:31], a[160:163], v[88:91], a[16:31]
  s_mul_i32 s89, s3, 5120
  v_add_f32 v193, v193, v63
  v_exp_f32 v65, v65
  v_cvt_pk_bf16_f32 v103, v62, v63
  v_mfma_f32_32x32x16_bf16 a[0:15], a[164:167], v[84:87], a[0:15]
  ds_read_b128 a[132:135], v243 offset:40960
  v_accvgpr_write_b32 a200, -1
  v_exp_f32 v66, v66
  v_add_f32 v194, v194, v64
  v_add_f32 v195, v195, v65
  v_mfma_f32_32x32x16_bf16 a[16:31], a[164:167], v[92:95], a[16:31]
  v_accvgpr_write_b32 a201, -1
  v_exp_f32 v67, v67
  v_cvt_pk_bf16_f32 v104, v64, v65
  v_exp_f32 v68, v68
  s_waitcnt lgkmcnt(2)
  v_mfma_f32_32x32x16_bf16 a[32:47], a[168:171], v[80:83], a[32:47]
  ds_read_b128 a[136:139], v244 offset:40960
  v_accvgpr_write_b32 a202, -1
  v_add_f32 v194, v194, v66
  v_add_f32 v195, v195, v67
  v_accvgpr_write_b32 a203, -1
  v_mfma_f32_32x32x16_bf16 a[48:63], a[168:171], v[88:91], a[48:63]
  s_mul_i32 s83, s3, 373760
  v_exp_f32 v69, v69
  v_cvt_pk_bf16_f32 v105, v66, v67
  v_exp_f32 v70, v70
  v_mfma_f32_32x32x16_bf16 a[32:47], a[172:175], v[84:87], a[32:47]
  ds_read_b128 a[140:143], v245 offset:40960
  v_add_f32 v194, v194, v68
  v_add_f32 v195, v195, v69
  v_add_u32 v225, s83, v226
  v_exp_f32 v71, v71
  v_mfma_f32_32x32x16_bf16 a[48:63], a[172:175], v[92:95], a[48:63]
  v_cvt_pk_bf16_f32 v106, v68, v69
  v_exp_f32 v72, v72
  v_mfma_f32_32x32x16_bf16 a[64:79], a[176:179], v[80:83], a[64:79]
  s_add_u32 s16, s15, 6144
  buffer_load_dword a205, v10, s[36:39], s16 offen
  s_lshr_b32 s85, s4, 3
  v_add_f32 v194, v194, v70
  v_add_f32 v195, v195, v71
  v_mfma_f32_32x32x16_bf16 a[80:95], a[176:179], v[88:91], a[80:95]
  s_mul_i32 s85, s85, 320
  ds_read_b128 a[144:147], v246 offset:40960
  v_exp_f32 v73, v73
  v_cvt_pk_bf16_f32 v107, v70, v71
  v_mfma_f32_32x32x16_bf16 a[64:79], a[180:183], v[84:87], a[64:79]
  s_mul_i32 s83, s3, 20480
  v_exp_f32 v74, v74
  v_add_f32 v194, v194, v72
  v_add_f32 v195, v195, v73
  v_mfma_f32_32x32x16_bf16 a[80:95], a[180:183], v[92:95], a[80:95]
  s_add_u32 s83, s83, s85
  ds_read_b128 a[148:151], v247 offset:40960
  v_exp_f32 v75, v75
  v_cvt_pk_bf16_f32 v108, v72, v73
  v_exp_f32 v76, v76
  v_mfma_f32_32x32x16_bf16 a[96:111], a[184:187], v[80:83], a[96:111]
  s_add_u32 s84, s7, 1
  v_add_f32 v194, v194, v74
  v_add_f32 v195, v195, v75
  v_exp_f32 v77, v77
  v_mfma_f32_32x32x16_bf16 a[112:127], a[184:187], v[88:91], a[112:127]
  s_and_b32 s84, s84, 3
  ds_read_b128 a[152:155], v248 offset:40960
  v_cvt_pk_bf16_f32 v109, v74, v75
  v_exp_f32 v78, v78
  v_add_f32 v194, v194, v76
  v_mfma_f32_32x32x16_bf16 a[96:111], a[188:191], v[84:87], a[96:111]
  s_mul_i32 s84, s84, 5
  v_add_f32 v195, v195, v77
  v_exp_f32 v79, v79
  v_add_u32 v14, 0, v6
  v_mfma_f32_32x32x16_bf16 a[112:127], a[188:191], v[92:95], a[112:127]
  ds_read_b128 a[156:159], v249 offset:40960
  v_cvt_pk_bf16_f32 v110, v76, v77
  v_add_f32 v194, v194, v78
  v_add_f32 v195, v195, v79
  v_mul_u32_u24 v15, 3277, v14
  v_cvt_pk_bf16_f32 v111, v78, v79
  s_waitcnt lgkmcnt(3)
  v_mfma_f32_32x32x16_bf16 v[48:63], a[128:131], v[128:131], v[112:127]
  ds_read_b64_tr_b16 a[160:161], v212 offset:24576
  v_exp_f32 v16, v16
  v_lshrrev_b32 v15, 16, v15
  v_exp_f32 v17, v17
  v_mfma_f32_32x32x16_bf16 v[64:79], a[128:131], v[132:135], v[112:127]
  ds_read_b64_tr_b16 a[162:163], v212 offset:26624
  v_exp_f32 v18, v18
  v_mul_u32_u24 v216, 20, v15
  v_add_f32 v192, v192, v16
  v_mfma_f32_32x32x16_bf16 v[48:63], a[132:135], v[136:139], v[48:63]
  ds_read_b64_tr_b16 a[164:165], v212 offset:28672
  v_add_f32 v193, v193, v17
  v_sub_u32 v14, v14, v216
  v_exp_f32 v19, v19
  v_cvt_pk_bf16_f32 v80, v16, v17
  v_mfma_f32_32x32x16_bf16 v[64:79], a[132:135], v[140:143], v[64:79]
  ds_read_b64_tr_b16 a[166:167], v212 offset:30720
  ds_read_b64_tr_b16 a[168:169], v213 offset:24576
  v_add_u32 v14, s84, v14
  v_exp_f32 v20, v20
  v_add_f32 v192, v192, v18
  v_mfma_f32_32x32x16_bf16 v[48:63], a[136:139], v[144:147], v[48:63]
  ds_read_b64_tr_b16 a[170:171], v213 offset:26624
  v_add_f32 v193, v193, v19
  v_subrev_u32 v216, 20, v14
  v_exp_f32 v21, v21
  v_mfma_f32_32x32x16_bf16 v[64:79], a[136:139], v[148:151], v[64:79]
  ds_read_b64_tr_b16 a[172:173], v213 offset:28672
  v_cvt_pk_bf16_f32 v81, v18, v19
  v_min_u32 v14, v14, v216
  v_exp_f32 v22, v22
  v_add_f32 v192, v192, v20
  v_mfma_f32_32x32x16_bf16 v[48:63], a[140:143], v[152:155], v[48:63]
  ds_read_b64_tr_b16 a[174:175], v213 offset:30720
  v_mul_u32_u24 v15, 1280, v15
  v_add_f32 v193, v193, v21
  v_exp_f32 v23, v23
  v_mfma_f32_32x32x16_bf16 v[64:79], a[140:143], v[156:159], v[64:79]
  ds_read_b64_tr_b16 a[176:177], v214 offset:24576
  ds_read_b64_tr_b16 a[178:179], v214 offset:26624
  v_lshl_add_u32 v15, v14, 4, v15
  v_cvt_pk_bf16_f32 v82, v20, v21
  v_exp_f32 v24, v24
  v_mfma_f32_32x32x16_bf16 v[48:63], a[144:147], v[160:163], v[48:63]
  s_add_u32 s16, s15, 8192
  buffer_load_dword a205, v10, s[36:39], s16 offen
  v_add_u32 v216, s83, v15
  v_mfma_f32_32x32x16_bf16 v[64:79], a[144:147], v[164:167], v[64:79]
  ds_read_b64_tr_b16 a[180:181], v214 offset:28672
  v_add_f32 v192, v192, v22
  v_add_f32 v193, v193, v23
  v_add_u32 v14, 64, v6
  v_exp_f32 v25, v25
  s_waitcnt lgkmcnt(5)
  v_mfma_f32_32x32x16_bf16 v[48:63], a[148:151], v[168:171], v[48:63]
  ds_read_b64_tr_b16 a[182:183], v214 offset:30720
  v_cvt_pk_bf16_f32 v83, v22, v23
  v_mul_u32_u24 v15, 3277, v14
  v_exp_f32 v26, v26
  v_mfma_f32_32x32x16_bf16 v[64:79], a[148:151], v[172:175], v[64:79]
  ds_read_b64_tr_b16 a[184:185], v215 offset:24576
  v_add_f32 v192, v192, v24
  v_lshrrev_b32 v15, 16, v15
  v_add_f32 v193, v193, v25
  v_exp_f32 v27, v27
  v_mfma_f32_32x32x16_bf16 v[48:63], a[152:155], v[176:179], v[48:63]
  ds_read_b64_tr_b16 a[186:187], v215 offset:26624
  ds_read_b64_tr_b16 a[188:189], v215 offset:28672
  v_mul_u32_u24 v217, 20, v15
  v_cvt_pk_bf16_f32 v84, v24, v25
  v_exp_f32 v28, v28
  v_mfma_f32_32x32x16_bf16 v[64:79], a[152:155], v[180:183], v[64:79]
  ds_read_b64_tr_b16 a[190:191], v215 offset:30720
  v_add_f32 v192, v192, v26
  v_sub_u32 v14, v14, v217
  v_add_f32 v193, v193, v27
  v_mfma_f32_32x32x16_bf16 v[48:63], a[156:159], v[184:187], v[48:63]
  v_exp_f32 v29, v29
  v_add_u32 v14, s84, v14
  v_cvt_pk_bf16_f32 v85, v26, v27
  v_exp_f32 v30, v30
  v_mfma_f32_32x32x16_bf16 v[64:79], a[156:159], v[188:191], v[64:79]
  v_subrev_u32 v217, 20, v14
  v_add_f32 v192, v192, v28
  v_add_f32 v193, v193, v29
  v_min_u32 v14, v14, v217
  v_exp_f32 v31, v31
  v_mfma_f32_32x32x16_bf16 a[0:15], a[160:163], v[96:99], a[0:15]
  s_waitcnt vmcnt(2) lgkmcnt(0)
  s_barrier
  v_mfma_f32_32x32x16_bf16 a[16:31], a[160:163], v[104:107], a[16:31]
  v_cvt_pk_bf16_f32 v86, v28, v29
  v_mul_u32_u24 v15, 1280, v15
  v_exp_f32 v32, v32
  v_add_f32 v192, v192, v30
  v_xor_b32 v242, 0x10000, v242
  v_add_f32 v193, v193, v31
  v_mfma_f32_32x32x16_bf16 a[0:15], a[164:167], v[100:103], a[0:15]
  ds_read_b128 a[128:131], v242 offset:16384
  buffer_atomic_add v255, v254, s[60:63], s86 offen sc1
  v_lshl_add_u32 v15, v14, 4, v15
  v_exp_f32 v33, v33
  v_mfma_f32_32x32x16_bf16 a[16:31], a[164:167], v[108:111], a[16:31]
  v_cvt_pk_bf16_f32 v87, v30, v31
  v_subrev_u32 v15, 1024, v15
  v_exp_f32 v34, v34
  v_add_f32 v194, v194, v32
  v_xor_b32 v243, 0x10000, v243
  v_add_f32 v195, v195, v33
  v_mfma_f32_32x32x16_bf16 a[32:47], a[168:171], v[96:99], a[32:47]
  ds_read_b128 a[132:135], v243 offset:16384
  v_add_u32 v217, s83, v15
  v_exp_f32 v35, v35
  v_cvt_pk_bf16_f32 v88, v32, v33
  v_add_u32 v14, 128, v6
  v_exp_f32 v36, v36
  v_add_f32 v194, v194, v34
  v_mfma_f32_32x32x16_bf16 a[48:63], a[168:171], v[104:107], a[48:63]
  s_add_u32 m0, s77, 81920
  s_mov_b32 s76, 98304
  buffer_load_dwordx4 v237, s[24:27], s76 offen lds
  v_mul_u32_u24 v15, 3277, v14
  v_add_f32 v195, v195, v35
  v_mfma_f32_32x32x16_bf16 a[32:47], a[172:175], v[100:103], a[32:47]
  v_xor_b32 v244, 0x10000, v244
  v_exp_f32 v37, v37
  v_cvt_pk_bf16_f32 v89, v34, v35
  v_lshrrev_b32 v15, 16, v15
  v_exp_f32 v38, v38
  v_mfma_f32_32x32x16_bf16 a[48:63], a[172:175], v[108:111], a[48:63]
  ds_read_b128 a[136:139], v244 offset:16384
  v_add_f32 v194, v194, v36
  v_mul_u32_u24 v218, 20, v15
  v_add_f32 v195, v195, v37
  v_xor_b32 v245, 0x10000, v245
  v_exp_f32 v39, v39
  v_mfma_f32_32x32x16_bf16 a[64:79], a[176:179], v[96:99], a[64:79]
  ds_read_b128 a[140:143], v245 offset:16384
  buffer_load_dwordx4 v238, s[24:27], s76 offen offset:1024 lds
  v_cvt_pk_bf16_f32 v90, v36, v37
  v_sub_u32 v14, v14, v218
  v_exp_f32 v40, v40
  v_mfma_f32_32x32x16_bf16 a[80:95], a[176:179], v[104:107], a[80:95]
  v_add_f32 v194, v194, v38
  v_add_u32 v14, s84, v14
  v_add_f32 v195, v195, v39
  v_exp_f32 v41, v41
  v_xor_b32 v246, 0x10000, v246
  v_cvt_pk_bf16_f32 v91, v38, v39
  v_mfma_f32_32x32x16_bf16 a[64:79], a[180:183], v[100:103], a[64:79]
  ds_read_b128 a[144:147], v246 offset:16384
  v_subrev_u32 v218, 20, v14
  v_exp_f32 v42, v42
  v_add_f32 v194, v194, v40
  v_min_u32 v14, v14, v218
  v_add_f32 v195, v195, v41
  v_exp_f32 v43, v43
  v_mfma_f32_32x32x16_bf16 a[80:95], a[180:183], v[108:111], a[80:95]
  v_xor_b32 v247, 0x10000, v247
  v_cvt_pk_bf16_f32 v92, v40, v41
  v_mul_u32_u24 v15, 1280, v15
  v_mfma_f32_32x32x16_bf16 a[96:111], a[184:187], v[96:99], a[96:111]
  ds_read_b128 a[148:151], v247 offset:16384
  buffer_load_dwordx4 v239, s[24:27], s76 offen offset:2048 lds
  v_exp_f32 v44, v44
  v_add_f32 v194, v194, v42
  v_lshl_add_u32 v15, v14, 4, v15
  v_add_f32 v195, v195, v43
  v_exp_f32 v45, v45
  v_mfma_f32_32x32x16_bf16 a[112:127], a[184:187], v[104:107], a[112:127]
  v_subrev_u32 v15, 2048, v15
  v_cvt_pk_bf16_f32 v93, v42, v43
  v_xor_b32 v248, 0x10000, v248
  v_exp_f32 v46, v46
  v_add_f32 v194, v194, v44
  v_add_u32 v218, s83, v15
  v_mfma_f32_32x32x16_bf16 a[96:111], a[188:191], v[100:103], a[96:111]
  ds_read_b128 a[152:155], v248 offset:16384
  buffer_load_dwordx4 v240, s[24:27], s76 offen offset:3072 lds
  v_add_f32 v195, v195, v45
  v_exp_f32 v47, v47
  v_mfma_f32_32x32x16_bf16 a[112:127], a[188:191], v[108:111], a[112:127]
  v_add_u32 v14, 192, v6
  v_cvt_pk_bf16_f32 v94, v44, v45
  v_xor_b32 v249, 0x10000, v249
  v_add_f32 v194, v194, v46
  v_add_f32 v195, v195, v47
  v_mul_u32_u24 v15, 3277, v14
  v_cvt_pk_bf16_f32 v95, v46, v47
  s_waitcnt lgkmcnt(2)
  v_mfma_f32_32x32x16_bf16 v[16:31], a[128:131], v[128:131], v[112:127]
  ds_read_b128 a[156:159], v249 offset:16384
  ds_read_b64_tr_b16 a[160:161], v250 offset:0
  v_exp_f32 v48, v48
  v_lshrrev_b32 v15, 16, v15
  v_exp_f32 v49, v49
  v_mfma_f32_32x32x16_bf16 v[32:47], a[128:131], v[132:135], v[112:127]
  ds_read_b64_tr_b16 a[162:163], v250 offset:2048
  v_exp_f32 v50, v50
  v_mul_u32_u24 v219, 20, v15
  v_add_f32 v192, v192, v48
  v_add_f32 v193, v193, v49
  v_mfma_f32_32x32x16_bf16 v[16:31], a[132:135], v[136:139], v[16:31]
  s_add_u32 m0, s77, 98304
  s_mov_b32 s76, 114688
  buffer_load_dwordx4 v237, s[24:27], s76 offen lds
  ds_read_b64_tr_b16 a[164:165], v250 offset:4096
  v_mfma_f32_32x32x16_bf16 v[32:47], a[132:135], v[140:143], v[32:47]
  ds_read_b64_tr_b16 a[166:167], v250 offset:6144
  v_sub_u32 v14, v14, v219
  v_exp_f32 v51, v51
  v_cvt_pk_bf16_f32 v96, v48, v49
  v_add_u32 v14, s84, v14
  v_mfma_f32_32x32x16_bf16 v[16:31], a[136:139], v[144:147], v[16:31]
  ds_read_b64_tr_b16 a[168:169], v251 offset:0
  ds_read_b64_tr_b16 a[170:171], v251 offset:2048
  v_exp_f32 v52, v52
  v_add_f32 v192, v192, v50
  v_add_f32 v193, v193, v51
  v_subrev_u32 v219, 20, v14
  v_mfma_f32_32x32x16_bf16 v[32:47], a[136:139], v[148:151], v[32:47]
  ds_read_b64_tr_b16 a[172:173], v251 offset:4096
  v_exp_f32 v53, v53
  v_cvt_pk_bf16_f32 v97, v50, v51
  v_min_u32 v14, v14, v219
  v_exp_f32 v54, v54
  v_mfma_f32_32x32x16_bf16 v[16:31], a[140:143], v[152:155], v[16:31]
  buffer_load_dwordx4 v238, s[24:27], s76 offen offset:1024 lds
  v_add_f32 v192, v192, v52
  v_mul_u32_u24 v15, 1280, v15
  v_mfma_f32_32x32x16_bf16 v[32:47], a[140:143], v[156:159], v[32:47]
  ds_read_b64_tr_b16 a[174:175], v251 offset:6144
  ds_read_b64_tr_b16 a[176:177], v252 offset:0
  v_add_f32 v193, v193, v53
  v_exp_f32 v55, v55
  v_lshl_add_u32 v15, v14, 4, v15
  v_cvt_pk_bf16_f32 v98, v52, v53
  v_mfma_f32_32x32x16_bf16 v[16:31], a[144:147], v[160:163], v[16:31]
  ds_read_b64_tr_b16 a[178:179], v252 offset:2048
  v_exp_f32 v56, v56
  v_subrev_u32 v15, 3072, v15
  v_add_f32 v192, v192, v54
  v_add_f32 v193, v193, v55
  v_mfma_f32_32x32x16_bf16 v[32:47], a[144:147], v[164:167], v[32:47]
  ds_read_b64_tr_b16 a[180:181], v252 offset:4096
  ds_read_b64_tr_b16 a[182:183], v252 offset:6144
  v_add_u32 v219, s83, v15
  v_exp_f32 v57, v57
  v_cvt_pk_bf16_f32 v99, v54, v55
  s_waitcnt lgkmcnt(5)
  v_mfma_f32_32x32x16_bf16 v[16:31], a[148:151], v[168:171], v[16:31]
  buffer_load_dwordx4 v239, s[24:27], s76 offen offset:2048 lds
  v_add_u32 v14, 256, v6
  v_exp_f32 v58, v58
  v_mfma_f32_32x32x16_bf16 v[32:47], a[148:151], v[172:175], v[32:47]
  ds_read_b64_tr_b16 a[184:185], v253 offset:0
  v_add_f32 v192, v192, v56
  v_mul_u32_u24 v15, 3277, v14
  v_add_f32 v193, v193, v57
  v_exp_f32 v59, v59
  v_mfma_f32_32x32x16_bf16 v[16:31], a[152:155], v[176:179], v[16:31]
  ds_read_b64_tr_b16 a[186:187], v253 offset:2048
  ds_read_b64_tr_b16 a[188:189], v253 offset:4096
  v_lshrrev_b32 v15, 16, v15
  v_cvt_pk_bf16_f32 v100, v56, v57
  v_exp_f32 v60, v60
  v_add_f32 v192, v192, v58
  v_mfma_f32_32x32x16_bf16 v[32:47], a[152:155], v[180:183], v[32:47]
  ds_read_b64_tr_b16 a[190:191], v253 offset:6144
  v_mul_u32_u24 v220, 20, v15
  v_add_f32 v193, v193, v59
  v_exp_f32 v61, v61
  v_sub_u32 v14, v14, v220
  v_mfma_f32_32x32x16_bf16 v[16:31], a[156:159], v[184:187], v[16:31]
  buffer_load_dwordx4 v240, s[24:27], s76 offen offset:3072 lds
  v_cvt_pk_bf16_f32 v101, v58, v59
  v_exp_f32 v62, v62
  v_mfma_f32_32x32x16_bf16 v[32:47], a[156:159], v[188:191], v[32:47]
  v_add_u32 v14, s84, v14
  v_add_f32 v192, v192, v60
  v_add_f32 v193, v193, v61
  v_subrev_u32 v220, 20, v14
  v_exp_f32 v63, v63
  v_mfma_f32_32x32x16_bf16 a[0:15], a[160:163], v[80:83], a[0:15]
  ds_read_b128 a[128:131], v242 offset:24576
  v_cvt_pk_bf16_f32 v102, v60, v61
  v_min_u32 v14, v14, v220
  v_exp_f32 v64, v64
  v_add_f32 v192, v192, v62
  v_mfma_f32_32x32x16_bf16 a[16:31], a[160:163], v[88:91], a[16:31]
  v_add_f32 v193, v193, v63
  v_mul_u32_u24 v15, 1280, v15
  v_exp_f32 v65, v65
  v_cvt_pk_bf16_f32 v103, v62, v63
  v_mfma_f32_32x32x16_bf16 a[0:15], a[164:167], v[84:87], a[0:15]
  s_add_u32 m0, s77, 114688
  s_mov_b32 s76, 81920
  buffer_load_dwordx4 v241, s[28:31], s76 offen lds
  v_lshl_add_u32 v15, v14, 4, v15
  v_exp_f32 v66, v66
  v_mfma_f32_32x32x16_bf16 a[16:31], a[164:167], v[92:95], a[16:31]
  ds_read_b128 a[132:135], v243 offset:24576
  v_add_f32 v194, v194, v64
  v_add_f32 v195, v195, v65
  v_add_u32 v220, s83, v15
  v_exp_f32 v67, v67
  v_mfma_f32_32x32x16_bf16 a[32:47], a[168:171], v[80:83], a[32:47]
  v_cvt_pk_bf16_f32 v104, v64, v65
  v_exp_f32 v68, v68
  v_lshrrev_b32 v14, 5, v6
  v_add_f32 v194, v194, v66
  v_add_f32 v195, v195, v67
  v_mfma_f32_32x32x16_bf16 a[48:63], a[168:171], v[88:91], a[48:63]
  ds_read_b128 a[136:139], v244 offset:24576
  v_bfe_u32 v15, v6, 2, 2
  v_exp_f32 v69, v69
  v_cvt_pk_bf16_f32 v105, v66, v67
  v_exp_f32 v70, v70
  s_waitcnt lgkmcnt(2)
  v_mfma_f32_32x32x16_bf16 a[32:47], a[172:175], v[84:87], a[32:47]
  buffer_load_dwordx4 v241, s[28:31], s76 offen offset:1024 lds
  v_lshl_add_u32 v14, v14, 3, v15
  v_add_f32 v194, v194, v68
  v_mfma_f32_32x32x16_bf16 a[48:63], a[172:175], v[92:95], a[48:63]
  ds_read_b128 a[140:143], v245 offset:24576
  v_add_f32 v195, v195, v69
  v_mul_u32_u24 v14, 320, v14
  v_exp_f32 v71, v71
  v_cvt_pk_bf16_f32 v106, v68, v69
  v_mfma_f32_32x32x16_bf16 a[64:79], a[176:179], v[80:83], a[64:79]
  v_exp_f32 v72, v72
  v_bfe_u32 v15, v6, 4, 1
  v_add_f32 v194, v194, v70
  v_add_f32 v195, v195, v71
  v_exp_f32 v73, v73
  v_mfma_f32_32x32x16_bf16 a[80:95], a[176:179], v[88:91], a[80:95]
  ds_read_b128 a[144:147], v246 offset:24576
  v_bfe_u32 v221, v6, 1, 1
  v_cvt_pk_bf16_f32 v107, v70, v71
  v_exp_f32 v74, v74
  v_lshl_add_u32 v15, v15, 1, v221
  v_mfma_f32_32x32x16_bf16 a[64:79], a[180:183], v[84:87], a[64:79]
  buffer_load_dwordx4 v241, s[28:31], s76 offen offset:2048 lds
  v_add_f32 v194, v194, v72
  v_add_f32 v195, v195, v73
  v_mfma_f32_32x32x16_bf16 a[80:95], a[180:183], v[92:95], a[80:95]
  ds_read_b128 a[148:151], v247 offset:24576
  v_exp_f32 v75, v75
  v_lshl_add_u32 v221, v15, 3, v14
  v_cvt_pk_bf16_f32 v108, v72, v73
  v_exp_f32 v76, v76
  v_mfma_f32_32x32x16_bf16 a[96:111], a[184:187], v[80:83], a[96:111]
  v_mul_u32_u24 v15, 80, v15
  v_add_f32 v194, v194, v74
  v_add_f32 v195, v195, v75
  v_exp_f32 v77, v77
  v_add_u32 v14, v14, v15
  v_cvt_pk_bf16_f32 v109, v74, v75
  v_mfma_f32_32x32x16_bf16 a[112:127], a[184:187], v[88:91], a[112:127]
  ds_read_b128 a[152:155], v248 offset:24576
  v_exp_f32 v78, v78
  v_add_f32 v194, v194, v76
  v_and_b32 v15, 1, v6
  v_add_f32 v195, v195, v77
  v_mfma_f32_32x32x16_bf16 a[96:111], a[188:191], v[84:87], a[96:111]
  buffer_load_dwordx4 v241, s[28:31], s76 offen offset:3072 lds
  v_exp_f32 v79, v79
  v_lshl_add_u32 v221, v15, 5, v221
  v_mfma_f32_32x32x16_bf16 a[112:127], a[188:191], v[92:95], a[112:127]
  ds_read_b128 a[156:159], v249 offset:24576
  v_cvt_pk_bf16_f32 v110, v76, v77
  v_add_f32 v194, v194, v78
  v_add_f32 v195, v195, v79
  v_add_u32 v221, 8, v221
  v_cvt_pk_bf16_f32 v111, v78, v79
  v_mfma_f32_32x32x16_bf16 v[48:63], a[128:131], v[128:131], v[112:127]
  ds_read_b64_tr_b16 a[160:161], v250 offset:8192
  v_exp_f32 v16, v16
  v_mul_u32_u24 v15, 72, v15
  v_exp_f32 v17, v17
  v_mfma_f32_32x32x16_bf16 v[64:79], a[128:131], v[132:135], v[112:127]
  ds_read_b64_tr_b16 a[162:163], v250 offset:10240
  v_exp_f32 v18, v18
  v_add_u32 v229, v14, v15
  v_add_f32 v192, v192, v16
  v_add_f32 v193, v193, v17
  s_waitcnt lgkmcnt(4)
  v_mfma_f32_32x32x16_bf16 v[48:63], a[132:135], v[136:139], v[48:63]
  s_add_u32 m0, s77, 131072
  s_mov_b32 s76, 98304
  buffer_load_dwordx4 v241, s[28:31], s76 offen lds
  ds_read_b64_tr_b16 a[164:165], v250 offset:12288
  v_add_u32 v222, 40960, v221
  v_mfma_f32_32x32x16_bf16 v[64:79], a[132:135], v[140:143], v[64:79]
  ds_read_b64_tr_b16 a[166:167], v250 offset:14336
  v_exp_f32 v19, v19
  v_cvt_pk_bf16_f32 v80, v16, v17
  v_add_u32 v230, 40960, v229
  v_exp_f32 v20, v20
  v_mfma_f32_32x32x16_bf16 v[48:63], a[136:139], v[144:147], v[48:63]
  ds_read_b64_tr_b16 a[168:169], v251 offset:8192
  ds_read_b64_tr_b16 a[170:171], v251 offset:10240
  v_add_f32 v192, v192, v18
  v_add_u32 v223, 81920, v221
  v_add_f32 v193, v193, v19
  v_mfma_f32_32x32x16_bf16 v[64:79], a[136:139], v[148:151], v[64:79]
  ds_read_b64_tr_b16 a[172:173], v251 offset:12288
  v_exp_f32 v21, v21
  v_add_u32 v231, 81920, v229
  v_cvt_pk_bf16_f32 v81, v18, v19
  v_exp_f32 v22, v22
  v_mfma_f32_32x32x16_bf16 v[48:63], a[140:143], v[152:155], v[48:63]
  buffer_load_dwordx4 v241, s[28:31], s76 offen offset:1024 lds
  ds_read_b64_tr_b16 a[174:175], v251 offset:14336
  v_add_u32 v224, 122880, v221
  v_add_f32 v192, v192, v20
  v_mfma_f32_32x32x16_bf16 v[64:79], a[140:143], v[156:159], v[64:79]
  ds_read_b64_tr_b16 a[176:177], v252 offset:8192
  v_add_f32 v193, v193, v21
  v_add_u32 v8, 122880, v229
  v_exp_f32 v23, v23
  v_cvt_pk_bf16_f32 v82, v20, v21
  v_mfma_f32_32x32x16_bf16 v[48:63], a[144:147], v[160:163], v[48:63]
  ds_read_b64_tr_b16 a[178:179], v252 offset:10240
  v_and_b32 v14, 31, v6
  v_exp_f32 v24, v24
  v_add_f32 v192, v192, v22
  v_mul_u32_u24 v14, 1280, v14
  v_add_f32 v193, v193, v23
  v_mfma_f32_32x32x16_bf16 v[64:79], a[144:147], v[164:167], v[64:79]
  ds_read_b64_tr_b16 a[180:181], v252 offset:12288
  ds_read_b64_tr_b16 a[182:183], v252 offset:14336
  v_exp_f32 v25, v25
  v_lshrrev_b32 v15, 5, v6
  v_cvt_pk_bf16_f32 v83, v22, v23
  v_mfma_f32_32x32x16_bf16 v[48:63], a[148:151], v[168:171], v[48:63]
  buffer_load_dwordx4 v241, s[28:31], s76 offen offset:2048 lds
  v_exp_f32 v26, v26
  v_lshl_add_u32 v227, v15, 5, v14
  v_mfma_f32_32x32x16_bf16 v[64:79], a[148:151], v[172:175], v[64:79]
  ds_read_b64_tr_b16 a[184:185], v253 offset:8192
  v_add_f32 v192, v192, v24
  v_add_f32 v193, v193, v25
  v_add_u32 v227, 8, v227
  v_exp_f32 v27, v27
  s_waitcnt lgkmcnt(4)
  v_mfma_f32_32x32x16_bf16 v[48:63], a[152:155], v[176:179], v[48:63]
  ds_read_b64_tr_b16 a[186:187], v253 offset:10240
  ds_read_b64_tr_b16 a[188:189], v253 offset:12288
  v_cvt_pk_bf16_f32 v84, v24, v25
  v_mul_u32_u24 v15, 72, v15
  v_exp_f32 v28, v28
  v_add_f32 v192, v192, v26
  v_mfma_f32_32x32x16_bf16 v[64:79], a[152:155], v[180:183], v[64:79]
  ds_read_b64_tr_b16 a[190:191], v253 offset:14336
  s_lshl_b32 s83, s5, 3
  v_add_u32 v9, v14, v15
  v_add_f32 v193, v193, v27
  v_exp_f32 v29, v29
  v_mfma_f32_32x32x16_bf16 v[48:63], a[156:159], v[184:187], v[48:63]
  buffer_load_dwordx4 v241, s[28:31], s76 offen offset:3072 lds
  v_cvt_pk_bf16_f32 v85, v26, v27
  v_exp_f32 v30, v30
  v_mfma_f32_32x32x16_bf16 v[64:79], a[156:159], v[188:191], v[64:79]
  s_and_b32 s84, s4, 4
  s_add_u32 s83, s83, s84
  v_add_f32 v192, v192, v28
  v_add_f32 v193, v193, v29
  v_exp_f32 v31, v31
  v_mfma_f32_32x32x16_bf16 a[0:15], a[160:163], v[96:99], a[0:15]
  s_add_u32 s83, s83, s3
  v_cvt_pk_bf16_f32 v86, v28, v29
  v_exp_f32 v32, v32
  v_add_f32 v192, v192, v30
  v_mfma_f32_32x32x16_bf16 a[16:31], a[160:163], v[104:107], a[16:31]
  ds_read_b128 a[128:131], v242 offset:32768
  s_mul_i32 s83, s83, 40960
  v_add_f32 v193, v193, v31
  v_exp_f32 v33, v33
  v_cvt_pk_bf16_f32 v87, v30, v31
  v_mfma_f32_32x32x16_bf16 a[0:15], a[164:167], v[100:103], a[0:15]
  s_add_u32 s83, s83, s85
  ds_read_b128 a[132:135], v243 offset:32768
  v_exp_f32 v34, v34
  v_add_f32 v194, v194, v32
  v_mfma_f32_32x32x16_bf16 a[16:31], a[164:167], v[108:111], a[16:31]
  s_mul_i32 s84, s7, 80
  v_add_f32 v195, v195, v33
  v_exp_f32 v35, v35
  v_cvt_pk_bf16_f32 v88, v32, v33
  v_mfma_f32_32x32x16_bf16 a[32:47], a[168:171], v[96:99], a[32:47]
  s_add_u32 s72, s83, s84
  ds_read_b128 a[136:139], v244 offset:32768
  v_exp_f32 v36, v36
  v_add_f32 v194, v194, v34
  v_add_f32 v195, v195, v35
  v_mfma_f32_32x32x16_bf16 a[48:63], a[168:171], v[104:107], a[48:63]
  v_lshlrev_b32 v14, 2, v6
  v_exp_f32 v37, v37
  v_cvt_pk_bf16_f32 v89, v34, v35
  v_exp_f32 v38, v38
  v_mfma_f32_32x32x16_bf16 a[32:47], a[172:175], v[100:103], a[32:47]
  ds_read_b128 a[140:143], v245 offset:32768
  v_mov_b32 v15, 0x40000000
  v_add_f32 v194, v194, v36
  v_add_f32 v195, v195, v37
  v_mfma_f32_32x32x16_bf16 a[48:63], a[172:175], v[108:111], a[48:63]
  v_cmp_gt_u32 vcc, 16, v6
  s_nop 1
  v_cndmask_b32 v228, v15, v14, vcc
  v_exp_f32 v39, v39
  v_cvt_pk_bf16_f32 v90, v36, v37
  v_exp_f32 v40, v40
  s_waitcnt lgkmcnt(2)
  v_mfma_f32_32x32x16_bf16 a[64:79], a[176:179], v[96:99], a[64:79]
  s_lshl_b32 s81, 0x55, s6
  v_add_f32 v194, v194, v38
  v_add_f32 v195, v195, v39
  v_exp_f32 v41, v41
  v_mfma_f32_32x32x16_bf16 a[80:95], a[176:179], v[104:107], a[80:95]
  s_lshr_b32 s6, 0xaa00, s6
  ds_read_b128 a[144:147], v246 offset:32768
  v_cvt_pk_bf16_f32 v91, v38, v39
  v_exp_f32 v42, v42
  v_mfma_f32_32x32x16_bf16 a[64:79], a[180:183], v[100:103], a[64:79]
  s_mul_i32 s78, s7, 552960
  v_add_f32 v194, v194, v40
  v_add_f32 v195, v195, v41
  v_exp_f32 v43, v43
  v_mfma_f32_32x32x16_bf16 a[80:95], a[180:183], v[108:111], a[80:95]
  s_mul_i32 s79, s7, 27648
  ds_read_b128 a[148:151], v247 offset:32768
  s_add_u32 s79, s79, 262144
  v_cvt_pk_bf16_f32 v92, v40, v41
  v_exp_f32 v44, v44
  v_mfma_f32_32x32x16_bf16 a[96:111], a[184:187], v[96:99], a[96:111]
  s_andn2_b32 s83, s2, 3
  v_add_f32 v194, v194, v42
  v_add_f32 v195, v195, v43
  v_exp_f32 v45, v45
  v_mfma_f32_32x32x16_bf16 a[112:127], a[184:187], v[104:107], a[112:127]
  ds_read_b128 a[152:155], v248 offset:32768
  v_cvt_pk_bf16_f32 v93, v42, v43
  v_exp_f32 v46, v46
  v_add_f32 v194, v194, v44
  v_mfma_f32_32x32x16_bf16 a[96:111], a[188:191], v[100:103], a[96:111]
  s_mul_i32 s85, s3, 3072
  s_add_u32 s84, s7, 1
  v_add_f32 v195, v195, v45
  v_exp_f32 v47, v47
  v_cvt_pk_bf16_f32 v94, v44, v45
  v_mfma_f32_32x32x16_bf16 a[112:127], a[188:191], v[108:111], a[112:127]
  ds_read_b128 a[156:159], v249 offset:32768
  s_and_b32 s84, s84, 3
  v_add_f32 v194, v194, v46
  v_add_f32 v195, v195, v47
  v_cvt_pk_bf16_f32 v95, v46, v47
  v_mfma_f32_32x32x16_bf16 v[16:31], a[128:131], v[128:131], v[112:127]
  ds_read_b64_tr_b16 a[160:161], v250 offset:16384
  s_add_u32 s84, s84, s83
  v_exp_f32 v48, v48
  v_exp_f32 v49, v49
  v_mfma_f32_32x32x16_bf16 v[32:47], a[128:131], v[132:135], v[112:127]
  ds_read_b64_tr_b16 a[162:163], v250 offset:18432
  s_mul_i32 s84, s84, 73728
  v_exp_f32 v50, v50
  v_add_f32 v192, v192, v48
  v_mfma_f32_32x32x16_bf16 v[16:31], a[132:135], v[136:139], v[16:31]
  ds_read_b64_tr_b16 a[164:165], v250 offset:20480
  s_add_u32 s84, s84, s85
  v_add_f32 v193, v193, v49
  v_exp_f32 v51, v51
  v_cvt_pk_bf16_f32 v96, v48, v49
  v_mfma_f32_32x32x16_bf16 v[32:47], a[132:135], v[140:143], v[32:47]
  ds_read_b64_tr_b16 a[166:167], v250 offset:22528
  s_add_u32 s20, s84, 0
  ds_read_b64_tr_b16 a[168:169], v251 offset:16384
  v_exp_f32 v52, v52
  v_add_f32 v192, v192, v50
  s_waitcnt lgkmcnt(6)
  v_mfma_f32_32x32x16_bf16 v[16:31], a[136:139], v[144:147], v[16:31]
  s_add_u32 s84, s7, 2
  ds_read_b64_tr_b16 a[170:171], v251 offset:18432
  v_add_f32 v193, v193, v51
  v_exp_f32 v53, v53
  v_mfma_f32_32x32x16_bf16 v[32:47], a[136:139], v[148:151], v[32:47]
  s_and_b32 s84, s84, 3
  ds_read_b64_tr_b16 a[172:173], v251 offset:20480
  s_add_u32 s84, s84, s83
  v_cvt_pk_bf16_f32 v97, v50, v51
  v_exp_f32 v54, v54
  v_mfma_f32_32x32x16_bf16 v[16:31], a[140:143], v[152:155], v[16:31]
  ds_read_b64_tr_b16 a[174:175], v251 offset:22528
  s_mul_i32 s84, s84, 73728
  v_add_f32 v192, v192, v52
  v_add_f32 v193, v193, v53
  v_exp_f32 v55, v55
  v_mfma_f32_32x32x16_bf16 v[32:47], a[140:143], v[156:159], v[32:47]
  ds_read_b64_tr_b16 a[176:177], v252 offset:16384
  s_add_u32 s84, s84, s85
  v_cvt_pk_bf16_f32 v98, v52, v53
  v_exp_f32 v56, v56
  v_mfma_f32_32x32x16_bf16 v[16:31], a[144:147], v[160:163], v[16:31]
  ds_read_b64_tr_b16 a[178:179], v252 offset:18432
  buffer_load_dword v3, off, s[60:63], s86 sc1
  v_add_f32 v192, v192, v54
  v_mfma_f32_32x32x16_bf16 v[32:47], a[144:147], v[164:167], v[32:47]
  s_add_u32 s21, s84, 12288
  ds_read_b64_tr_b16 a[180:181], v252 offset:20480
  v_add_f32 v193, v193, v55
  v_exp_f32 v57, v57
  v_mfma_f32_32x32x16_bf16 v[16:31], a[148:151], v[168:171], v[16:31]
  s_add_u32 s84, s7, 3
  ds_read_b64_tr_b16 a[182:183], v252 offset:22528
  s_and_b32 s84, s84, 3
  v_cvt_pk_bf16_f32 v99, v54, v55
  v_exp_f32 v58, v58
  v_mfma_f32_32x32x16_bf16 v[32:47], a[148:151], v[172:175], v[32:47]
  ds_read_b64_tr_b16 a[184:185], v253 offset:16384
  s_add_u32 s84, s84, s83
  v_add_f32 v192, v192, v56
  v_add_f32 v193, v193, v57
  v_exp_f32 v59, v59
  v_mfma_f32_32x32x16_bf16 v[16:31], a[152:155], v[176:179], v[16:31]
  ds_read_b64_tr_b16 a[186:187], v253 offset:18432
  s_mul_i32 s84, s84, 73728
  ds_read_b64_tr_b16 a[188:189], v253 offset:20480
  v_cvt_pk_bf16_f32 v100, v56, v57
  v_exp_f32 v60, v60
  v_mfma_f32_32x32x16_bf16 v[32:47], a[152:155], v[180:183], v[32:47]
  s_add_u32 s84, s84, s85
  ds_read_b64_tr_b16 a[190:191], v253 offset:22528
  v_add_f32 v192, v192, v58
  v_add_f32 v193, v193, v59
  s_waitcnt lgkmcnt(6)
  v_mfma_f32_32x32x16_bf16 v[16:31], a[156:159], v[184:187], v[16:31]
  s_add_u32 s22, s84, 24576
  v_exp_f32 v61, v61
  v_cvt_pk_bf16_f32 v101, v58, v59
  v_exp_f32 v62, v62
  v_mfma_f32_32x32x16_bf16 v[32:47], a[156:159], v[188:191], v[32:47]
  s_mul_i32 s84, s2, 73728
  s_add_u32 s23, s84, s85
  v_add_f32 v192, v192, v60
  v_add_f32 v193, v193, v61
  v_exp_f32 v63, v63
  v_mfma_f32_32x32x16_bf16 a[0:15], a[160:163], v[80:83], a[0:15]
  ds_read_b128 a[128:131], v242 offset:40960
  v_cvt_pk_bf16_f32 v102, v60, v61
  v_exp_f32 v64, v64
  v_add_f32 v192, v192, v62
  v_mfma_f32_32x32x16_bf16 a[16:31], a[160:163], v[88:91], a[16:31]
  v_add_f32 v193, v193, v63
  v_exp_f32 v65, v65
  v_cvt_pk_bf16_f32 v103, v62, v63
  v_mfma_f32_32x32x16_bf16 a[0:15], a[164:167], v[84:87], a[0:15]
  ds_read_b128 a[132:135], v243 offset:40960
  v_exp_f32 v66, v66
  v_add_f32 v194, v194, v64
  v_add_f32 v195, v195, v65
  v_mfma_f32_32x32x16_bf16 a[16:31], a[164:167], v[92:95], a[16:31]
  v_exp_f32 v67, v67
  v_cvt_pk_bf16_f32 v104, v64, v65
  v_exp_f32 v68, v68
  v_mfma_f32_32x32x16_bf16 a[32:47], a[168:171], v[80:83], a[32:47]
  ds_read_b128 a[136:139], v244 offset:40960
  v_add_f32 v194, v194, v66
  v_add_f32 v195, v195, v67
  v_mfma_f32_32x32x16_bf16 a[48:63], a[168:171], v[88:91], a[48:63]
  v_exp_f32 v69, v69
  v_cvt_pk_bf16_f32 v105, v66, v67
  v_exp_f32 v70, v70
  v_mfma_f32_32x32x16_bf16 a[32:47], a[172:175], v[84:87], a[32:47]
  ds_read_b128 a[140:143], v245 offset:40960
  v_add_f32 v194, v194, v68
  v_add_f32 v195, v195, v69
  v_exp_f32 v71, v71
  v_mfma_f32_32x32x16_bf16 a[48:63], a[172:175], v[92:95], a[48:63]
  v_cvt_pk_bf16_f32 v106, v68, v69
  v_exp_f32 v72, v72
  v_mfma_f32_32x32x16_bf16 a[64:79], a[176:179], v[80:83], a[64:79]
  s_add_u32 s83, s23, 36864
  buffer_store_dwordx4 a[200:203], v226, s[64:67], s83 offen sc1
  v_add_f32 v194, v194, v70
  v_mfma_f32_32x32x16_bf16 a[80:95], a[176:179], v[88:91], a[80:95]
  ds_read_b128 a[144:147], v246 offset:40960
  v_add_f32 v195, v195, v71
  v_exp_f32 v73, v73
  v_cvt_pk_bf16_f32 v107, v70, v71
  s_waitcnt lgkmcnt(3)
  v_mfma_f32_32x32x16_bf16 a[64:79], a[180:183], v[84:87], a[64:79]
  v_exp_f32 v74, v74
  v_add_f32 v194, v194, v72
  v_add_f32 v195, v195, v73
  v_mfma_f32_32x32x16_bf16 a[80:95], a[180:183], v[92:95], a[80:95]
  ds_read_b128 a[148:151], v247 offset:40960
  v_exp_f32 v75, v75
  v_cvt_pk_bf16_f32 v108, v72, v73
  v_mfma_f32_32x32x16_bf16 a[96:111], a[184:187], v[80:83], a[96:111]
  v_exp_f32 v76, v76
  v_add_f32 v194, v194, v74
  v_add_f32 v195, v195, v75
  v_exp_f32 v77, v77
  v_mfma_f32_32x32x16_bf16 a[112:127], a[184:187], v[88:91], a[112:127]
  ds_read_b128 a[152:155], v248 offset:40960
  v_cvt_pk_bf16_f32 v109, v74, v75
  v_exp_f32 v78, v78
  v_mfma_f32_32x32x16_bf16 a[96:111], a[188:191], v[84:87], a[96:111]
  v_add_f32 v194, v194, v76
  v_add_f32 v195, v195, v77
  v_exp_f32 v79, v79
  v_mfma_f32_32x32x16_bf16 a[112:127], a[188:191], v[92:95], a[112:127]
  ds_read_b128 a[156:159], v249 offset:40960
  v_cvt_pk_bf16_f32 v110, v76, v77
  v_add_f32 v194, v194, v78
  v_add_f32 v195, v195, v79
  v_cvt_pk_bf16_f32 v111, v78, v79
  v_mfma_f32_32x32x16_bf16 v[48:63], a[128:131], v[128:131], v[112:127]
  ds_read_b64_tr_b16 a[160:161], v250 offset:24576
  v_exp_f32 v16, v16
  v_exp_f32 v17, v17
  v_mfma_f32_32x32x16_bf16 v[64:79], a[128:131], v[132:135], v[112:127]
  ds_read_b64_tr_b16 a[162:163], v250 offset:26624
  v_exp_f32 v18, v18
  v_add_f32 v192, v192, v16
  v_mfma_f32_32x32x16_bf16 v[48:63], a[132:135], v[136:139], v[48:63]
  ds_read_b64_tr_b16 a[164:165], v250 offset:28672
  v_add_f32 v193, v193, v17
  v_exp_f32 v19, v19
  v_cvt_pk_bf16_f32 v80, v16, v17
  v_mfma_f32_32x32x16_bf16 v[64:79], a[132:135], v[140:143], v[64:79]
  ds_read_b64_tr_b16 a[166:167], v250 offset:30720
  v_exp_f32 v20, v20
  v_add_f32 v192, v192, v18
  s_waitcnt lgkmcnt(5)
  v_mfma_f32_32x32x16_bf16 v[48:63], a[136:139], v[144:147], v[48:63]
  ds_read_b64_tr_b16 a[168:169], v251 offset:24576
  ds_read_b64_tr_b16 a[170:171], v251 offset:26624
  v_add_f32 v193, v193, v19
  v_exp_f32 v21, v21
  v_mfma_f32_32x32x16_bf16 v[64:79], a[136:139], v[148:151], v[64:79]
  ds_read_b64_tr_b16 a[172:173], v251 offset:28672
  v_cvt_pk_bf16_f32 v81, v18, v19
  v_exp_f32 v22, v22
  v_mfma_f32_32x32x16_bf16 v[48:63], a[140:143], v[152:155], v[48:63]
  ds_read_b64_tr_b16 a[174:175], v251 offset:30720
  v_add_f32 v192, v192, v20
  v_add_f32 v193, v193, v21
  v_exp_f32 v23, v23
  v_mfma_f32_32x32x16_bf16 v[64:79], a[140:143], v[156:159], v[64:79]
  ds_read_b64_tr_b16 a[176:177], v252 offset:24576
  v_cvt_pk_bf16_f32 v82, v20, v21
  v_exp_f32 v24, v24
  v_mfma_f32_32x32x16_bf16 v[48:63], a[144:147], v[160:163], v[48:63]
  ds_read_b64_tr_b16 a[178:179], v252 offset:26624
  buffer_store_dwordx4 a[200:203], v226, s[64:67], s83 offen offset:1024 sc1
  v_mfma_f32_32x32x16_bf16 v[64:79], a[144:147], v[164:167], v[64:79]
  ds_read_b64_tr_b16 a[180:181], v252 offset:28672
  v_add_f32 v192, v192, v22
  v_add_f32 v193, v193, v23
  v_exp_f32 v25, v25
  v_mfma_f32_32x32x16_bf16 v[48:63], a[148:151], v[168:171], v[48:63]
  ds_read_b64_tr_b16 a[182:183], v252 offset:30720
  v_cvt_pk_bf16_f32 v83, v22, v23
  v_exp_f32 v26, v26
  v_mfma_f32_32x32x16_bf16 v[64:79], a[148:151], v[172:175], v[64:79]
  ds_read_b64_tr_b16 a[184:185], v253 offset:24576
  v_add_f32 v192, v192, v24
  v_add_f32 v193, v193, v25
  v_exp_f32 v27, v27
  v_mfma_f32_32x32x16_bf16 v[48:63], a[152:155], v[176:179], v[48:63]
  ds_read_b64_tr_b16 a[186:187], v253 offset:26624
  ds_read_b64_tr_b16 a[188:189], v253 offset:28672
  v_cvt_pk_bf16_f32 v84, v24, v25
  v_mfma_f32_32x32x16_bf16 v[64:79], a[152:155], v[180:183], v[64:79]
  ds_read_b64_tr_b16 a[190:191], v253 offset:30720
  v_exp_f32 v28, v28
  v_add_f32 v192, v192, v26
  v_add_f32 v193, v193, v27
  s_waitcnt lgkmcnt(7)
  v_mfma_f32_32x32x16_bf16 v[48:63], a[156:159], v[184:187], v[48:63]
  v_exp_f32 v29, v29
  v_cvt_pk_bf16_f32 v85, v26, v27
  v_exp_f32 v30, v30
  v_mfma_f32_32x32x16_bf16 v[64:79], a[156:159], v[188:191], v[64:79]
  v_add_f32 v192, v192, v28
  v_add_f32 v193, v193, v29
  v_exp_f32 v31, v31
  v_mfma_f32_32x32x16_bf16 a[0:15], a[160:163], v[96:99], a[0:15]
  s_waitcnt vmcnt(2) lgkmcnt(0)
  s_barrier
  v_readfirstlane_b32 s82, v3
  s_nop 1
  s_cmp_ge_u32 s82, 32
  s_cbranch_scc0 L_spinA
L_backA:
  v_mfma_f32_32x32x16_bf16 a[16:31], a[160:163], v[104:107], a[16:31]
  v_cvt_pk_bf16_f32 v86, v28, v29
  v_exp_f32 v32, v32
  v_add_f32 v192, v192, v30
  v_xor_b32 v242, 0x10000, v242
  v_add_f32 v193, v193, v31
  v_mfma_f32_32x32x16_bf16 a[0:15], a[164:167], v[100:103], a[0:15]
  ds_read_b128 a[128:131], v242 offset:16384
  buffer_store_dwordx4 a[200:203], v226, s[64:67], s83 offen offset:2048 sc1
  v_exp_f32 v33, v33
  v_cvt_pk_bf16_f32 v87, v30, v31
  v_mfma_f32_32x32x16_bf16 a[16:31], a[164:167], v[108:111], a[16:31]
  v_exp_f32 v34, v34
  v_add_f32 v194, v194, v32
  v_xor_b32 v243, 0x10000, v243
  v_add_f32 v195, v195, v33
  v_mfma_f32_32x32x16_bf16 a[32:47], a[168:171], v[96:99], a[32:47]
  ds_read_b128 a[132:135], v243 offset:16384
  s_add_u32 s74, s78, 0
  s_add_u32 m0, s89, 0
  s_nop 0
  buffer_load_dwordx4 v216, s[40:43], s74 offen lds
  v_exp_f32 v35, v35
  v_cvt_pk_bf16_f32 v88, v32, v33
  v_mfma_f32_32x32x16_bf16 a[48:63], a[168:171], v[104:107], a[48:63]
  v_exp_f32 v36, v36
  v_add_f32 v194, v194, v34
  v_add_f32 v195, v195, v35
  v_xor_b32 v244, 0x10000, v244
  v_mfma_f32_32x32x16_bf16 a[32:47], a[172:175], v[100:103], a[32:47]
  ds_read_b128 a[136:139], v244 offset:16384
  v_exp_f32 v37, v37
  v_cvt_pk_bf16_f32 v89, v34, v35
  v_exp_f32 v38, v38
  v_add_f32 v194, v194, v36
  v_mfma_f32_32x32x16_bf16 a[48:63], a[172:175], v[108:111], a[48:63]
  buffer_load_dwordx4 v217, s[40:43], s74 offen offset:1024 lds
  v_add_f32 v195, v195, v37
  v_xor_b32 v245, 0x10000, v245
  v_mfma_f32_32x32x16_bf16 a[64:79], a[176:179], v[96:99], a[64:79]
  ds_read_b128 a[140:143], v245 offset:16384
  v_exp_f32 v39, v39
  v_cvt_pk_bf16_f32 v90, v36, v37
  v_exp_f32 v40, v40
  v_add_f32 v194, v194, v38
  v_add_f32 v195, v195, v39
  v_mfma_f32_32x32x16_bf16 a[80:95], a[176:179], v[104:107], a[80:95]
  v_exp_f32 v41, v41
  v_xor_b32 v246, 0x10000, v246
  v_cvt_pk_bf16_f32 v91, v38, v39
  v_mfma_f32_32x32x16_bf16 a[64:79], a[180:183], v[100:103], a[64:79]
  ds_read_b128 a[144:147], v246 offset:16384
  buffer_load_dwordx4 v218, s[40:43], s74 offen offset:2048 lds
  v_exp_f32 v42, v42
  v_add_f32 v194, v194, v40
  v_add_f32 v195, v195, v41
  v_mfma_f32_32x32x16_bf16 a[80:95], a[180:183], v[108:111], a[80:95]
  v_exp_f32 v43, v43
  v_xor_b32 v247, 0x10000, v247
  v_cvt_pk_bf16_f32 v92, v40, v41
  v_exp_f32 v44, v44
  v_add_f32 v194, v194, v42
  v_mfma_f32_32x32x16_bf16 a[96:111], a[184:187], v[96:99], a[96:111]
  ds_read_b128 a[148:151], v247 offset:16384
  buffer_load_dwordx4 v219, s[40:43], s74 offen offset:3072 lds
  v_add_f32 v195, v195, v43
  v_exp_f32 v45, v45
  v_mfma_f32_32x32x16_bf16 a[112:127], a[184:187], v[104:107], a[112:127]
  v_cvt_pk_bf16_f32 v93, v42, v43
  v_xor_b32 v248, 0x10000, v248
  v_exp_f32 v46, v46
  v_add_f32 v194, v194, v44
  v_mfma_f32_32x32x16_bf16 a[96:111], a[188:191], v[100:103], a[96:111]
  ds_read_b128 a[152:155], v248 offset:16384
  s_add_u32 m0, s89, 4096
  s_nop 0
  buffer_load_dwordx4 v220, s[40:43], s74 offen lds
  v_add_f32 v195, v195, v45
  v_exp_f32 v47, v47
  v_mfma_f32_32x32x16_bf16 a[112:127], a[188:191], v[108:111], a[112:127]
  v_cvt_pk_bf16_f32 v94, v44, v45
  v_xor_b32 v249, 0x10000, v249
  v_add_f32 v194, v194, v46
  v_add_f32 v195, v195, v47
  v_cvt_pk_bf16_f32 v95, v46, v47
  s_waitcnt lgkmcnt(2)
  v_mfma_f32_32x32x16_bf16 v[16:31], a[128:131], v[128:131], v[112:127]
  ds_read_b128 a[156:159], v249 offset:16384
  ds_read_b64_tr_b16 a[160:161], v212 offset:0
  v_exp_f32 v48, v48
  v_exp_f32 v49, v49
  v_exp_f32 v50, v50
  v_mfma_f32_32x32x16_bf16 v[32:47], a[128:131], v[132:135], v[112:127]
  ds_read_b64_tr_b16 a[162:163], v212 offset:2048
  s_add_u32 s83, s23, 49152
  buffer_store_dwordx4 a[200:203], v226, s[64:67], s83 offen sc1
  v_mfma_f32_32x32x16_bf16 v[16:31], a[132:135], v[136:139], v[16:31]
  ds_read_b64_tr_b16 a[164:165], v212 offset:4096
  v_add_f32 v192, v192, v48
  v_add_f32 v193, v193, v49
  v_exp_f32 v51, v51
  v_mfma_f32_32x32x16_bf16 v[32:47], a[132:135], v[140:143], v[32:47]
  ds_read_b64_tr_b16 a[166:167], v212 offset:6144
  ds_read_b64_tr_b16 a[168:169], v213 offset:0
  v_cvt_pk_bf16_f32 v96, v48, v49
  v_exp_f32 v52, v52
  v_add_f32 v192, v192, v50
  v_mfma_f32_32x32x16_bf16 v[16:31], a[136:139], v[144:147], v[16:31]
  s_add_u32 s74, s78, 61440
  s_add_u32 m0, s89, 40960
  s_nop 0
  buffer_load_dwordx4 v216, s[40:43], s74 offen lds
  v_mfma_f32_32x32x16_bf16 v[32:47], a[136:139], v[148:151], v[32:47]
  ds_read_b64_tr_b16 a[170:171], v213 offset:2048
  ds_read_b64_tr_b16 a[172:173], v213 offset:4096
  v_add_f32 v193, v193, v51
  v_exp_f32 v53, v53
  v_cvt_pk_bf16_f32 v97, v50, v51
  v_mfma_f32_32x32x16_bf16 v[16:31], a[140:143], v[152:155], v[16:31]
  ds_read_b64_tr_b16 a[174:175], v213 offset:6144
  v_exp_f32 v54, v54
  v_add_f32 v192, v192, v52
  v_add_f32 v193, v193, v53
  v_mfma_f32_32x32x16_bf16 v[32:47], a[140:143], v[156:159], v[32:47]
  buffer_load_dwordx4 v217, s[40:43], s74 offen offset:1024 lds
  ds_read_b64_tr_b16 a[176:177], v214 offset:0
  v_exp_f32 v55, v55
  v_mfma_f32_32x32x16_bf16 v[16:31], a[144:147], v[160:163], v[16:31]
  ds_read_b64_tr_b16 a[178:179], v214 offset:2048
  v_cvt_pk_bf16_f32 v98, v52, v53
  v_exp_f32 v56, v56
  v_add_f32 v192, v192, v54
  v_add_f32 v193, v193, v55
  v_mfma_f32_32x32x16_bf16 v[32:47], a[144:147], v[164:167], v[32:47]
  ds_read_b64_tr_b16 a[180:181], v214 offset:4096
  buffer_load_dwordx4 v218, s[40:43], s74 offen offset:2048 lds
  v_exp_f32 v57, v57
  s_waitcnt lgkmcnt(6)
  v_mfma_f32_32x32x16_bf16 v[16:31], a[148:151], v[168:171], v[16:31]
  ds_read_b64_tr_b16 a[182:183], v214 offset:6144
  v_cvt_pk_bf16_f32 v99, v54, v55
  v_exp_f32 v58, v58
  v_add_f32 v192, v192, v56
  v_mfma_f32_32x32x16_bf16 v[32:47], a[148:151], v[172:175], v[32:47]
  ds_read_b64_tr_b16 a[184:185], v215 offset:0
  ds_read_b64_tr_b16 a[186:187], v215 offset:2048
  v_add_f32 v193, v193, v57
  v_exp_f32 v59, v59
  v_cvt_pk_bf16_f32 v100, v56, v57
  v_mfma_f32_32x32x16_bf16 v[16:31], a[152:155], v[176:179], v[16:31]
  buffer_load_dwordx4 v219, s[40:43], s74 offen offset:3072 lds
  ds_read_b64_tr_b16 a[188:189], v215 offset:4096
  v_exp_f32 v60, v60
  v_mfma_f32_32x32x16_bf16 v[32:47], a[152:155], v[180:183], v[32:47]
  ds_read_b64_tr_b16 a[190:191], v215 offset:6144
  v_add_f32 v192, v192, v58
  v_add_f32 v193, v193, v59
  v_exp_f32 v61, v61
  v_mfma_f32_32x32x16_bf16 v[16:31], a[156:159], v[184:187], v[16:31]
  s_add_u32 m0, s89, 45056
  s_nop 0
  buffer_load_dwordx4 v220, s[40:43], s74 offen lds
  v_cvt_pk_bf16_f32 v101, v58, v59
  v_exp_f32 v62, v62
  v_mfma_f32_32x32x16_bf16 v[32:47], a[156:159], v[188:191], v[32:47]
  v_add_f32 v192, v192, v60
  v_add_f32 v193, v193, v61
  v_exp_f32 v63, v63
  v_mfma_f32_32x32x16_bf16 a[0:15], a[160:163], v[80:83], a[0:15]
  ds_read_b128 a[128:131], v242 offset:24576
  v_cvt_pk_bf16_f32 v102, v60, v61
  v_exp_f32 v64, v64
  v_add_f32 v192, v192, v62
  v_add_f32 v193, v193, v63
  v_mfma_f32_32x32x16_bf16 a[16:31], a[160:163], v[88:91], a[16:31]
  buffer_store_dwordx4 a[200:203], v226, s[64:67], s83 offen offset:1024 sc1
  v_exp_f32 v65, v65
  v_mfma_f32_32x32x16_bf16 a[0:15], a[164:167], v[84:87], a[0:15]
  ds_read_b128 a[132:135], v243 offset:24576
  v_cvt_pk_bf16_f32 v103, v62, v63
  v_exp_f32 v66, v66
  v_add_f32 v194, v194, v64
  v_add_f32 v195, v195, v65
  v_mfma_f32_32x32x16_bf16 a[16:31], a[164:167], v[92:95], a[16:31]
  v_exp_f32 v67, v67
  v_cvt_pk_bf16_f32 v104, v64, v65
  s_waitcnt lgkmcnt(2)
  v_mfma_f32_32x32x16_bf16 a[32:47], a[168:171], v[80:83], a[32:47]
  s_add_u32 s74, s74, 81920
  s_add_u32 m0, s89, 61440
  s_nop 0
  buffer_load_dwordx4 v216, s[40:43], s74 offen lds
  v_exp_f32 v68, v68
  v_add_f32 v194, v194, v66
  v_mfma_f32_32x32x16_bf16 a[48:63], a[168:171], v[88:91], a[48:63]
  ds_read_b128 a[136:139], v244 offset:24576
  v_add_f32 v195, v195, v67
  v_exp_f32 v69, v69
  v_cvt_pk_bf16_f32 v105, v66, v67
  v_mfma_f32_32x32x16_bf16 a[32:47], a[172:175], v[84:87], a[32:47]
  buffer_load_dwordx4 v217, s[40:43], s74 offen offset:1024 lds
  v_exp_f32 v70, v70
  v_add_f32 v194, v194, v68
  v_mfma_f32_32x32x16_bf16 a[48:63], a[172:175], v[92:95], a[48:63]
  ds_read_b128 a[140:143], v245 offset:24576
  v_add_f32 v195, v195, v69
  v_exp_f32 v71, v71
  v_cvt_pk_bf16_f32 v106, v68, v69
  v_mfma_f32_32x32x16_bf16 a[64:79], a[176:179], v[80:83], a[64:79]
  v_exp_f32 v72, v72
  v_add_f32 v194, v194, v70
  v_add_f32 v195, v195, v71
  v_exp_f32 v73, v73
  v_mfma_f32_32x32x16_bf16 a[80:95], a[176:179], v[88:91], a[80:95]
  ds_read_b128 a[144:147], v246 offset:24576
  buffer_load_dwordx4 v218, s[40:43], s74 offen offset:2048 lds
  v_cvt_pk_bf16_f32 v107, v70, v71
  v_mfma_f32_32x32x16_bf16 a[64:79], a[180:183], v[84:87], a[64:79]
  v_exp_f32 v74, v74
  v_add_f32 v194, v194, v72
  v_add_f32 v195, v195, v73
  v_exp_f32 v75, v75
  v_mfma_f32_32x32x16_bf16 a[80:95], a[180:183], v[92:95], a[80:95]
  ds_read_b128 a[148:151], v247 offset:24576
  v_cvt_pk_bf16_f32 v108, v72, v73
  v_exp_f32 v76, v76
  v_add_f32 v194, v194, v74
  v_mfma_f32_32x32x16_bf16 a[96:111], a[184:187], v[80:83], a[96:111]
  buffer_load_dwordx4 v219, s[40:43], s74 offen offset:3072 lds
  v_add_f32 v195, v195, v75
  v_exp_f32 v77, v77
  v_mfma_f32_32x32x16_bf16 a[112:127], a[184:187], v[88:91], a[112:127]
  ds_read_b128 a[152:155], v248 offset:24576
  v_cvt_pk_bf16_f32 v109, v74, v75
  v_exp_f32 v78, v78
  v_add_f32 v194, v194, v76
  v_add_f32 v195, v195, v77
  v_mfma_f32_32x32x16_bf16 a[96:111], a[188:191], v[84:87], a[96:111]
  s_add_u32 m0, s89, 65536
  s_nop 0
  buffer_load_dwordx4 v220, s[40:43], s74 offen lds
  v_exp_f32 v79, v79
  v_mfma_f32_32x32x16_bf16 a[112:127], a[188:191], v[92:95], a[112:127]
  ds_read_b128 a[156:159], v249 offset:24576
  v_cvt_pk_bf16_f32 v110, v76, v77
  v_add_f32 v194, v194, v78
  v_add_f32 v195, v195, v79
  v_cvt_pk_bf16_f32 v111, v78, v79
  s_waitcnt lgkmcnt(3)
  v_mfma_f32_32x32x16_bf16 v[48:63], a[128:131], v[128:131], v[112:127]
  ds_read_b64_tr_b16 a[160:161], v212 offset:8192
  v_exp_f32 v16, v16
  v_exp_f32 v17, v17
  v_exp_f32 v18, v18
  v_mfma_f32_32x32x16_bf16 v[64:79], a[128:131], v[132:135], v[112:127]
  ds_read_b64_tr_b16 a[162:163], v212 offset:10240
  buffer_store_dwordx4 a[200:203], v226, s[64:67], s83 offen offset:2048 sc1
  v_mfma_f32_32x32x16_bf16 v[48:63], a[132:135], v[136:139], v[48:63]
  ds_read_b64_tr_b16 a[164:165], v212 offset:12288
  ds_read_b64_tr_b16 a[166:167], v212 offset:14336
  v_add_f32 v192, v192, v16
  v_add_f32 v193, v193, v17
  v_exp_f32 v19, v19
  v_cvt_pk_bf16_f32 v80, v16, v17
  v_mfma_f32_32x32x16_bf16 v[64:79], a[132:135], v[140:143], v[64:79]
  ds_read_b64_tr_b16 a[168:169], v213 offset:8192
  v_exp_f32 v20, v20
  v_add_f32 v192, v192, v18
  v_mfma_f32_32x32x16_bf16 v[48:63], a[136:139], v[144:147], v[48:63]
  s_add_u32 s74, s88, 0
  s_and_b32 s74, s74, 7
  s_lshl2_add_u32 s74, s74, s7
  s_mul_i32 s74, s74, 163840
  s_add_u32 s74, s74, 81920
  s_add_u32 m0, s89, 20480
  s_nop 0
  buffer_load_dwordx4 v216, s[36:39], s74 offen lds
  v_mfma_f32_32x32x16_bf16 v[64:79], a[136:139], v[148:151], v[64:79]
  ds_read_b64_tr_b16 a[170:171], v213 offset:10240
  v_add_f32 v193, v193, v19
  v_exp_f32 v21, v21
  v_mfma_f32_32x32x16_bf16 v[48:63], a[140:143], v[152:155], v[48:63]
  ds_read_b64_tr_b16 a[172:173], v213 offset:12288
  ds_read_b64_tr_b16 a[174:175], v213 offset:14336
  v_cvt_pk_bf16_f32 v81, v18, v19
  v_exp_f32 v22, v22
  v_add_f32 v192, v192, v20
  v_mfma_f32_32x32x16_bf16 v[64:79], a[140:143], v[156:159], v[64:79]
  buffer_load_dwordx4 v217, s[36:39], s74 offen offset:1024 lds
  v_add_f32 v193, v193, v21
  v_exp_f32 v23, v23
  v_mfma_f32_32x32x16_bf16 v[48:63], a[144:147], v[160:163], v[48:63]
  ds_read_b64_tr_b16 a[176:177], v214 offset:8192
  ds_read_b64_tr_b16 a[178:179], v214 offset:10240
  v_cvt_pk_bf16_f32 v82, v20, v21
  v_exp_f32 v24, v24
  v_add_f32 v192, v192, v22
  v_mfma_f32_32x32x16_bf16 v[64:79], a[144:147], v[164:167], v[64:79]
  ds_read_b64_tr_b16 a[180:181], v214 offset:12288
  v_add_f32 v193, v193, v23
  v_exp_f32 v25, v25
  s_waitcnt lgkmcnt(6)
  v_mfma_f32_32x32x16_bf16 v[48:63], a[148:151], v[168:171], v[48:63]
  buffer_load_dwordx4 v218, s[36:39], s74 offen offset:2048 lds
  ds_read_b64_tr_b16 a[182:183], v214 offset:14336
  v_cvt_pk_bf16_f32 v83, v22, v23
  v_exp_f32 v26, v26
  v_mfma_f32_32x32x16_bf16 v[64:79], a[148:151], v[172:175], v[64:79]
  ds_read_b64_tr_b16 a[184:185], v215 offset:8192
  ds_read_b64_tr_b16 a[186:187], v215 offset:10240
  v_add_f32 v192, v192, v24
  v_add_f32 v193, v193, v25
  v_exp_f32 v27, v27
  v_mfma_f32_32x32x16_bf16 v[48:63], a[152:155], v[176:179], v[48:63]
  buffer_load_dwordx4 v219, s[36:39], s74 offen offset:3072 lds
  ds_read_b64_tr_b16 a[188:189], v215 offset:12288
  v_cvt_pk_bf16_f32 v84, v24, v25
  v_mfma_f32_32x32x16_bf16 v[64:79], a[152:155], v[180:183], v[64:79]
  ds_read_b64_tr_b16 a[190:191], v215 offset:14336
  v_exp_f32 v28, v28
  v_add_f32 v192, v192, v26
  v_add_f32 v193, v193, v27
  v_exp_f32 v29, v29
  v_mfma_f32_32x32x16_bf16 v[48:63], a[156:159], v[184:187], v[48:63]
  s_add_u32 m0, s89, 24576
  s_nop 0
  buffer_load_dwordx4 v220, s[36:39], s74 offen lds
  v_cvt_pk_bf16_f32 v85, v26, v27
  v_exp_f32 v30, v30
  v_mfma_f32_32x32x16_bf16 v[64:79], a[156:159], v[188:191], v[64:79]
  v_add_f32 v192, v192, v28
  v_add_f32 v193, v193, v29
  v_exp_f32 v31, v31
  v_mfma_f32_32x32x16_bf16 a[0:15], a[160:163], v[96:99], a[0:15]
  ds_read_b128 a[128:131], v242 offset:32768
  v_cvt_pk_bf16_f32 v86, v28, v29
  v_exp_f32 v32, v32
  v_add_f32 v192, v192, v30
  v_add_f32 v193, v193, v31
  v_mfma_f32_32x32x16_bf16 a[16:31], a[160:163], v[104:107], a[16:31]
  s_add_u32 s83, s23, 61440
  buffer_store_dwordx4 a[200:203], v226, s[64:67], s83 offen sc1
  v_mfma_f32_32x32x16_bf16 a[0:15], a[164:167], v[100:103], a[0:15]
  v_exp_f32 v33, v33
  v_cvt_pk_bf16_f32 v87, v30, v31
  v_exp_f32 v34, v34
  v_add_f32 v194, v194, v32
  v_mfma_f32_32x32x16_bf16 a[16:31], a[164:167], v[108:111], a[16:31]
  ds_read_b128 a[132:135], v243 offset:32768
  v_add_f32 v195, v195, v33
  v_exp_f32 v35, v35
  v_cvt_pk_bf16_f32 v88, v32, v33
  s_waitcnt lgkmcnt(2)
  v_mfma_f32_32x32x16_bf16 a[32:47], a[168:171], v[96:99], a[32:47]
  s_add_u32 s73, s79, 0
  buffer_load_dwordx4 v[196:199], v225, s[52:55], s73 offen sc1
  v_exp_f32 v36, v36
  v_add_f32 v194, v194, v34
  v_mfma_f32_32x32x16_bf16 a[48:63], a[168:171], v[104:107], a[48:63]
  ds_read_b128 a[136:139], v244 offset:32768
  v_add_f32 v195, v195, v35
  v_exp_f32 v37, v37
  v_mfma_f32_32x32x16_bf16 a[32:47], a[172:175], v[100:103], a[32:47]
  v_cvt_pk_bf16_f32 v89, v34, v35
  v_exp_f32 v38, v38
  v_add_f32 v194, v194, v36
  v_add_f32 v195, v195, v37
  v_mfma_f32_32x32x16_bf16 a[48:63], a[172:175], v[108:111], a[48:63]
  ds_read_b128 a[140:143], v245 offset:32768
  v_exp_f32 v39, v39
  v_cvt_pk_bf16_f32 v90, v36, v37
  v_exp_f32 v40, v40
  v_mfma_f32_32x32x16_bf16 a[64:79], a[176:179], v[96:99], a[64:79]
  buffer_load_dwordx4 v[200:203], v225, s[52:55], s73 offen offset:1024 sc1
  v_add_f32 v194, v194, v38
  v_add_f32 v195, v195, v39
  v_mfma_f32_32x32x16_bf16 a[80:95], a[176:179], v[104:107], a[80:95]
  ds_read_b128 a[144:147], v246 offset:32768
  v_exp_f32 v41, v41
  v_cvt_pk_bf16_f32 v91, v38, v39
  v_exp_f32 v42, v42
  v_mfma_f32_32x32x16_bf16 a[64:79], a[180:183], v[100:103], a[64:79]
  ds_read_b128 a[148:151], v247 offset:32768
  v_add_f32 v194, v194, v40
  v_add_f32 v195, v195, v41
  v_exp_f32 v43, v43
  v_mfma_f32_32x32x16_bf16 a[80:95], a[180:183], v[108:111], a[80:95]
  buffer_load_dwordx4 v[204:207], v225, s[52:55], s73 offen offset:2048 sc1
  v_cvt_pk_bf16_f32 v92, v40, v41
  v_mfma_f32_32x32x16_bf16 a[96:111], a[184:187], v[96:99], a[96:111]
  v_exp_f32 v44, v44
  v_add_f32 v194, v194, v42
  v_add_f32 v195, v195, v43
  v_exp_f32 v45, v45
  v_mfma_f32_32x32x16_bf16 a[112:127], a[184:187], v[104:107], a[112:127]
  ds_read_b128 a[152:155], v248 offset:32768
  v_cvt_pk_bf16_f32 v93, v42, v43
  v_exp_f32 v46, v46
  v_add_f32 v194, v194, v44
  v_add_f32 v195, v195, v45
  v_mfma_f32_32x32x16_bf16 a[96:111], a[188:191], v[100:103], a[96:111]
  buffer_load_dwordx4 v[208:211], v225, s[52:55], s73 offen offset:3072 sc1
  v_exp_f32 v47, v47
  v_mfma_f32_32x32x16_bf16 a[112:127], a[188:191], v[108:111], a[112:127]
  ds_read_b128 a[156:159], v249 offset:32768
  v_cvt_pk_bf16_f32 v94, v44, v45
  v_add_f32 v194, v194, v46
  v_add_f32 v195, v195, v47
  v_cvt_pk_bf16_f32 v95, v46, v47
  s_waitcnt lgkmcnt(3)
  v_mfma_f32_32x32x16_bf16 v[16:31], a[128:131], v[128:131], v[112:127]
  ds_read_b64_tr_b16 a[160:161], v212 offset:16384
  v_exp_f32 v48, v48
  v_exp_f32 v49, v49
  v_mfma_f32_32x32x16_bf16 v[32:47], a[128:131], v[132:135], v[112:127]
  ds_read_b64_tr_b16 a[162:163], v212 offset:18432
  v_exp_f32 v50, v50
  v_add_f32 v192, v192, v48
  v_add_f32 v193, v193, v49
  v_mfma_f32_32x32x16_bf16 v[16:31], a[132:135], v[136:139], v[16:31]
  buffer_store_dwordx4 a[200:203], v226, s[64:67], s83 offen offset:1024 sc1
  ds_read_b64_tr_b16 a[164:165], v212 offset:20480
  v_mfma_f32_32x32x16_bf16 v[32:47], a[132:135], v[140:143], v[32:47]
  ds_read_b64_tr_b16 a[166:167], v212 offset:22528
  v_exp_f32 v51, v51
  v_cvt_pk_bf16_f32 v96, v48, v49
  v_exp_f32 v52, v52
  v_mfma_f32_32x32x16_bf16 v[16:31], a[136:139], v[144:147], v[16:31]
  ds_read_b64_tr_b16 a[168:169], v213 offset:16384
  ds_read_b64_tr_b16 a[170:171], v213 offset:18432
  v_add_f32 v192, v192, v50
  v_add_f32 v193, v193, v51
  v_exp_f32 v53, v53
  v_mfma_f32_32x32x16_bf16 v[32:47], a[136:139], v[148:151], v[32:47]
  ds_read_b64_tr_b16 a[172:173], v213 offset:20480
  v_cvt_pk_bf16_f32 v97, v50, v51
  v_exp_f32 v54, v54
  v_add_f32 v192, v192, v52
  v_mfma_f32_32x32x16_bf16 v[16:31], a[140:143], v[152:155], v[16:31]
  s_add_u32 s73, s79, 4096
  buffer_load_dwordx4 v[232:235], v225, s[52:55], s73 offen sc1
  v_mfma_f32_32x32x16_bf16 v[32:47], a[140:143], v[156:159], v[32:47]
  ds_read_b64_tr_b16 a[174:175], v213 offset:22528
  ds_read_b64_tr_b16 a[176:177], v214 offset:16384
  v_add_f32 v193, v193, v53
  v_exp_f32 v55, v55
  v_cvt_pk_bf16_f32 v98, v52, v53
  v_mfma_f32_32x32x16_bf16 v[16:31], a[144:147], v[160:163], v[16:31]
  ds_read_b64_tr_b16 a[178:179], v214 offset:18432
  v_exp_f32 v56, v56
  v_add_f32 v192, v192, v54
  v_add_f32 v193, v193, v55
  v_mfma_f32_32x32x16_bf16 v[32:47], a[144:147], v[164:167], v[32:47]
  ds_read_b64_tr_b16 a[180:181], v214 offset:20480
  ds_read_b64_tr_b16 a[182:183], v214 offset:22528
  v_exp_f32 v57, v57
  v_cvt_pk_bf16_f32 v99, v54, v55
  s_waitcnt lgkmcnt(6)
  v_mfma_f32_32x32x16_bf16 v[16:31], a[148:151], v[168:171], v[16:31]
  buffer_load_dwordx4 v[236:239], v225, s[52:55], s73 offen offset:1024 sc1
  v_exp_f32 v58, v58
  v_mfma_f32_32x32x16_bf16 v[32:47], a[148:151], v[172:175], v[32:47]
  ds_read_b64_tr_b16 a[184:185], v215 offset:16384
  v_add_f32 v192, v192, v56
  v_add_f32 v193, v193, v57
  v_exp_f32 v59, v59
  v_mfma_f32_32x32x16_bf16 v[16:31], a[152:155], v[176:179], v[16:31]
  ds_read_b64_tr_b16 a[186:187], v215 offset:18432
  ds_read_b64_tr_b16 a[188:189], v215 offset:20480
  v_cvt_pk_bf16_f32 v100, v56, v57
  v_exp_f32 v60, v60
  v_mfma_f32_32x32x16_bf16 v[32:47], a[152:155], v[180:183], v[32:47]
  ds_read_b64_tr_b16 a[190:191], v215 offset:22528
  v_add_f32 v192, v192, v58
  v_add_f32 v193, v193, v59
  v_exp_f32 v61, v61
  v_mfma_f32_32x32x16_bf16 v[16:31], a[156:159], v[184:187], v[16:31]
  buffer_load_dwordx4 a[240:243], v225, s[52:55], s73 offen offset:2048 sc1
  v_cvt_pk_bf16_f32 v101, v58, v59
  v_mfma_f32_32x32x16_bf16 v[32:47], a[156:159], v[188:191], v[32:47]
  v_exp_f32 v62, v62
  v_add_f32 v192, v192, v60
  v_add_f32 v193, v193, v61
  v_exp_f32 v63, v63
  v_mfma_f32_32x32x16_bf16 a[0:15], a[160:163], v[80:83], a[0:15]
  ds_read_b128 a[128:131], v242 offset:40960
  v_cvt_pk_bf16_f32 v102, v60, v61
  v_exp_f32 v64, v64
  v_add_f32 v192, v192, v62
  v_mfma_f32_32x32x16_bf16 a[16:31], a[160:163], v[88:91], a[16:31]
  v_add_f32 v193, v193, v63
  v_exp_f32 v65, v65
  v_cvt_pk_bf16_f32 v103, v62, v63
  v_mfma_f32_32x32x16_bf16 a[0:15], a[164:167], v[84:87], a[0:15]
  buffer_store_dwordx4 a[200:203], v226, s[64:67], s83 offen offset:2048 sc1
  v_exp_f32 v66, v66
  v_add_f32 v194, v194, v64
  v_mfma_f32_32x32x16_bf16 a[16:31], a[164:167], v[92:95], a[16:31]
  ds_read_b128 a[132:135], v243 offset:40960
  v_add_f32 v195, v195, v65
  v_exp_f32 v67, v67
  v_cvt_pk_bf16_f32 v104, v64, v65
  v_mfma_f32_32x32x16_bf16 a[32:47], a[168:171], v[80:83], a[32:47]
  ds_read_b128 a[136:139], v244 offset:40960
  v_exp_f32 v68, v68
  v_add_f32 v194, v194, v66
  v_add_f32 v195, v195, v67
  v_mfma_f32_32x32x16_bf16 a[48:63], a[168:171], v[88:91], a[48:63]
  v_exp_f32 v69, v69
  v_cvt_pk_bf16_f32 v105, v66, v67
  v_exp_f32 v70, v70
  s_waitcnt lgkmcnt(3)
  v_mfma_f32_32x32x16_bf16 a[32:47], a[172:175], v[84:87], a[32:47]
  s_add_u32 s73, s79, 4096
  buffer_load_dwordx4 a[244:247], v225, s[52:55], s73 offen offset:3072 sc1
  v_add_f32 v194, v194, v68
  v_add_f32 v195, v195, v69
  v_mfma_f32_32x32x16_bf16 a[48:63], a[172:175], v[92:95], a[48:63]
  ds_read_b128 a[140:143], v245 offset:40960
  v_exp_f32 v71, v71
  v_cvt_pk_bf16_f32 v106, v68, v69
  v_exp_f32 v72, v72
  v_mfma_f32_32x32x16_bf16 a[64:79], a[176:179], v[80:83], a[64:79]
  v_add_f32 v194, v194, v70
  v_add_f32 v195, v195, v71
  v_exp_f32 v73, v73
  v_mfma_f32_32x32x16_bf16 a[80:95], a[176:179], v[88:91], a[80:95]
  ds_read_b128 a[144:147], v246 offset:40960
  v_cvt_pk_bf16_f32 v107, v70, v71
  v_exp_f32 v74, v74
  v_add_f32 v194, v194, v72
  v_mfma_f32_32x32x16_bf16 a[64:79], a[180:183], v[84:87], a[64:79]
  s_add_u32 s73, s79, 8192
  buffer_load_dwordx4 a[248:251], v225, s[52:55], s73 offen sc1
  v_add_f32 v195, v195, v73
  v_mfma_f32_32x32x16_bf16 a[80:95], a[180:183], v[92:95], a[80:95]
  ds_read_b128 a[148:151], v247 offset:40960
  v_exp_f32 v75, v75
  v_cvt_pk_bf16_f32 v108, v72, v73
  v_exp_f32 v76, v76
  v_mfma_f32_32x32x16_bf16 a[96:111], a[184:187], v[80:83], a[96:111]
  v_add_f32 v194, v194, v74
  v_add_f32 v195, v195, v75
  v_exp_f32 v77, v77
  v_cvt_pk_bf16_f32 v109, v74, v75
  v_mfma_f32_32x32x16_bf16 a[112:127], a[184:187], v[88:91], a[112:127]
  ds_read_b128 a[152:155], v248 offset:40960
  v_exp_f32 v78, v78
  v_add_f32 v194, v194, v76
  v_add_f32 v195, v195, v77
  v_mfma_f32_32x32x16_bf16 a[96:111], a[188:191], v[84:87], a[96:111]
  buffer_load_dwordx4 a[252:255], v225, s[52:55], s73 offen offset:1024 sc1
  v_exp_f32 v79, v79
  v_mfma_f32_32x32x16_bf16 a[112:127], a[188:191], v[92:95], a[112:127]
  ds_read_b128 a[156:159], v249 offset:40960
  v_cvt_pk_bf16_f32 v110, v76, v77
  v_add_f32 v194, v194, v78
  v_add_f32 v195, v195, v79
  v_cvt_pk_bf16_f32 v111, v78, v79
  s_waitcnt lgkmcnt(3)
  v_mfma_f32_32x32x16_bf16 v[48:63], a[128:131], v[128:131], v[112:127]
  ds_read_b64_tr_b16 a[160:161], v212 offset:24576
  v_exp_f32 v16, v16
  v_exp_f32 v17, v17
  v_mfma_f32_32x32x16_bf16 v[64:79], a[128:131], v[132:135], v[112:127]
  ds_read_b64_tr_b16 a[162:163], v212 offset:26624
  v_exp_f32 v18, v18
  v_add_f32 v192, v192, v16
  v_add_f32 v193, v193, v17
  v_mfma_f32_32x32x16_bf16 v[48:63], a[132:135], v[136:139], v[48:63]
  ds_read_b64_tr_b16 a[164:165], v212 offset:28672
  v_exp_f32 v19, v19
  v_cvt_pk_bf16_f32 v80, v16, v17
  v_mfma_f32_32x32x16_bf16 v[64:79], a[132:135], v[140:143], v[64:79]
  ds_read_b64_tr_b16 a[166:167], v212 offset:30720
  ds_read_b64_tr_b16 a[168:169], v213 offset:24576
  v_exp_f32 v20, v20
  v_add_f32 v192, v192, v18
  v_mfma_f32_32x32x16_bf16 v[48:63], a[136:139], v[144:147], v[48:63]
  s_add_u32 s73, s79, 8192
  buffer_load_dwordx4 v[240:243], v225, s[52:55], s73 offen offset:2048 sc1
  v_mfma_f32_32x32x16_bf16 v[64:79], a[136:139], v[148:151], v[64:79]
  ds_read_b64_tr_b16 a[170:171], v213 offset:26624
  v_add_f32 v193, v193, v19
  v_exp_f32 v21, v21
  v_cvt_pk_bf16_f32 v81, v18, v19
  v_mfma_f32_32x32x16_bf16 v[48:63], a[140:143], v[152:155], v[48:63]
  ds_read_b64_tr_b16 a[172:173], v213 offset:28672
  ds_read_b64_tr_b16 a[174:175], v213 offset:30720
  v_exp_f32 v22, v22
  v_add_f32 v192, v192, v20
  v_mfma_f32_32x32x16_bf16 v[64:79], a[140:143], v[156:159], v[64:79]
  ds_read_b64_tr_b16 a[176:177], v214 offset:24576
  v_add_f32 v193, v193, v21
  v_exp_f32 v23, v23
  v_cvt_pk_bf16_f32 v82, v20, v21
  v_mfma_f32_32x32x16_bf16 v[48:63], a[144:147], v[160:163], v[48:63]
  ds_read_b64_tr_b16 a[178:179], v214 offset:26624
  v_exp_f32 v24, v24
  v_add_f32 v192, v192, v22
  v_mfma_f32_32x32x16_bf16 v[64:79], a[144:147], v[164:167], v[64:79]
  ds_read_b64_tr_b16 a[180:181], v214 offset:28672
  v_add_f32 v193, v193, v23
  v_exp_f32 v25, v25
  v_cvt_pk_bf16_f32 v83, v22, v23
  s_waitcnt lgkmcnt(6)
  v_mfma_f32_32x32x16_bf16 v[48:63], a[148:151], v[168:171], v[48:63]
  ds_read_b64_tr_b16 a[182:183], v214 offset:30720
  ds_read_b64_tr_b16 a[184:185], v215 offset:24576
  v_exp_f32 v26, v26
  v_add_f32 v192, v192, v24
  v_mfma_f32_32x32x16_bf16 v[64:79], a[148:151], v[172:175], v[64:79]
  ds_read_b64_tr_b16 a[186:187], v215 offset:26624
  v_add_f32 v193, v193, v25
  v_exp_f32 v27, v27
  v_cvt_pk_bf16_f32 v84, v24, v25
  v_mfma_f32_32x32x16_bf16 v[48:63], a[152:155], v[176:179], v[48:63]
  buffer_load_dwordx4 v[244:247], v225, s[52:55], s73 offen offset:3072 sc1
  ds_read_b64_tr_b16 a[188:189], v215 offset:28672
  v_mfma_f32_32x32x16_bf16 v[64:79], a[152:155], v[180:183], v[64:79]
  ds_read_b64_tr_b16 a[190:191], v215 offset:30720
  v_exp_f32 v28, v28
  v_add_f32 v192, v192, v26
  v_mfma_f32_32x32x16_bf16 v[48:63], a[156:159], v[184:187], v[48:63]
  v_add_f32 v193, v193, v27
  v_exp_f32 v29, v29
  v_cvt_pk_bf16_f32 v85, v26, v27
  v_exp_f32 v30, v30
  v_mfma_f32_32x32x16_bf16 v[64:79], a[156:159], v[188:191], v[64:79]
  v_add_f32 v192, v192, v28
  v_add_f32 v193, v193, v29
  v_exp_f32 v31, v31
  v_mfma_f32_32x32x16_bf16 a[0:15], a[160:163], v[96:99], a[0:15]
  s_waitcnt vmcnt(21) lgkmcnt(0)
  s_barrier
  v_mfma_f32_32x32x16_bf16 a[16:31], a[160:163], v[104:107], a[16:31]
  ds_read_b64_tr_b16 a[128:129], v212 offset:32768
  s_add_u32 s74, s78, 225280
  s_add_u32 m0, s89, 81920
  s_nop 0
  buffer_load_dwordx4 v216, s[40:43], s74 offen lds
  v_cvt_pk_bf16_f32 v86, v28, v29
  v_exp_f32 v32, v32
  v_mfma_f32_32x32x16_bf16 a[0:15], a[164:167], v[100:103], a[0:15]
  ds_read_b64_tr_b16 a[130:131], v212 offset:34816
  v_add_f32 v192, v192, v30
  v_add_f32 v193, v193, v31
  v_exp_f32 v33, v33
  v_cvt_pk_bf16_f32 v87, v30, v31
  v_mfma_f32_32x32x16_bf16 a[16:31], a[164:167], v[108:111], a[16:31]
  buffer_load_dwordx4 v217, s[40:43], s74 offen offset:1024 lds
  ds_read_b64_tr_b16 a[132:133], v212 offset:36864
  v_exp_f32 v34, v34
  v_add_f32 v194, v194, v32
  v_mfma_f32_32x32x16_bf16 a[32:47], a[168:171], v[96:99], a[32:47]
  ds_read_b64_tr_b16 a[134:135], v212 offset:38912
  buffer_load_dwordx4 v218, s[40:43], s74 offen offset:2048 lds
  v_add_f32 v195, v195, v33
  v_exp_f32 v35, v35
  v_cvt_pk_bf16_f32 v88, v32, v33
  v_mfma_f32_32x32x16_bf16 a[48:63], a[168:171], v[104:107], a[48:63]
  ds_read_b64_tr_b16 a[136:137], v213 offset:32768
  ds_read_b64_tr_b16 a[138:139], v213 offset:34816
  v_exp_f32 v36, v36
  v_add_f32 v194, v194, v34
  v_add_f32 v195, v195, v35
  v_exp_f32 v37, v37
  v_mfma_f32_32x32x16_bf16 a[32:47], a[172:175], v[100:103], a[32:47]
  buffer_load_dwordx4 v219, s[40:43], s74 offen offset:3072 lds
  v_cvt_pk_bf16_f32 v89, v34, v35
  v_exp_f32 v38, v38
  v_add_f32 v194, v194, v36
  v_mfma_f32_32x32x16_bf16 a[48:63], a[172:175], v[108:111], a[48:63]
  ds_read_b64_tr_b16 a[140:141], v213 offset:36864
  s_add_u32 m0, s89, 86016
  s_nop 0
  buffer_load_dwordx4 v220, s[40:43], s74 offen lds
  v_add_f32 v195, v195, v37
  v_exp_f32 v39, v39
  v_mfma_f32_32x32x16_bf16 a[64:79], a[176:179], v[96:99], a[64:79]
  ds_read_b64_tr_b16 a[142:143], v213 offset:38912
  ds_read_b64_tr_b16 a[144:145], v214 offset:32768
  v_cvt_pk_bf16_f32 v90, v36, v37
  v_exp_f32 v40, v40
  v_add_f32 v194, v194, v38
  v_add_f32 v195, v195, v39
  v_mfma_f32_32x32x16_bf16 a[80:95], a[176:179], v[104:107], a[80:95]
  s_add_u32 s74, s74, 81920
  s_add_u32 m0, s89, 102400
  s_nop 0
  buffer_load_dwordx4 v216, s[40:43], s74 offen lds
  v_exp_f32 v41, v41
  v_mfma_f32_32x32x16_bf16 a[64:79], a[180:183], v[100:103], a[64:79]
  ds_read_b64_tr_b16 a[146:147], v214 offset:34816
  buffer_load_dwordx4 v217, s[40:43], s74 offen offset:1024 lds
  v_cvt_pk_bf16_f32 v91, v38, v39
  v_exp_f32 v42, v42
  v_add_f32 v194, v194, v40
  v_add_f32 v195, v195, v41
  v_mfma_f32_32x32x16_bf16 a[80:95], a[180:183], v[108:111], a[80:95]
  ds_read_b64_tr_b16 a[148:149], v214 offset:36864
  v_exp_f32 v43, v43
  v_cvt_pk_bf16_f32 v92, v40, v41
  v_exp_f32 v44, v44
  v_mfma_f32_32x32x16_bf16 a[96:111], a[184:187], v[96:99], a[96:111]
  ds_read_b64_tr_b16 a[150:151], v214 offset:38912
  buffer_load_dwordx4 v218, s[40:43], s74 offen offset:2048 lds
  ds_read_b64_tr_b16 a[152:153], v215 offset:32768
  v_add_f32 v194, v194, v42
  v_add_f32 v195, v195, v43
  v_mfma_f32_32x32x16_bf16 a[112:127], a[184:187], v[104:107], a[112:127]
  ds_read_b64_tr_b16 a[154:155], v215 offset:34816
  buffer_load_dwordx4 v219, s[40:43], s74 offen offset:3072 lds
  v_exp_f32 v45, v45
  v_cvt_pk_bf16_f32 v93, v42, v43
  v_exp_f32 v46, v46
  v_mfma_f32_32x32x16_bf16 a[96:111], a[188:191], v[100:103], a[96:111]
  ds_read_b64_tr_b16 a[156:157], v215 offset:36864
  v_add_f32 v194, v194, v44
  v_add_f32 v195, v195, v45
  v_exp_f32 v47, v47
  v_cvt_pk_bf16_f32 v94, v44, v45
  v_add_f32 v194, v194, v46
  v_mfma_f32_32x32x16_bf16 a[112:127], a[188:191], v[108:111], a[112:127]
  s_add_u32 m0, s89, 106496
  s_nop 0
  buffer_load_dwordx4 v220, s[40:43], s74 offen lds
  ds_read_b64_tr_b16 a[158:159], v215 offset:38912
  v_add_f32 v195, v195, v47
  v_cvt_pk_bf16_f32 v95, v46, v47
  s_waitcnt lgkmcnt(5)
  v_mfma_f32_32x32x16_bf16 a[0:15], a[128:131], v[80:83], a[0:15]
  ds_read_b64_tr_b16 a[160:161], v212 offset:40960
  v_exp_f32 v48, v48
  v_exp_f32 v49, v49
  v_exp_f32 v50, v50
  v_add_f32 v192, v192, v48
  v_mfma_f32_32x32x16_bf16 a[16:31], a[128:131], v[88:91], a[16:31]
  s_add_u32 s74, s78, 389120
  s_add_u32 m0, s89, 122880
  s_nop 0
  buffer_load_dwordx4 v216, s[40:43], s74 offen lds
  ds_read_b64_tr_b16 a[162:163], v212 offset:43008
  v_add_f32 v193, v193, v49
  v_exp_f32 v51, v51
  v_cvt_pk_bf16_f32 v96, v48, v49
  v_exp_f32 v52, v52
  v_mfma_f32_32x32x16_bf16 a[0:15], a[132:135], v[84:87], a[0:15]
  ds_read_b64_tr_b16 a[164:165], v212 offset:45056
  buffer_load_dwordx4 v217, s[40:43], s74 offen offset:1024 lds
  v_add_f32 v192, v192, v50
  v_add_f32 v193, v193, v51
  v_exp_f32 v53, v53
  v_cvt_pk_bf16_f32 v97, v50, v51
  v_exp_f32 v54, v54
  v_mfma_f32_32x32x16_bf16 a[16:31], a[132:135], v[92:95], a[16:31]
  ds_read_b64_tr_b16 a[166:167], v212 offset:47104
  v_add_f32 v192, v192, v52
  v_add_f32 v193, v193, v53
  v_exp_f32 v55, v55
  v_cvt_pk_bf16_f32 v98, v52, v53
  v_exp_f32 v56, v56
  v_add_f32 v192, v192, v54
  v_mfma_f32_32x32x16_bf16 a[32:47], a[136:139], v[80:83], a[32:47]
  buffer_load_dwordx4 v218, s[40:43], s74 offen offset:2048 lds
  ds_read_b64_tr_b16 a[168:169], v213 offset:40960
  v_add_f32 v193, v193, v55
  v_exp_f32 v57, v57
  v_cvt_pk_bf16_f32 v99, v54, v55
  v_exp_f32 v58, v58
  v_mfma_f32_32x32x16_bf16 a[48:63], a[136:139], v[88:91], a[48:63]
  ds_read_b64_tr_b16 a[170:171], v213 offset:43008
  v_add_f32 v192, v192, v56
  v_add_f32 v193, v193, v57
  v_exp_f32 v59, v59
  v_cvt_pk_bf16_f32 v100, v56, v57
  v_exp_f32 v60, v60
  v_add_f32 v192, v192, v58
  v_add_f32 v193, v193, v59
  v_mfma_f32_32x32x16_bf16 a[32:47], a[140:143], v[84:87], a[32:47]
  buffer_load_dwordx4 v219, s[40:43], s74 offen offset:3072 lds
  ds_read_b64_tr_b16 a[172:173], v213 offset:45056
  v_exp_f32 v61, v61
  v_cvt_pk_bf16_f32 v101, v58, v59
  v_exp_f32 v62, v62
  v_add_f32 v192, v192, v60
  v_mfma_f32_32x32x16_bf16 a[48:63], a[140:143], v[92:95], a[48:63]
  ds_read_b64_tr_b16 a[174:175], v213 offset:47104
  v_add_f32 v193, v193, v61
  v_exp_f32 v63, v63
  v_cvt_pk_bf16_f32 v102, v60, v61
  v_exp_f32 v64, v64
  v_add_f32 v192, v192, v62
  v_add_f32 v193, v193, v63
  v_mfma_f32_32x32x16_bf16 a[64:79], a[144:147], v[80:83], a[64:79]
  s_add_u32 m0, s89, 126976
  s_nop 0
  buffer_load_dwordx4 v220, s[40:43], s74 offen lds
  ds_read_b64_tr_b16 a[176:177], v214 offset:40960
  v_exp_f32 v65, v65
  v_cvt_pk_bf16_f32 v103, v62, v63
  v_exp_f32 v66, v66
  v_add_f32 v194, v194, v64
  v_mfma_f32_32x32x16_bf16 a[80:95], a[144:147], v[88:91], a[80:95]
  ds_read_b64_tr_b16 a[178:179], v214 offset:43008
  v_add_f32 v195, v195, v65
  v_exp_f32 v67, v67
  v_cvt_pk_bf16_f32 v104, v64, v65
  v_exp_f32 v68, v68
  v_add_f32 v194, v194, v66
  s_waitcnt lgkmcnt(3)
  v_mfma_f32_32x32x16_bf16 a[64:79], a[148:151], v[84:87], a[64:79]
  s_add_u32 s73, s79, 12288
  buffer_load_dwordx4 v[112:115], v225, s[52:55], s73 offen sc1
  ds_read_b64_tr_b16 a[180:181], v214 offset:45056
  v_add_f32 v195, v195, v67
  v_exp_f32 v69, v69
  v_cvt_pk_bf16_f32 v105, v66, v67
  v_exp_f32 v70, v70
  v_add_f32 v194, v194, v68
  v_mfma_f32_32x32x16_bf16 a[80:95], a[148:151], v[92:95], a[80:95]
  ds_read_b64_tr_b16 a[182:183], v214 offset:47104
  buffer_load_dwordx4 v[116:119], v225, s[52:55], s73 offen offset:1024 sc1
  v_add_f32 v195, v195, v69
  v_exp_f32 v71, v71
  v_cvt_pk_bf16_f32 v106, v68, v69
  v_exp_f32 v72, v72
  v_mfma_f32_32x32x16_bf16 a[96:111], a[152:155], v[80:83], a[96:111]
  ds_read_b64_tr_b16 a[184:185], v215 offset:40960
  v_add_f32 v194, v194, v70
  v_add_f32 v195, v195, v71
  v_exp_f32 v73, v73
  v_cvt_pk_bf16_f32 v107, v70, v71
  v_exp_f32 v74, v74
  v_add_f32 v194, v194, v72
  v_add_f32 v195, v195, v73
  v_mfma_f32_32x32x16_bf16 a[112:127], a[152:155], v[88:91], a[112:127]
  buffer_load_dwordx4 v[120:123], v225, s[52:55], s73 offen offset:2048 sc1
  ds_read_b64_tr_b16 a[186:187], v215 offset:43008
  v_exp_f32 v75, v75
  v_cvt_pk_bf16_f32 v108, v72, v73
  v_exp_f32 v76, v76
  v_mfma_f32_32x32x16_bf16 a[96:111], a[156:159], v[84:87], a[96:111]
  ds_read_b64_tr_b16 a[188:189], v215 offset:45056
  v_add_f32 v194, v194, v74
  v_add_f32 v195, v195, v75
  v_exp_f32 v77, v77
  v_cvt_pk_bf16_f32 v109, v74, v75
  v_exp_f32 v78, v78
  v_add_f32 v194, v194, v76
  v_add_f32 v195, v195, v77
  v_mfma_f32_32x32x16_bf16 a[112:127], a[156:159], v[92:95], a[112:127]
  buffer_load_dwordx4 v[124:127], v225, s[52:55], s73 offen offset:3072 sc1
  ds_read_b64_tr_b16 a[190:191], v215 offset:47104
  v_exp_f32 v79, v79
  v_cvt_pk_bf16_f32 v110, v76, v77
  v_add_f32 v194, v194, v78
  v_add_f32 v195, v195, v79
  v_cvt_pk_bf16_f32 v111, v78, v79
  v_add_f32 v192, v192, v193
  v_mov_b32 v193, v192
  v_add_f32 v194, v194, v195
  v_mov_b32 v195, v194
  v_permlane32_swap_b32 v192, v193
  s_nop 0
  v_permlane32_swap_b32 v194, v195
  v_add_f32 v192, v192, v193
  v_add_f32 v194, v194, v195
  v_rcp_f32 v193, v192
  v_rcp_f32 v195, v194
  v_min_f32 v10, v192, v194
  v_max_f32 v11, v192, v194
  v_add_f32 v12, v192, v194
  v_cmp_lt_f32 vcc, 0x30800000, v10
  v_mov_b32 v13, 0x4e800000
  v_cmp_lt_f32 s[82:83], v11, v13
  v_cmp_o_f32 s[84:85], v12, v12
  s_nop 1
  s_and_b64 vcc, vcc, s[82:83]
  s_and_b64 vcc, vcc, s[84:85]
  s_andn2_b64 vcc, exec, vcc
  s_cbranch_scc1 L_slow
L_slow_back:
  v_mfma_f32_32x32x16_bf16 a[0:15], a[160:163], v[96:99], a[0:15]
  s_add_u32 s73, s79, 16384
  buffer_load_dwordx4 v[16:19], v225, s[52:55], s73 offen sc1
  buffer_load_dwordx4 v[20:23], v225, s[52:55], s73 offen offset:1024 sc1
  buffer_load_dwordx4 v[24:27], v225, s[52:55], s73 offen offset:2048 sc1
  v_mfma_f32_32x32x16_bf16 a[0:15], a[164:167], v[100:103], a[0:15]
  buffer_load_dwordx4 v[28:31], v225, s[52:55], s73 offen offset:3072 sc1
  s_add_u32 s73, s79, 20480
  buffer_load_dwordx4 v[32:35], v225, s[52:55], s73 offen sc1
  v_mfma_f32_32x32x16_bf16 a[32:47], a[168:171], v[96:99], a[32:47]
  buffer_load_dwordx4 v[36:39], v225, s[52:55], s73 offen offset:1024 sc1
  buffer_load_dwordx4 v[128:131], v225, s[52:55], s73 offen offset:2048 sc1
  s_waitcnt lgkmcnt(0)
  v_mfma_f32_32x32x16_bf16 a[32:47], a[172:175], v[100:103], a[32:47]
  buffer_load_dwordx4 v[132:135], v225, s[52:55], s73 offen offset:3072 sc1
  s_add_u32 s73, s79, 24576
  buffer_load_dwordx4 v[136:139], v225, s[52:55], s73 offen sc1
  s_nop 0
  v_accvgpr_read_b32 v88, a0
  v_accvgpr_read_b32 v89, a1
  v_accvgpr_read_b32 v90, a2
  v_accvgpr_read_b32 v91, a3
  v_mfma_f32_32x32x16_bf16 a[64:79], a[176:179], v[96:99], a[64:79]
  buffer_load_dwordx4 v[140:143], v225, s[52:55], s73 offen offset:1024 sc1
  buffer_load_dwordx4 v[144:147], v225, s[52:55], s73 offen offset:2048 sc1
  v_accvgpr_read_b32 v92, a4
  v_accvgpr_read_b32 v93, a5
  v_accvgpr_read_b32 v94, a6
  v_accvgpr_read_b32 v95, a7
  v_mfma_f32_32x32x16_bf16 a[64:79], a[180:183], v[100:103], a[64:79]
  v_mul_f32 v88, v193, v88
  v_mul_f32 v89, v193, v89
  v_mul_f32 v90, v193, v90
  v_mul_f32 v91, v193, v91
  v_mfma_f32_32x32x16_bf16 a[96:111], a[184:187], v[96:99], a[96:111]
  v_mul_f32 v92, v193, v92
  v_mul_f32 v93, v193, v93
  v_mul_f32 v94, v193, v94
  v_mul_f32 v95, v193, v95
  v_mfma_f32_32x32x16_bf16 a[96:111], a[188:191], v[100:103], a[96:111]
  v_cvt_pk_bf16_f32 v148, v88, v89
  v_cvt_pk_bf16_f32 v149, v90, v91
  v_cvt_pk_bf16_f32 v150, v92, v93
  v_cvt_pk_bf16_f32 v151, v94, v95
  v_mfma_f32_32x32x16_bf16 a[16:31], a[160:163], v[104:107], a[16:31]
  s_lshl_b32 s75, s4, 13
  buffer_store_dwordx4 v[148:151], v4, s[32:35], s75 offen offset:0 sc1
  v_accvgpr_read_b32 v80, a8
  v_accvgpr_read_b32 v81, a9
  v_accvgpr_read_b32 v82, a10
  v_mfma_f32_32x32x16_bf16 a[16:31], a[164:167], v[108:111], a[16:31]
  v_accvgpr_read_b32 v83, a11
  v_accvgpr_read_b32 v84, a12
  v_accvgpr_read_b32 v85, a13
  v_accvgpr_read_b32 v86, a14
  v_mfma_f32_32x32x16_bf16 a[48:63], a[168:171], v[104:107], a[48:63]
  v_accvgpr_read_b32 v87, a15
  v_mul_f32 v80, v193, v80
  v_mul_f32 v81, v193, v81
  v_mul_f32 v82, v193, v82
  v_mfma_f32_32x32x16_bf16 a[48:63], a[172:175], v[108:111], a[48:63]
  ds_read_b64_tr_b16 v[40:41], v221 offset:0
  ds_read_b64_tr_b16 v[42:43], v221 offset:1280
  v_mul_f32 v83, v193, v83
  v_mul_f32 v84, v193, v84
  v_mul_f32 v85, v193, v85
  v_mul_f32 v86, v193, v86
  v_mfma_f32_32x32x16_bf16 a[80:95], a[176:179], v[104:107], a[80:95]
  ds_read_b64_tr_b16 v[44:45], v221 offset:80
  ds_read_b64_tr_b16 v[46:47], v221 offset:1360
  v_mul_f32 v87, v193, v87
  v_cvt_pk_bf16_f32 v152, v80, v81
  v_cvt_pk_bf16_f32 v153, v82, v83
  v_cvt_pk_bf16_f32 v154, v84, v85
  v_mfma_f32_32x32x16_bf16 a[80:95], a[180:183], v[108:111], a[80:95]
  ds_read_b64_tr_b16 v[48:49], v221 offset:160
  ds_read_b64_tr_b16 v[50:51], v221 offset:1440
  v_cvt_pk_bf16_f32 v155, v86, v87
  v_accvgpr_read_b32 v88, a32
  v_mfma_f32_32x32x16_bf16 a[112:127], a[184:187], v[104:107], a[112:127]
  buffer_store_dwordx4 v[152:155], v4, s[32:35], s75 offen offset:1024 sc1
  ds_read_b64_tr_b16 v[52:53], v221 offset:240
  ds_read_b64_tr_b16 v[54:55], v221 offset:1520
  v_accvgpr_read_b32 v89, a33
  v_accvgpr_read_b32 v90, a34
  v_accvgpr_read_b32 v91, a35
  v_accvgpr_read_b32 v92, a36
  v_mfma_f32_32x32x16_bf16 a[112:127], a[188:191], v[108:111], a[112:127]
  ds_read_b64_tr_b16 v[56:57], v229 offset:0
  ds_read_b64_tr_b16 v[58:59], v229 offset:1280
  v_accvgpr_read_b32 v93, a37
  v_accvgpr_read_b32 v94, a38
  v_accvgpr_read_b32 v95, a39
  v_mul_f32 v88, v193, v88
  s_waitcnt vmcnt(45) lgkmcnt(8)
  v_mfma_f32_32x32x16_bf16 a[128:143], v[40:43], v[196:199], 0
  ds_read_b64_tr_b16 v[60:61], v221 offset:5120
  ds_read_b64_tr_b16 v[62:63], v221 offset:6400
  v_mul_f32 v89, v193, v89
  v_mul_f32 v90, v193, v90
  v_mul_f32 v91, v193, v91
  v_mul_f32 v92, v193, v92
  s_waitcnt lgkmcnt(8)
  v_mfma_f32_32x32x16_bf16 a[144:159], v[44:47], v[196:199], 0
  ds_read_b64_tr_b16 v[64:65], v221 offset:5200
  ds_read_b64_tr_b16 v[66:67], v221 offset:6480
  v_mul_f32 v93, v193, v93
  v_mul_f32 v94, v193, v94
  v_mul_f32 v95, v193, v95
  v_cvt_pk_bf16_f32 v156, v88, v89
  s_waitcnt lgkmcnt(6)
  v_mfma_f32_32x32x16_bf16 a[192:207], v[48:51], v[196:199], 0
  ds_read_b64_tr_b16 v[68:69], v221 offset:5280
  ds_read_b64_tr_b16 v[70:71], v221 offset:6560
  v_cvt_pk_bf16_f32 v157, v90, v91
  v_cvt_pk_bf16_f32 v158, v92, v93
  v_cvt_pk_bf16_f32 v159, v94, v95
  v_mfma_f32_32x32x16_bf16 a[208:223], v[52:55], v[196:199], 0
  buffer_store_dwordx4 v[156:159], v4, s[32:35], s75 offen offset:2048 sc1
  ds_read_b64_tr_b16 v[72:73], v221 offset:5360
  ds_read_b64_tr_b16 v[74:75], v221 offset:6640
  v_accvgpr_read_b32 v80, a40
  v_accvgpr_read_b32 v81, a41
  v_accvgpr_read_b32 v82, a42
  v_accvgpr_read_b32 v83, a43
  s_waitcnt lgkmcnt(6)
  v_mfma_f32_32x32x16_bf16 a[224:239], v[56:59], v[196:199], 0
  ds_read_b64_tr_b16 v[76:77], v229 offset:5120
  ds_read_b64_tr_b16 v[78:79], v229 offset:6400
  v_accvgpr_read_b32 v84, a44
  v_accvgpr_read_b32 v85, a45
  v_accvgpr_read_b32 v86, a46
  v_accvgpr_read_b32 v87, a47
  s_waitcnt vmcnt(45)
  v_mfma_f32_32x32x16_bf16 a[128:143], v[60:63], v[200:203], a[128:143]
  ds_read_b64_tr_b16 v[40:41], v221 offset:10240
  ds_read_b64_tr_b16 v[42:43], v221 offset:11520
  v_mul_f32 v80, v193, v80
  v_mul_f32 v81, v193, v81
  v_mul_f32 v82, v193, v82
  v_mul_f32 v83, v193, v83
  s_waitcnt lgkmcnt(6)
  v_mfma_f32_32x32x16_bf16 a[144:159], v[64:67], v[200:203], a[144:159]
  ds_read_b64_tr_b16 v[44:45], v221 offset:10320
  ds_read_b64_tr_b16 v[46:47], v221 offset:11600
  v_mul_f32 v84, v193, v84
  v_mul_f32 v85, v193, v85
  v_mul_f32 v86, v193, v86
  v_mul_f32 v87, v193, v87
  v_mfma_f32_32x32x16_bf16 a[192:207], v[68:71], v[200:203], a[192:207]
  ds_read_b64_tr_b16 v[48:49], v221 offset:10400
  ds_read_b64_tr_b16 v[50:51], v221 offset:11680
  v_cvt_pk_bf16_f32 v160, v80, v81
  v_cvt_pk_bf16_f32 v161, v82, v83
  v_cvt_pk_bf16_f32 v162, v84, v85
  v_cvt_pk_bf16_f32 v163, v86, v87
  s_waitcnt lgkmcnt(6)
  v_mfma_f32_32x32x16_bf16 a[208:223], v[72:75], v[200:203], a[208:223]
  ds_read_b64_tr_b16 v[52:53], v221 offset:10480
  buffer_store_dwordx4 v[160:163], v4, s[32:35], s75 offen offset:3072 sc1
  ds_read_b64_tr_b16 v[54:55], v221 offset:11760
  v_accvgpr_read_b32 v88, a64
  v_accvgpr_read_b32 v89, a65
  v_mfma_f32_32x32x16_bf16 a[224:239], v[76:79], v[200:203], a[224:239]
  ds_read_b64_tr_b16 v[56:57], v229 offset:10240
  ds_read_b64_tr_b16 v[58:59], v229 offset:11520
  v_accvgpr_read_b32 v90, a66
  v_accvgpr_read_b32 v91, a67
  v_accvgpr_read_b32 v92, a68
  v_accvgpr_read_b32 v93, a69
  s_waitcnt vmcnt(45) lgkmcnt(8)
  v_mfma_f32_32x32x16_bf16 a[128:143], v[40:43], v[204:207], a[128:143]
  ds_read_b64_tr_b16 v[60:61], v222 offset:0
  ds_read_b64_tr_b16 v[62:63], v222 offset:1280
  v_accvgpr_read_b32 v94, a70
  v_accvgpr_read_b32 v95, a71
  v_mul_f32 v88, v193, v88
  v_mul_f32 v89, v193, v89
  s_waitcnt lgkmcnt(7)
  v_mfma_f32_32x32x16_bf16 a[144:159], v[44:47], v[204:207], a[144:159]
  ds_read_b64_tr_b16 v[64:65], v222 offset:80
  ds_read_b64_tr_b16 v[66:67], v222 offset:1360
  v_mul_f32 v90, v193, v90
  v_mul_f32 v91, v193, v91
  v_mul_f32 v92, v193, v92
  v_mul_f32 v93, v193, v93
  s_waitcnt lgkmcnt(7)
  v_mfma_f32_32x32x16_bf16 a[192:207], v[48:51], v[204:207], a[192:207]
  ds_read_b64_tr_b16 v[68:69], v222 offset:160
  ds_read_b64_tr_b16 v[70:71], v222 offset:1440
  v_mul_f32 v94, v193, v94
  v_mul_f32 v95, v193, v95
  v_cvt_pk_bf16_f32 v164, v88, v89
  v_cvt_pk_bf16_f32 v165, v90, v91
  s_waitcnt lgkmcnt(6)
  v_mfma_f32_32x32x16_bf16 a[208:223], v[52:55], v[204:207], a[208:223]
  ds_read_b64_tr_b16 v[72:73], v222 offset:240
  ds_read_b64_tr_b16 v[74:75], v222 offset:1520
  s_add_u32 s75, s75, 4096
  v_cvt_pk_bf16_f32 v166, v92, v93
  v_cvt_pk_bf16_f32 v167, v94, v95
  v_accvgpr_read_b32 v80, a72
  v_mfma_f32_32x32x16_bf16 a[224:239], v[56:59], v[204:207], a[224:239]
  buffer_store_dwordx4 v[164:167], v4, s[32:35], s75 offen offset:0 sc1
  ds_read_b64_tr_b16 v[76:77], v230 offset:0
  ds_read_b64_tr_b16 v[78:79], v230 offset:1280
  v_accvgpr_read_b32 v81, a73
  v_accvgpr_read_b32 v82, a74
  v_accvgpr_read_b32 v83, a75
  v_accvgpr_read_b32 v84, a76
  s_waitcnt vmcnt(45) lgkmcnt(6)
  v_mfma_f32_32x32x16_bf16 a[128:143], v[60:63], v[208:211], a[128:143]
  ds_read_b64_tr_b16 v[40:41], v222 offset:5120
  ds_read_b64_tr_b16 v[42:43], v222 offset:6400
  v_accvgpr_read_b32 v85, a77
  v_accvgpr_read_b32 v86, a78
  v_accvgpr_read_b32 v87, a79
  v_mul_f32 v80, v193, v80
  v_mfma_f32_32x32x16_bf16 a[144:159], v[64:67], v[208:211], a[144:159]
  ds_read_b64_tr_b16 v[44:45], v222 offset:5200
  ds_read_b64_tr_b16 v[46:47], v222 offset:6480
  v_mul_f32 v81, v193, v81
  v_mul_f32 v82, v193, v82
  v_mul_f32 v83, v193, v83
  v_mul_f32 v84, v193, v84
  s_waitcnt lgkmcnt(6)
  v_mfma_f32_32x32x16_bf16 a[192:207], v[68:71], v[208:211], a[192:207]
  ds_read_b64_tr_b16 v[48:49], v222 offset:5280
  ds_read_b64_tr_b16 v[50:51], v222 offset:6560
  v_mul_f32 v85, v193, v85
  v_mul_f32 v86, v193, v86
  v_mul_f32 v87, v193, v87
  v_cvt_pk_bf16_f32 v168, v80, v81
  v_mfma_f32_32x32x16_bf16 a[208:223], v[72:75], v[208:211], a[208:223]
  ds_read_b64_tr_b16 v[52:53], v222 offset:5360
  ds_read_b64_tr_b16 v[54:55], v222 offset:6640
  v_cvt_pk_bf16_f32 v169, v82, v83
  v_cvt_pk_bf16_f32 v170, v84, v85
  v_cvt_pk_bf16_f32 v171, v86, v87
  s_waitcnt lgkmcnt(8)
  v_mfma_f32_32x32x16_bf16 a[224:239], v[76:79], v[208:211], a[224:239]
  buffer_store_dwordx4 v[168:171], v4, s[32:35], s75 offen offset:1024 sc1
  ds_read_b64_tr_b16 v[56:57], v230 offset:5120
  ds_read_b64_tr_b16 v[58:59], v230 offset:6400
  v_accvgpr_read_b32 v88, a96
  v_accvgpr_read_b32 v89, a97
  v_accvgpr_read_b32 v90, a98
  s_waitcnt vmcnt(44) lgkmcnt(7)
  v_mfma_f32_32x32x16_bf16 a[128:143], v[40:43], v[232:235], a[128:143]
  ds_read_b64_tr_b16 v[60:61], v222 offset:10240
  ds_read_b64_tr_b16 v[62:63], v222 offset:11520
  v_accvgpr_read_b32 v91, a99
  v_accvgpr_read_b32 v92, a100
  v_accvgpr_read_b32 v93, a101
  v_accvgpr_read_b32 v94, a102
  s_waitcnt lgkmcnt(7)
  v_mfma_f32_32x32x16_bf16 a[144:159], v[44:47], v[232:235], a[144:159]
  ds_read_b64_tr_b16 v[64:65], v222 offset:10320
  ds_read_b64_tr_b16 v[66:67], v222 offset:11600
  v_accvgpr_read_b32 v95, a103
  v_mul_f32 v88, v193, v88
  v_mul_f32 v89, v193, v89
  v_mul_f32 v90, v193, v90
  s_waitcnt lgkmcnt(6)
  v_mfma_f32_32x32x16_bf16 a[192:207], v[48:51], v[232:235], a[192:207]
  ds_read_b64_tr_b16 v[68:69], v222 offset:10400
  ds_read_b64_tr_b16 v[70:71], v222 offset:11680
  v_mul_f32 v91, v193, v91
  v_mul_f32 v92, v193, v92
  v_mul_f32 v93, v193, v93
  v_mul_f32 v94, v193, v94
  v_mfma_f32_32x32x16_bf16 a[208:223], v[52:55], v[232:235], a[208:223]
  s_waitcnt vmcnt(26)
  s_barrier
  ds_read_b64_tr_b16 v[72:73], v222 offset:10480
  ds_read_b64_tr_b16 v[74:75], v222 offset:11760
  v_mul_f32 v95, v193, v95
  v_cvt_pk_bf16_f32 v172, v88, v89
  v_cvt_pk_bf16_f32 v173, v90, v91
  v_cvt_pk_bf16_f32 v174, v92, v93
  s_waitcnt lgkmcnt(6)
  v_mfma_f32_32x32x16_bf16 a[224:239], v[56:59], v[232:235], a[224:239]
  ds_read_b64_tr_b16 v[76:77], v230 offset:10240
  v_cvt_pk_bf16_f32 v175, v94, v95
  v_accvgpr_read_b32 v80, a104
  v_accvgpr_read_b32 v81, a105
  v_mfma_f32_32x32x16_bf16 a[128:143], v[60:63], v[236:239], a[128:143]
  buffer_store_dwordx4 v[172:175], v4, s[32:35], s75 offen offset:2048 sc1
  ds_read_b64_tr_b16 v[78:79], v230 offset:11520
  s_add_u32 s74, s78, 471040
  s_add_u32 m0, s89, 143360
  s_nop 0
  buffer_load_dwordx4 v216, s[40:43], s74 offen lds
  ds_read_b64_tr_b16 v[40:41], v222 offset:15360
  ds_read_b64_tr_b16 v[42:43], v222 offset:16640
  v_accvgpr_read_b32 v82, a106
  v_accvgpr_read_b32 v83, a107
  v_accvgpr_read_b32 v84, a108
  v_accvgpr_read_b32 v85, a109
  s_waitcnt lgkmcnt(6)
  v_mfma_f32_32x32x16_bf16 a[144:159], v[64:67], v[236:239], a[144:159]
  ds_read_b64_tr_b16 v[44:45], v222 offset:15440
  ds_read_b64_tr_b16 v[46:47], v222 offset:16720
  buffer_load_dwordx4 v217, s[40:43], s74 offen offset:1024 lds
  v_accvgpr_read_b32 v86, a110
  v_accvgpr_read_b32 v87, a111
  v_mul_f32 v80, v193, v80
  v_mul_f32 v81, v193, v81
  v_mfma_f32_32x32x16_bf16 a[192:207], v[68:71], v[236:239], a[192:207]
  ds_read_b64_tr_b16 v[48:49], v222 offset:15520
  ds_read_b64_tr_b16 v[50:51], v222 offset:16800
  v_mul_f32 v82, v193, v82
  v_mul_f32 v83, v193, v83
  v_mul_f32 v84, v193, v84
  v_mul_f32 v85, v193, v85
  s_waitcnt lgkmcnt(7)
  v_mfma_f32_32x32x16_bf16 a[208:223], v[72:75], v[236:239], a[208:223]
  ds_read_b64_tr_b16 v[52:53], v222 offset:15600
  ds_read_b64_tr_b16 v[54:55], v222 offset:16880
  v_mul_f32 v86, v193, v86
  v_mul_f32 v87, v193, v87
  v_cvt_pk_bf16_f32 v176, v80, v81
  v_cvt_pk_bf16_f32 v177, v82, v83
  s_waitcnt lgkmcnt(6)
  v_mfma_f32_32x32x16_bf16 a[224:239], v[76:79], v[236:239], a[224:239]
  ds_read_b64_tr_b16 v[56:57], v230 offset:15360
  ds_read_b64_tr_b16 v[58:59], v230 offset:16640
  v_cvt_pk_bf16_f32 v178, v84, v85
  v_cvt_pk_bf16_f32 v179, v86, v87
  v_mfma_f32_32x32x16_bf16 a[128:143], v[40:43], a[240:243], a[128:143]
  buffer_store_dwordx4 v[176:179], v4, s[32:35], s75 offen offset:3072 sc1
  buffer_load_dwordx4 v218, s[40:43], s74 offen offset:2048 lds
  ds_read_b64_tr_b16 v[60:61], v222 offset:20480
  ds_read_b64_tr_b16 v[62:63], v222 offset:21760
  s_waitcnt lgkmcnt(8)
  v_mfma_f32_32x32x16_bf16 a[144:159], v[44:47], a[240:243], a[144:159]
  ds_read_b64_tr_b16 v[64:65], v222 offset:20560
  ds_read_b64_tr_b16 v[66:67], v222 offset:21840
  s_waitcnt lgkmcnt(8)
  v_mfma_f32_32x32x16_bf16 a[192:207], v[48:51], a[240:243], a[192:207]
  ds_read_b64_tr_b16 v[68:69], v222 offset:20640
  ds_read_b64_tr_b16 v[70:71], v222 offset:21920
  buffer_load_dwordx4 v219, s[40:43], s74 offen offset:3072 lds
  s_waitcnt lgkmcnt(8)
  v_mfma_f32_32x32x16_bf16 a[208:223], v[52:55], a[240:243], a[208:223]
  ds_read_b64_tr_b16 v[72:73], v222 offset:20720
  ds_read_b64_tr_b16 v[74:75], v222 offset:22000
  s_waitcnt lgkmcnt(8)
  v_mfma_f32_32x32x16_bf16 a[224:239], v[56:59], a[240:243], a[224:239]
  ds_read_b64_tr_b16 v[76:77], v230 offset:20480
  ds_read_b64_tr_b16 v[78:79], v230 offset:21760
  s_waitcnt lgkmcnt(8)
  v_mfma_f32_32x32x16_bf16 a[128:143], v[60:63], a[244:247], a[128:143]
  ds_read_b64_tr_b16 v[40:41], v222 offset:25600
  s_add_u32 m0, s89, 147456
  ds_read_b64_tr_b16 v[42:43], v222 offset:26880
  buffer_load_dwordx4 v220, s[40:43], s74 offen lds
  s_waitcnt lgkmcnt(8)
  v_mfma_f32_32x32x16_bf16 a[144:159], v[64:67], a[244:247], a[144:159]
  ds_read_b64_tr_b16 v[44:45], v222 offset:25680
  ds_read_b64_tr_b16 v[46:47], v222 offset:26960
  s_waitcnt lgkmcnt(8)
  v_mfma_f32_32x32x16_bf16 a[192:207], v[68:71], a[244:247], a[192:207]
  ds_read_b64_tr_b16 v[48:49], v222 offset:25760
  ds_read_b64_tr_b16 v[50:51], v222 offset:27040
  s_waitcnt lgkmcnt(8)
  v_mfma_f32_32x32x16_bf16 a[208:223], v[72:75], a[244:247], a[208:223]
  ds_read_b64_tr_b16 v[52:53], v222 offset:25840
  s_add_u32 s74, s88, 0
  s_and_b32 s74, s74, 7
  s_lshl2_add_u32 s74, s74, s7
  ds_read_b64_tr_b16 v[54:55], v222 offset:27120
  s_mul_i32 s74, s74, 163840
  s_add_u32 m0, s89, 0
  s_nop 0
  buffer_load_dwordx4 v216, s[36:39], s74 offen lds
  s_waitcnt lgkmcnt(8)
  v_mfma_f32_32x32x16_bf16 a[224:239], v[76:79], a[244:247], a[224:239]
  ds_read_b64_tr_b16 v[56:57], v230 offset:25600
  ds_read_b64_tr_b16 v[58:59], v230 offset:26880
  s_waitcnt lgkmcnt(8)
  v_mfma_f32_32x32x16_bf16 a[128:143], v[40:43], a[248:251], a[128:143]
  ds_read_b64_tr_b16 v[60:61], v222 offset:30720
  ds_read_b64_tr_b16 v[62:63], v222 offset:32000
  s_waitcnt lgkmcnt(8)
  v_mfma_f32_32x32x16_bf16 a[144:159], v[44:47], a[248:251], a[144:159]
  ds_read_b64_tr_b16 v[64:65], v222 offset:30800
  ds_read_b64_tr_b16 v[66:67], v222 offset:32080
  buffer_load_dwordx4 v217, s[36:39], s74 offen offset:1024 lds
  s_waitcnt lgkmcnt(8)
  v_mfma_f32_32x32x16_bf16 a[192:207], v[48:51], a[248:251], a[192:207]
  ds_read_b64_tr_b16 v[68:69], v222 offset:30880
  ds_read_b64_tr_b16 v[70:71], v222 offset:32160
  s_waitcnt lgkmcnt(8)
  v_mfma_f32_32x32x16_bf16 a[208:223], v[52:55], a[248:251], a[208:223]
  ds_read_b64_tr_b16 v[72:73], v222 offset:30960
  ds_read_b64_tr_b16 v[74:75], v222 offset:32240
  s_waitcnt lgkmcnt(8)
  v_mfma_f32_32x32x16_bf16 a[224:239], v[56:59], a[248:251], a[224:239]
  ds_read_b64_tr_b16 v[76:77], v230 offset:30720
  ds_read_b64_tr_b16 v[78:79], v230 offset:32000
  buffer_load_dwordx4 v218, s[36:39], s74 offen offset:2048 lds
  s_waitcnt lgkmcnt(8)
  v_mfma_f32_32x32x16_bf16 a[128:143], v[60:63], a[252:255], a[128:143]
  ds_read_b64_tr_b16 v[40:41], v222 offset:35840
  ds_read_b64_tr_b16 v[42:43], v222 offset:37120
  s_waitcnt lgkmcnt(8)
  v_mfma_f32_32x32x16_bf16 a[144:159], v[64:67], a[252:255], a[144:159]
  ds_read_b64_tr_b16 v[44:45], v222 offset:35920
  ds_read_b64_tr_b16 v[46:47], v222 offset:37200
  s_waitcnt lgkmcnt(8)
  v_mfma_f32_32x32x16_bf16 a[192:207], v[68:71], a[252:255], a[192:207]
  ds_read_b64_tr_b16 v[48:49], v222 offset:36000
  ds_read_b64_tr_b16 v[50:51], v222 offset:37280
  buffer_load_dwordx4 v219, s[36:39], s74 offen offset:3072 lds
  s_waitcnt lgkmcnt(8)
  v_mfma_f32_32x32x16_bf16 a[208:223], v[72:75], a[252:255], a[208:223]
  ds_read_b64_tr_b16 v[52:53], v222 offset:36080
  ds_read_b64_tr_b16 v[54:55], v222 offset:37360
  s_waitcnt lgkmcnt(8)
  v_mfma_f32_32x32x16_bf16 a[224:239], v[76:79], a[252:255], a[224:239]
  ds_read_b64_tr_b16 v[56:57], v230 offset:35840
  ds_read_b64_tr_b16 v[58:59], v230 offset:37120
  s_waitcnt lgkmcnt(8)
  v_mfma_f32_32x32x16_bf16 a[128:143], v[40:43], v[240:243], a[128:143]
  ds_read_b64_tr_b16 v[60:61], v223 offset:0
  s_add_u32 m0, s89, 4096
  ds_read_b64_tr_b16 v[62:63], v223 offset:1280
  buffer_load_dwordx4 v220, s[36:39], s74 offen lds
  s_waitcnt lgkmcnt(8)
  v_mfma_f32_32x32x16_bf16 a[144:159], v[44:47], v[240:243], a[144:159]
  ds_read_b64_tr_b16 v[64:65], v223 offset:80
  ds_read_b64_tr_b16 v[66:67], v223 offset:1360
  s_waitcnt lgkmcnt(8)
  v_mfma_f32_32x32x16_bf16 a[192:207], v[48:51], v[240:243], a[192:207]
  ds_read_b64_tr_b16 v[68:69], v223 offset:160
  ds_read_b64_tr_b16 v[70:71], v223 offset:1440
  s_waitcnt lgkmcnt(8)
  v_mfma_f32_32x32x16_bf16 a[208:223], v[52:55], v[240:243], a[208:223]
  ds_read_b64_tr_b16 v[72:73], v223 offset:240
  ds_read_b64_tr_b16 v[74:75], v223 offset:1520
  s_waitcnt lgkmcnt(8)
  v_mfma_f32_32x32x16_bf16 a[224:239], v[56:59], v[240:243], a[224:239]
  ds_read_b64_tr_b16 v[76:77], v231 offset:0
  ds_read_b64_tr_b16 v[78:79], v231 offset:1280
  s_waitcnt lgkmcnt(8)
  v_mfma_f32_32x32x16_bf16 a[128:143], v[60:63], v[244:247], a[128:143]
  ds_read_b64_tr_b16 v[40:41], v223 offset:5120
  ds_read_b64_tr_b16 v[42:43], v223 offset:6400
  v_accvgpr_read_b32 v104, a16
  v_accvgpr_read_b32 v105, a17
  v_accvgpr_read_b32 v106, a18
  s_waitcnt lgkmcnt(8)
  v_mfma_f32_32x32x16_bf16 a[144:159], v[64:67], v[244:247], a[144:159]
  ds_read_b64_tr_b16 v[44:45], v223 offset:5200
  ds_read_b64_tr_b16 v[46:47], v223 offset:6480
  v_accvgpr_read_b32 v107, a19
  v_accvgpr_read_b32 v108, a20
  s_waitcnt lgkmcnt(8)
  v_mfma_f32_32x32x16_bf16 a[192:207], v[68:71], v[244:247], a[192:207]
  ds_read_b64_tr_b16 v[48:49], v223 offset:5280
  ds_read_b64_tr_b16 v[50:51], v223 offset:6560
  v_accvgpr_read_b32 v109, a21
  v_accvgpr_read_b32 v110, a22
  s_waitcnt lgkmcnt(8)
  v_mfma_f32_32x32x16_bf16 a[208:223], v[72:75], v[244:247], a[208:223]
  ds_read_b64_tr_b16 v[52:53], v223 offset:5360
  ds_read_b64_tr_b16 v[54:55], v223 offset:6640
  v_accvgpr_read_b32 v111, a23
  v_mul_f32 v104, v195, v104
  s_waitcnt lgkmcnt(8)
  v_mfma_f32_32x32x16_bf16 a[224:239], v[76:79], v[244:247], a[224:239]
  ds_read_b64_tr_b16 v[56:57], v231 offset:5120
  ds_read_b64_tr_b16 v[58:59], v231 offset:6400
  v_mul_f32 v105, v195, v105
  v_mul_f32 v106, v195, v106
  s_waitcnt vmcnt(32) lgkmcnt(8)
  v_mfma_f32_32x32x16_bf16 a[128:143], v[40:43], v[112:115], a[128:143]
  ds_read_b64_tr_b16 v[60:61], v223 offset:10240
  ds_read_b64_tr_b16 v[62:63], v223 offset:11520
  v_mul_f32 v107, v195, v107
  v_mul_f32 v108, v195, v108
  s_waitcnt lgkmcnt(8)
  v_mfma_f32_32x32x16_bf16 a[144:159], v[44:47], v[112:115], a[144:159]
  ds_read_b64_tr_b16 v[64:65], v223 offset:10320
  ds_read_b64_tr_b16 v[66:67], v223 offset:11600
  v_mul_f32 v109, v195, v109
  v_mul_f32 v110, v195, v110
  s_waitcnt lgkmcnt(8)
  v_mfma_f32_32x32x16_bf16 a[192:207], v[48:51], v[112:115], a[192:207]
  ds_read_b64_tr_b16 v[68:69], v223 offset:10400
  ds_read_b64_tr_b16 v[70:71], v223 offset:11680
  v_mul_f32 v111, v195, v111
  v_cvt_pk_bf16_f32 v80, v104, v105
  s_waitcnt lgkmcnt(8)
  v_mfma_f32_32x32x16_bf16 a[208:223], v[52:55], v[112:115], a[208:223]
  s_waitcnt vmcnt(8)
  s_barrier
  buffer_store_dword v255, v254, s[64:67], s68 offen sc1
  ds_read_b64_tr_b16 v[72:73], v223 offset:10480
  ds_read_b64_tr_b16 v[74:75], v223 offset:11760
  v_cvt_pk_bf16_f32 v81, v106, v107
  v_cvt_pk_bf16_f32 v82, v108, v109
  s_waitcnt lgkmcnt(8)
  v_mfma_f32_32x32x16_bf16 a[224:239], v[56:59], v[112:115], a[224:239]
  ds_read_b64_tr_b16 v[76:77], v231 offset:10240
  s_lshl_b32 s75, s4, 13
  v_cvt_pk_bf16_f32 v83, v110, v111
  s_waitcnt lgkmcnt(7)
  v_mfma_f32_32x32x16_bf16 a[128:143], v[60:63], v[116:119], a[128:143]
  buffer_store_dwordx4 v[80:83], v5, s[32:35], s75 offen offset:0 sc1
  s_add_u32 s74, s88, 2
  ds_read_b64_tr_b16 v[78:79], v231 offset:11520
  s_and_b32 s74, s74, 7
  s_lshl2_add_u32 s74, s74, s7
  s_mul_i32 s74, s74, 163840
  s_add_u32 m0, s89, 40960
  s_nop 0
  buffer_load_dwordx4 v216, s[36:39], s74 offen lds
  ds_read_b64_tr_b16 v[40:41], v223 offset:15360
  ds_read_b64_tr_b16 v[42:43], v223 offset:16640
  v_accvgpr_read_b32 v96, a24
  v_accvgpr_read_b32 v97, a25
  v_accvgpr_read_b32 v98, a26
  s_waitcnt lgkmcnt(6)
  v_mfma_f32_32x32x16_bf16 a[144:159], v[64:67], v[116:119], a[144:159]
  ds_read_b64_tr_b16 v[44:45], v223 offset:15440
  ds_read_b64_tr_b16 v[46:47], v223 offset:16720
  buffer_load_dwordx4 v217, s[36:39], s74 offen offset:1024 lds
  v_accvgpr_read_b32 v99, a27
  v_accvgpr_read_b32 v100, a28
  v_mfma_f32_32x32x16_bf16 a[192:207], v[68:71], v[116:119], a[192:207]
  ds_read_b64_tr_b16 v[48:49], v223 offset:15520
  ds_read_b64_tr_b16 v[50:51], v223 offset:16800
  v_accvgpr_read_b32 v101, a29
  v_accvgpr_read_b32 v102, a30
  s_waitcnt lgkmcnt(7)
  v_mfma_f32_32x32x16_bf16 a[208:223], v[72:75], v[116:119], a[208:223]
  ds_read_b64_tr_b16 v[52:53], v223 offset:15600
  ds_read_b64_tr_b16 v[54:55], v223 offset:16880
  v_accvgpr_read_b32 v103, a31
  v_mul_f32 v96, v195, v96
  s_waitcnt lgkmcnt(8)
  v_mfma_f32_32x32x16_bf16 a[224:239], v[76:79], v[116:119], a[224:239]
  ds_read_b64_tr_b16 v[56:57], v231 offset:15360
  ds_read_b64_tr_b16 v[58:59], v231 offset:16640
  buffer_load_dwordx4 v218, s[36:39], s74 offen offset:2048 lds
  v_mul_f32 v97, v195, v97
  v_mul_f32 v98, v195, v98
  s_waitcnt lgkmcnt(8)
  v_mfma_f32_32x32x16_bf16 a[128:143], v[40:43], v[120:123], a[128:143]
  ds_read_b64_tr_b16 v[60:61], v223 offset:20480
  ds_read_b64_tr_b16 v[62:63], v223 offset:21760
  v_mul_f32 v99, v195, v99
  v_mul_f32 v100, v195, v100
  s_waitcnt lgkmcnt(8)
  v_mfma_f32_32x32x16_bf16 a[144:159], v[44:47], v[120:123], a[144:159]
  ds_read_b64_tr_b16 v[64:65], v223 offset:20560
  ds_read_b64_tr_b16 v[66:67], v223 offset:21840
  v_mul_f32 v101, v195, v101
  v_mul_f32 v102, v195, v102
  s_waitcnt lgkmcnt(8)
  v_mfma_f32_32x32x16_bf16 a[192:207], v[48:51], v[120:123], a[192:207]
  ds_read_b64_tr_b16 v[68:69], v223 offset:20640
  ds_read_b64_tr_b16 v[70:71], v223 offset:21920
  buffer_load_dwordx4 v219, s[36:39], s74 offen offset:3072 lds
  v_mul_f32 v103, v195, v103
  v_cvt_pk_bf16_f32 v84, v96, v97
  s_waitcnt lgkmcnt(8)
  v_mfma_f32_32x32x16_bf16 a[208:223], v[52:55], v[120:123], a[208:223]
  ds_read_b64_tr_b16 v[72:73], v223 offset:20720
  ds_read_b64_tr_b16 v[74:75], v223 offset:22000
  v_cvt_pk_bf16_f32 v85, v98, v99
  v_cvt_pk_bf16_f32 v86, v100, v101
  s_waitcnt lgkmcnt(8)
  v_mfma_f32_32x32x16_bf16 a[224:239], v[56:59], v[120:123], a[224:239]
  ds_read_b64_tr_b16 v[76:77], v231 offset:20480
  ds_read_b64_tr_b16 v[78:79], v231 offset:21760
  v_cvt_pk_bf16_f32 v87, v102, v103
  s_waitcnt lgkmcnt(8)
  v_mfma_f32_32x32x16_bf16 a[128:143], v[60:63], v[124:127], a[128:143]
  buffer_store_dwordx4 v[84:87], v5, s[32:35], s75 offen offset:1024 sc1
  ds_read_b64_tr_b16 v[40:41], v223 offset:25600
  ds_read_b64_tr_b16 v[42:43], v223 offset:26880
  s_add_u32 m0, s89, 45056
  s_nop 0
  buffer_load_dwordx4 v220, s[36:39], s74 offen lds
  v_accvgpr_read_b32 v104, a48
  v_accvgpr_read_b32 v105, a49
  v_accvgpr_read_b32 v106, a50
  s_waitcnt lgkmcnt(8)
  v_mfma_f32_32x32x16_bf16 a[144:159], v[64:67], v[124:127], a[144:159]
  ds_read_b64_tr_b16 v[44:45], v223 offset:25680
  ds_read_b64_tr_b16 v[46:47], v223 offset:26960
  v_accvgpr_read_b32 v107, a51
  v_accvgpr_read_b32 v108, a52
  s_waitcnt lgkmcnt(8)
  v_mfma_f32_32x32x16_bf16 a[192:207], v[68:71], v[124:127], a[192:207]
  ds_read_b64_tr_b16 v[48:49], v223 offset:25760
  ds_read_b64_tr_b16 v[50:51], v223 offset:27040
  v_accvgpr_read_b32 v109, a53
  v_accvgpr_read_b32 v110, a54
  s_waitcnt lgkmcnt(8)
  v_mfma_f32_32x32x16_bf16 a[208:223], v[72:75], v[124:127], a[208:223]
  ds_read_b64_tr_b16 v[52:53], v223 offset:25840
  ds_read_b64_tr_b16 v[54:55], v223 offset:27120
  s_add_u32 s74, s74, 81920
  s_add_u32 m0, s89, 61440
  s_nop 0
  buffer_load_dwordx4 v216, s[36:39], s74 offen lds
  v_accvgpr_read_b32 v111, a55
  v_mul_f32 v104, v195, v104
  s_waitcnt lgkmcnt(6)
  v_mfma_f32_32x32x16_bf16 a[224:239], v[76:79], v[124:127], a[224:239]
  ds_read_b64_tr_b16 v[56:57], v231 offset:25600
  ds_read_b64_tr_b16 v[58:59], v231 offset:26880
  v_mul_f32 v105, v195, v105
  v_mul_f32 v106, v195, v106
  v_mfma_f32_32x32x16_bf16 a[128:143], v[40:43], v[16:19], a[128:143]
  ds_read_b64_tr_b16 v[60:61], v223 offset:30720
  ds_read_b64_tr_b16 v[62:63], v223 offset:32000
  v_mul_f32 v107, v195, v107
  v_mul_f32 v108, v195, v108
  s_waitcnt lgkmcnt(8)
  v_mfma_f32_32x32x16_bf16 a[144:159], v[44:47], v[16:19], a[144:159]
  ds_read_b64_tr_b16 v[64:65], v223 offset:30800
  ds_read_b64_tr_b16 v[66:67], v223 offset:32080
  buffer_load_dwordx4 v217, s[36:39], s74 offen offset:1024 lds
  v_mul_f32 v109, v195, v109
  v_mul_f32 v110, v195, v110
  s_waitcnt lgkmcnt(8)
  v_mfma_f32_32x32x16_bf16 a[192:207], v[48:51], v[16:19], a[192:207]
  ds_read_b64_tr_b16 v[68:69], v223 offset:30880
  ds_read_b64_tr_b16 v[70:71], v223 offset:32160
  v_mul_f32 v111, v195, v111
  v_cvt_pk_bf16_f32 v88, v104, v105
  s_waitcnt lgkmcnt(8)
  v_mfma_f32_32x32x16_bf16 a[208:223], v[52:55], v[16:19], a[208:223]
  ds_read_b64_tr_b16 v[72:73], v223 offset:30960
  ds_read_b64_tr_b16 v[74:75], v223 offset:32240
  v_cvt_pk_bf16_f32 v89, v106, v107
  v_cvt_pk_bf16_f32 v90, v108, v109
  s_waitcnt lgkmcnt(8)
  v_mfma_f32_32x32x16_bf16 a[224:239], v[56:59], v[16:19], a[224:239]
  ds_read_b64_tr_b16 v[76:77], v231 offset:30720
  ds_read_b64_tr_b16 v[78:79], v231 offset:32000
  v_cvt_pk_bf16_f32 v91, v110, v111
  s_waitcnt lgkmcnt(8)
  v_mfma_f32_32x32x16_bf16 a[128:143], v[60:63], v[20:23], a[128:143]
  buffer_store_dwordx4 v[88:91], v5, s[32:35], s75 offen offset:2048 sc1
  buffer_load_dwordx4 v218, s[36:39], s74 offen offset:2048 lds
  s_waitcnt vmcnt(17)
  s_barrier
  ds_read_b64_tr_b16 v[40:41], v223 offset:35840
  ds_read_b64_tr_b16 v[42:43], v223 offset:37120
  v_accvgpr_read_b32 v96, a56
  v_accvgpr_read_b32 v97, a57
  v_accvgpr_read_b32 v98, a58
  s_waitcnt lgkmcnt(8)
  v_mfma_f32_32x32x16_bf16 a[144:159], v[64:67], v[20:23], a[144:159]
  ds_read_b64_tr_b16 v[44:45], v223 offset:35920
  ds_read_b64_tr_b16 v[46:47], v223 offset:37200
  s_andn2_b32 s76, s68, 127
  buffer_load_dword v3, v228, s[64:67], s76 offen sc1
  v_accvgpr_read_b32 v99, a59
  v_accvgpr_read_b32 v100, a60
  s_waitcnt lgkmcnt(7)
  v_mfma_f32_32x32x16_bf16 a[192:207], v[68:71], v[20:23], a[192:207]
  ds_read_b64_tr_b16 v[48:49], v223 offset:36000
  ds_read_b64_tr_b16 v[50:51], v223 offset:37280
  buffer_load_dwordx4 v219, s[36:39], s74 offen offset:3072 lds
  v_accvgpr_read_b32 v101, a61
  v_accvgpr_read_b32 v102, a62
  s_waitcnt lgkmcnt(6)
  v_mfma_f32_32x32x16_bf16 a[208:223], v[72:75], v[20:23], a[208:223]
  ds_read_b64_tr_b16 v[52:53], v223 offset:36080
  ds_read_b64_tr_b16 v[54:55], v223 offset:37360
  v_accvgpr_read_b32 v103, a63
  v_mul_f32 v96, v195, v96
  v_mfma_f32_32x32x16_bf16 a[224:239], v[76:79], v[20:23], a[224:239]
  ds_read_b64_tr_b16 v[56:57], v231 offset:35840
  ds_read_b64_tr_b16 v[58:59], v231 offset:37120
  v_mul_f32 v97, v195, v97
  v_mul_f32 v98, v195, v98
  s_waitcnt lgkmcnt(8)
  v_mfma_f32_32x32x16_bf16 a[128:143], v[40:43], v[24:27], a[128:143]
  ds_read_b64_tr_b16 v[60:61], v224 offset:0
  ds_read_b64_tr_b16 v[62:63], v224 offset:1280
  s_add_u32 m0, s89, 65536
  s_nop 0
  buffer_load_dwordx4 v220, s[36:39], s74 offen lds
  v_mul_f32 v99, v195, v99
  v_mul_f32 v100, v195, v100
  s_waitcnt lgkmcnt(8)
  v_mfma_f32_32x32x16_bf16 a[144:159], v[44:47], v[24:27], a[144:159]
  ds_read_b64_tr_b16 v[64:65], v224 offset:80
  ds_read_b64_tr_b16 v[66:67], v224 offset:1360
  v_mul_f32 v101, v195, v101
  v_mul_f32 v102, v195, v102
  s_waitcnt lgkmcnt(8)
  v_mfma_f32_32x32x16_bf16 a[192:207], v[48:51], v[24:27], a[192:207]
  ds_read_b64_tr_b16 v[68:69], v224 offset:160
  ds_read_b64_tr_b16 v[70:71], v224 offset:1440
  v_mul_f32 v103, v195, v103
  v_cvt_pk_bf16_f32 v92, v96, v97
  s_waitcnt lgkmcnt(8)
  v_mfma_f32_32x32x16_bf16 a[208:223], v[52:55], v[24:27], a[208:223]
  ds_read_b64_tr_b16 v[72:73], v224 offset:240
  ds_read_b64_tr_b16 v[74:75], v224 offset:1520
  v_cvt_pk_bf16_f32 v93, v98, v99
  v_cvt_pk_bf16_f32 v94, v100, v101
  s_waitcnt lgkmcnt(8)
  v_mfma_f32_32x32x16_bf16 a[224:239], v[56:59], v[24:27], a[224:239]
  ds_read_b64_tr_b16 v[76:77], v8 offset:0
  ds_read_b64_tr_b16 v[78:79], v8 offset:1280
  v_cvt_pk_bf16_f32 v95, v102, v103
  s_waitcnt lgkmcnt(8)
  v_mfma_f32_32x32x16_bf16 a[128:143], v[60:63], v[28:31], a[128:143]
  buffer_store_dwordx4 v[92:95], v5, s[32:35], s75 offen offset:3072 sc1
  ds_read_b64_tr_b16 v[40:41], v224 offset:5120
  ds_read_b64_tr_b16 v[42:43], v224 offset:6400
  v_accvgpr_read_b32 v104, a80
  v_accvgpr_read_b32 v105, a81
  v_accvgpr_read_b32 v106, a82
  s_waitcnt lgkmcnt(8)
  v_mfma_f32_32x32x16_bf16 a[144:159], v[64:67], v[28:31], a[144:159]
  ds_read_b64_tr_b16 v[44:45], v224 offset:5200
  ds_read_b64_tr_b16 v[46:47], v224 offset:6480
  v_accvgpr_read_b32 v107, a83
  v_accvgpr_read_b32 v108, a84
  s_waitcnt lgkmcnt(8)
  v_mfma_f32_32x32x16_bf16 a[192:207], v[68:71], v[28:31], a[192:207]
  ds_read_b64_tr_b16 v[48:49], v224 offset:5280
  ds_read_b64_tr_b16 v[50:51], v224 offset:6560
  v_accvgpr_read_b32 v109, a85
  v_accvgpr_read_b32 v110, a86
  s_waitcnt lgkmcnt(8)
  v_mfma_f32_32x32x16_bf16 a[208:223], v[72:75], v[28:31], a[208:223]
  ds_read_b64_tr_b16 v[52:53], v224 offset:5360
  ds_read_b64_tr_b16 v[54:55], v224 offset:6640
  v_accvgpr_read_b32 v111, a87
  v_mul_f32 v104, v195, v104
  s_waitcnt lgkmcnt(8)
  v_mfma_f32_32x32x16_bf16 a[224:239], v[76:79], v[28:31], a[224:239]
  ds_read_b64_tr_b16 v[56:57], v8 offset:5120
  ds_read_b64_tr_b16 v[58:59], v8 offset:6400
  v_mul_f32 v105, v195, v105
  v_mul_f32 v106, v195, v106
  s_waitcnt lgkmcnt(8)
  v_mfma_f32_32x32x16_bf16 a[128:143], v[40:43], v[32:35], a[128:143]
  ds_read_b64_tr_b16 v[60:61], v224 offset:10240
  ds_read_b64_tr_b16 v[62:63], v224 offset:11520
  v_mul_f32 v107, v195, v107
  v_mul_f32 v108, v195, v108
  s_waitcnt lgkmcnt(8)
  v_mfma_f32_32x32x16_bf16 a[144:159], v[44:47], v[32:35], a[144:159]
  ds_read_b64_tr_b16 v[64:65], v224 offset:10320
  ds_read_b64_tr_b16 v[66:67], v224 offset:11600
  v_mul_f32 v109, v195, v109
  v_mul_f32 v110, v195, v110
  s_waitcnt lgkmcnt(8)
  v_mfma_f32_32x32x16_bf16 a[192:207], v[48:51], v[32:35], a[192:207]
  ds_read_b64_tr_b16 v[68:69], v224 offset:10400
  ds_read_b64_tr_b16 v[70:71], v224 offset:11680
  v_mul_f32 v111, v195, v111
  v_cvt_pk_bf16_f32 v80, v104, v105
  s_waitcnt lgkmcnt(8)
  v_mfma_f32_32x32x16_bf16 a[208:223], v[52:55], v[32:35], a[208:223]
  s_waitcnt vmcnt(16)
  s_barrier
  ds_read_b64_tr_b16 v[72:73], v224 offset:10480
  ds_read_b64_tr_b16 v[74:75], v224 offset:11760
  v_cvt_pk_bf16_f32 v81, v106, v107
  v_cvt_pk_bf16_f32 v82, v108, v109
  s_waitcnt lgkmcnt(8)
  v_mfma_f32_32x32x16_bf16 a[224:239], v[56:59], v[32:35], a[224:239]
  s_waitcnt vmcnt(3)
  v_cmp_ne_u32 vcc, 0, v3
  s_nop 1
  s_and_b32 s82, vcc_lo, s81
  s_cmp_eq_u32 s82, s81
  s_cbranch_scc0 L_spinO1
L_backO1:
  ds_read_b64_tr_b16 v[76:77], v8 offset:10240
  s_add_u32 s75, s75, 4096
  v_cvt_pk_bf16_f32 v83, v110, v111
  buffer_store_dwordx4 v[80:83], v5, s[32:35], s75 offen offset:0 sc1
  s_add_u32 s74, s88, 4
  s_and_b32 s74, s74, 7
  s_lshl2_add_u32 s74, s74, s7
  s_mul_i32 s74, s74, 163840
  ds_read_b64_tr_b16 v[78:79], v8 offset:11520
  s_add_u32 m0, s89, 81920
  s_nop 0
  buffer_load_dwordx4 v216, s[36:39], s74 offen lds
  s_add_u32 s73, s88, 2
  s_and_b32 s73, s73, 7
  s_lshl2_add_u32 s73, s73, s7
  s_mul_i32 s73, s73, 8192
  buffer_load_dwordx4 v[180:183], v225, s[52:55], s73 offen sc1
  s_waitcnt lgkmcnt(2)
  v_mfma_f32_32x32x16_bf16 a[128:143], v[60:63], v[36:39], a[128:143]
  ds_read_b64_tr_b16 v[40:41], v224 offset:15360
  ds_read_b64_tr_b16 v[42:43], v224 offset:16640
  v_accvgpr_read_b32 v96, a88
  v_accvgpr_read_b32 v97, a89
  v_accvgpr_read_b32 v98, a90
  v_mfma_f32_32x32x16_bf16 a[144:159], v[64:67], v[36:39], a[144:159]
  ds_read_b64_tr_b16 v[44:45], v224 offset:15440
  ds_read_b64_tr_b16 v[46:47], v224 offset:16720
  buffer_load_dwordx4 v217, s[36:39], s74 offen offset:1024 lds
  v_accvgpr_read_b32 v99, a91
  v_accvgpr_read_b32 v100, a92
  v_mfma_f32_32x32x16_bf16 a[192:207], v[68:71], v[36:39], a[192:207]
  ds_read_b64_tr_b16 v[48:49], v224 offset:15520
  ds_read_b64_tr_b16 v[50:51], v224 offset:16800
  buffer_load_dwordx4 v[184:187], v225, s[52:55], s73 offen offset:1024 sc1
  v_accvgpr_read_b32 v101, a93
  v_accvgpr_read_b32 v102, a94
  v_mfma_f32_32x32x16_bf16 a[208:223], v[72:75], v[36:39], a[208:223]
  ds_read_b64_tr_b16 v[52:53], v224 offset:15600
  ds_read_b64_tr_b16 v[54:55], v224 offset:16880
  v_accvgpr_read_b32 v103, a95
  v_mul_f32 v96, v195, v96
  s_waitcnt lgkmcnt(8)
  v_mfma_f32_32x32x16_bf16 a[224:239], v[76:79], v[36:39], a[224:239]
  ds_read_b64_tr_b16 v[56:57], v8 offset:15360
  ds_read_b64_tr_b16 v[58:59], v8 offset:16640
  buffer_load_dwordx4 v218, s[36:39], s74 offen offset:2048 lds
  v_mul_f32 v97, v195, v97
  v_mul_f32 v98, v195, v98
  s_waitcnt lgkmcnt(8)
  v_mfma_f32_32x32x16_bf16 a[128:143], v[40:43], v[128:131], a[128:143]
  ds_read_b64_tr_b16 v[60:61], v224 offset:20480
  ds_read_b64_tr_b16 v[62:63], v224 offset:21760
  buffer_load_dwordx4 v[188:191], v225, s[52:55], s73 offen offset:2048 sc1
  v_mul_f32 v99, v195, v99
  v_mul_f32 v100, v195, v100
  s_waitcnt lgkmcnt(8)
  v_mfma_f32_32x32x16_bf16 a[144:159], v[44:47], v[128:131], a[144:159]
  ds_read_b64_tr_b16 v[64:65], v224 offset:20560
  ds_read_b64_tr_b16 v[66:67], v224 offset:21840
  v_mul_f32 v101, v195, v101
  v_mul_f32 v102, v195, v102
  s_waitcnt lgkmcnt(8)
  v_mfma_f32_32x32x16_bf16 a[192:207], v[48:51], v[128:131], a[192:207]
  ds_read_b64_tr_b16 v[68:69], v224 offset:20640
  ds_read_b64_tr_b16 v[70:71], v224 offset:21920
  buffer_load_dwordx4 v219, s[36:39], s74 offen offset:3072 lds
  v_mul_f32 v103, v195, v103
  v_cvt_pk_bf16_f32 v84, v96, v97
  s_waitcnt lgkmcnt(8)
  v_mfma_f32_32x32x16_bf16 a[208:223], v[52:55], v[128:131], a[208:223]
  ds_read_b64_tr_b16 v[72:73], v224 offset:20720
  ds_read_b64_tr_b16 v[74:75], v224 offset:22000
  buffer_load_dwordx4 v[196:199], v225, s[52:55], s73 offen offset:3072 sc1
  v_cvt_pk_bf16_f32 v85, v98, v99
  v_cvt_pk_bf16_f32 v86, v100, v101
  s_waitcnt lgkmcnt(8)
  v_mfma_f32_32x32x16_bf16 a[224:239], v[56:59], v[128:131], a[224:239]
  ds_read_b64_tr_b16 v[76:77], v8 offset:20480
  ds_read_b64_tr_b16 v[78:79], v8 offset:21760
  v_cvt_pk_bf16_f32 v87, v102, v103
  s_waitcnt lgkmcnt(8)
  v_mfma_f32_32x32x16_bf16 a[128:143], v[60:63], v[132:135], a[128:143]
  buffer_store_dwordx4 v[84:87], v5, s[32:35], s75 offen offset:1024 sc1
  ds_read_b64_tr_b16 v[40:41], v224 offset:25600
  ds_read_b64_tr_b16 v[42:43], v224 offset:26880
  s_add_u32 m0, s89, 86016
  s_nop 0
  buffer_load_dwordx4 v220, s[36:39], s74 offen lds
  v_accvgpr_read_b32 v104, a112
  v_accvgpr_read_b32 v105, a113
  v_accvgpr_read_b32 v106, a114
  s_waitcnt lgkmcnt(7)
  v_mfma_f32_32x32x16_bf16 a[144:159], v[64:67], v[132:135], a[144:159]
  ds_read_b64_tr_b16 v[44:45], v224 offset:25680
  ds_read_b64_tr_b16 v[46:47], v224 offset:26960
  v_accvgpr_read_b32 v107, a115
  v_accvgpr_read_b32 v108, a116
  s_waitcnt lgkmcnt(8)
  v_mfma_f32_32x32x16_bf16 a[192:207], v[68:71], v[132:135], a[192:207]
  ds_read_b64_tr_b16 v[48:49], v224 offset:25760
  ds_read_b64_tr_b16 v[50:51], v224 offset:27040
  s_add_u32 s73, s73, 4096
  buffer_load_dwordx4 v[200:203], v225, s[52:55], s73 offen sc1
  v_accvgpr_read_b32 v109, a117
  v_accvgpr_read_b32 v110, a118
  s_waitcnt lgkmcnt(7)
  v_mfma_f32_32x32x16_bf16 a[208:223], v[72:75], v[132:135], a[208:223]
  ds_read_b64_tr_b16 v[52:53], v224 offset:25840
  ds_read_b64_tr_b16 v[54:55], v224 offset:27120
  s_add_u32 s74, s74, 81920
  s_add_u32 m0, s89, 102400
  s_nop 0
  buffer_load_dwordx4 v216, s[36:39], s74 offen lds
  v_accvgpr_read_b32 v111, a119
  v_mul_f32 v104, v195, v104
  s_waitcnt lgkmcnt(6)
  v_mfma_f32_32x32x16_bf16 a[224:239], v[76:79], v[132:135], a[224:239]
  ds_read_b64_tr_b16 v[56:57], v8 offset:25600
  ds_read_b64_tr_b16 v[58:59], v8 offset:26880
  v_mul_f32 v105, v195, v105
  v_mul_f32 v106, v195, v106
  v_mfma_f32_32x32x16_bf16 a[128:143], v[40:43], v[136:139], a[128:143]
  ds_read_b64_tr_b16 v[60:61], v224 offset:30720
  ds_read_b64_tr_b16 v[62:63], v224 offset:32000
  buffer_load_dwordx4 v[204:207], v225, s[52:55], s73 offen offset:1024 sc1
  v_mul_f32 v107, v195, v107
  v_mul_f32 v108, v195, v108
  s_waitcnt lgkmcnt(7)
  v_mfma_f32_32x32x16_bf16 a[144:159], v[44:47], v[136:139], a[144:159]
  ds_read_b64_tr_b16 v[64:65], v224 offset:30800
  ds_read_b64_tr_b16 v[66:67], v224 offset:32080
  buffer_load_dwordx4 v217, s[36:39], s74 offen offset:1024 lds
  v_mul_f32 v109, v195, v109
  v_mul_f32 v110, v195, v110
  s_waitcnt lgkmcnt(8)
  v_mfma_f32_32x32x16_bf16 a[192:207], v[48:51], v[136:139], a[192:207]
  ds_read_b64_tr_b16 v[68:69], v224 offset:30880
  ds_read_b64_tr_b16 v[70:71], v224 offset:32160
  v_mul_f32 v111, v195, v111
  v_cvt_pk_bf16_f32 v88, v104, v105
  s_waitcnt lgkmcnt(8)
  v_mfma_f32_32x32x16_bf16 a[208:223], v[52:55], v[136:139], a[208:223]
  ds_read_b64_tr_b16 v[72:73], v224 offset:30960
  ds_read_b64_tr_b16 v[74:75], v224 offset:32240
  buffer_load_dwordx4 v[208:211], v225, s[52:55], s73 offen offset:2048 sc1
  v_cvt_pk_bf16_f32 v89, v106, v107
  v_cvt_pk_bf16_f32 v90, v108, v109
  s_waitcnt lgkmcnt(8)
  v_mfma_f32_32x32x16_bf16 a[224:239], v[56:59], v[136:139], a[224:239]
  ds_read_b64_tr_b16 v[76:77], v8 offset:30720
  ds_read_b64_tr_b16 v[78:79], v8 offset:32000
  v_cvt_pk_bf16_f32 v91, v110, v111
  s_waitcnt lgkmcnt(8)
  v_mfma_f32_32x32x16_bf16 a[128:143], v[60:63], v[140:143], a[128:143]
  buffer_store_dwordx4 v[88:91], v5, s[32:35], s75 offen offset:2048 sc1
  buffer_load_dwordx4 v218, s[36:39], s74 offen offset:2048 lds
  ds_read_b64_tr_b16 v[40:41], v224 offset:35840
  ds_read_b64_tr_b16 v[42:43], v224 offset:37120
  v_accvgpr_read_b32 v96, a120
  v_accvgpr_read_b32 v97, a121
  v_accvgpr_read_b32 v98, a122
  s_waitcnt lgkmcnt(8)
  v_mfma_f32_32x32x16_bf16 a[144:159], v[64:67], v[140:143], a[144:159]
  ds_read_b64_tr_b16 v[44:45], v224 offset:35920
  ds_read_b64_tr_b16 v[46:47], v224 offset:37200
  buffer_load_dwordx4 v[232:235], v225, s[52:55], s73 offen offset:3072 sc1
  v_accvgpr_read_b32 v99, a123
  v_accvgpr_read_b32 v100, a124
  s_waitcnt lgkmcnt(8)
  v_mfma_f32_32x32x16_bf16 a[192:207], v[68:71], v[140:143], a[192:207]
  ds_read_b64_tr_b16 v[48:49], v224 offset:36000
  ds_read_b64_tr_b16 v[50:51], v224 offset:37280
  buffer_load_dwordx4 v219, s[36:39], s74 offen offset:3072 lds
  v_accvgpr_read_b32 v101, a125
  v_accvgpr_read_b32 v102, a126
  s_waitcnt lgkmcnt(8)
  v_mfma_f32_32x32x16_bf16 a[208:223], v[72:75], v[140:143], a[208:223]
  ds_read_b64_tr_b16 v[52:53], v224 offset:36080
  ds_read_b64_tr_b16 v[54:55], v224 offset:37360
  v_accvgpr_read_b32 v103, a127
  v_mul_f32 v96, v195, v96
  s_waitcnt lgkmcnt(8)
  v_mfma_f32_32x32x16_bf16 a[224:239], v[76:79], v[140:143], a[224:239]
  ds_read_b64_tr_b16 v[56:57], v8 offset:35840
  ds_read_b64_tr_b16 v[58:59], v8 offset:37120
  v_mul_f32 v97, v195, v97
  v_mul_f32 v98, v195, v98
  s_waitcnt lgkmcnt(8)
  v_mfma_f32_32x32x16_bf16 a[128:143], v[40:43], v[144:147], a[128:143]
  ds_read_b64_tr_b16 v[60:61], v221 offset:0
  s_add_u32 m0, s89, 106496
  s_nop 0
  buffer_load_dwordx4 v220, s[36:39], s74 offen lds
  ds_read_b64_tr_b16 v[62:63], v221 offset:1280
  s_add_u32 s73, s88, 4
  s_and_b32 s73, s73, 7
  s_lshl2_add_u32 s73, s73, s7
  s_mul_i32 s73, s73, 8192
  buffer_load_dwordx4 v[236:239], v225, s[52:55], s73 offen sc1
  v_mul_f32 v99, v195, v99
  v_mul_f32 v100, v195, v100
  s_waitcnt lgkmcnt(6)
  v_mfma_f32_32x32x16_bf16 a[144:159], v[44:47], v[144:147], a[144:159]
  ds_read_b64_tr_b16 v[64:65], v221 offset:80
  ds_read_b64_tr_b16 v[66:67], v221 offset:1360
  v_mul_f32 v101, v195, v101
  v_mul_f32 v102, v195, v102
  v_mfma_f32_32x32x16_bf16 a[192:207], v[48:51], v[144:147], a[192:207]
  ds_read_b64_tr_b16 v[68:69], v221 offset:160
  ds_read_b64_tr_b16 v[70:71], v221 offset:1440
  v_mul_f32 v103, v195, v103
  v_cvt_pk_bf16_f32 v92, v96, v97
  s_waitcnt lgkmcnt(6)
  v_mfma_f32_32x32x16_bf16 a[208:223], v[52:55], v[144:147], a[208:223]
  ds_read_b64_tr_b16 v[72:73], v221 offset:240
  ds_read_b64_tr_b16 v[74:75], v221 offset:1520
  v_cvt_pk_bf16_f32 v93, v98, v99
  v_cvt_pk_bf16_f32 v94, v100, v101
  v_mfma_f32_32x32x16_bf16 a[224:239], v[56:59], v[144:147], a[224:239]
  ds_read_b64_tr_b16 v[76:77], v229 offset:0
  ds_read_b64_tr_b16 v[78:79], v229 offset:1280
  v_cvt_pk_bf16_f32 v95, v102, v103
  s_waitcnt lgkmcnt(8)
  v_mfma_f32_32x32x16_bf16 a[0:15], v[60:63], v[148:151], 0
  buffer_store_dwordx4 v[92:95], v5, s[32:35], s75 offen offset:3072 sc1
  ds_read_b64_tr_b16 v[40:41], v221 offset:5120
  ds_read_b64_tr_b16 v[42:43], v221 offset:6400
  buffer_load_dwordx4 v[240:243], v225, s[52:55], s73 offen offset:1024 sc1
  s_waitcnt lgkmcnt(8)
  v_mfma_f32_32x32x16_bf16 a[32:47], v[64:67], v[148:151], 0
  ds_read_b64_tr_b16 v[44:45], v221 offset:5200
  ds_read_b64_tr_b16 v[46:47], v221 offset:6480
  s_waitcnt lgkmcnt(8)
  v_mfma_f32_32x32x16_bf16 a[64:79], v[68:71], v[148:151], 0
  ds_read_b64_tr_b16 v[48:49], v221 offset:5280
  ds_read_b64_tr_b16 v[50:51], v221 offset:6560
  s_waitcnt lgkmcnt(8)
  v_mfma_f32_32x32x16_bf16 a[96:111], v[72:75], v[148:151], 0
  ds_read_b64_tr_b16 v[52:53], v221 offset:5360
  ds_read_b64_tr_b16 v[54:55], v221 offset:6640
  s_waitcnt lgkmcnt(8)
  v_mfma_f32_32x32x16_bf16 a[160:175], v[76:79], v[148:151], 0
  ds_read_b64_tr_b16 v[56:57], v229 offset:5120
  ds_read_b64_tr_b16 v[58:59], v229 offset:6400
  s_waitcnt lgkmcnt(8)
  v_mfma_f32_32x32x16_bf16 a[0:15], v[40:43], v[152:155], a[0:15]
  ds_read_b64_tr_b16 v[60:61], v221 offset:10240
  ds_read_b64_tr_b16 v[62:63], v221 offset:11520
  s_waitcnt lgkmcnt(8)
  v_mfma_f32_32x32x16_bf16 a[32:47], v[44:47], v[152:155], a[32:47]
  ds_read_b64_tr_b16 v[64:65], v221 offset:10320
  ds_read_b64_tr_b16 v[66:67], v221 offset:11600
  buffer_load_dwordx4 v[244:247], v225, s[52:55], s73 offen offset:2048 sc1
  s_waitcnt lgkmcnt(8)
  v_mfma_f32_32x32x16_bf16 a[64:79], v[48:51], v[152:155], a[64:79]
  ds_read_b64_tr_b16 v[68:69], v221 offset:10400
  ds_read_b64_tr_b16 v[70:71], v221 offset:11680
  s_waitcnt lgkmcnt(8)
  v_mfma_f32_32x32x16_bf16 a[96:111], v[52:55], v[152:155], a[96:111]
  s_waitcnt vmcnt(26)
  s_barrier
  ds_read_b64_tr_b16 v[72:73], v221 offset:10480
  ds_read_b64_tr_b16 v[74:75], v221 offset:11760
  s_waitcnt lgkmcnt(8)
  v_mfma_f32_32x32x16_bf16 a[160:175], v[56:59], v[152:155], a[160:175]
  ds_read_b64_tr_b16 v[76:77], v229 offset:10240
  s_add_u32 s74, s88, 6
  s_and_b32 s74, s74, 7
  s_lshl2_add_u32 s74, s74, s7
  ds_read_b64_tr_b16 v[78:79], v229 offset:11520
  s_mul_i32 s74, s74, 163840
  s_add_u32 m0, s89, 122880
  s_nop 0
  buffer_load_dwordx4 v216, s[36:39], s74 offen lds
  s_waitcnt lgkmcnt(8)
  v_mfma_f32_32x32x16_bf16 a[0:15], v[60:63], v[156:159], a[0:15]
  ds_read_b64_tr_b16 v[40:41], v221 offset:15360
  ds_read_b64_tr_b16 v[42:43], v221 offset:16640
  s_waitcnt lgkmcnt(8)
  v_mfma_f32_32x32x16_bf16 a[32:47], v[64:67], v[156:159], a[32:47]
  ds_read_b64_tr_b16 v[44:45], v221 offset:15440
  buffer_load_dwordx4 v217, s[36:39], s74 offen offset:1024 lds
  ds_read_b64_tr_b16 v[46:47], v221 offset:16720
  buffer_load_dwordx4 v[112:115], v225, s[52:55], s73 offen offset:3072 sc1
  s_waitcnt lgkmcnt(8)
  v_mfma_f32_32x32x16_bf16 a[64:79], v[68:71], v[156:159], a[64:79]
  ds_read_b64_tr_b16 v[48:49], v221 offset:15520
  ds_read_b64_tr_b16 v[50:51], v221 offset:16800
  s_waitcnt lgkmcnt(8)
  v_mfma_f32_32x32x16_bf16 a[96:111], v[72:75], v[156:159], a[96:111]
  ds_read_b64_tr_b16 v[52:53], v221 offset:15600
  ds_read_b64_tr_b16 v[54:55], v221 offset:16880
  s_waitcnt lgkmcnt(8)
  v_mfma_f32_32x32x16_bf16 a[160:175], v[76:79], v[156:159], a[160:175]
  ds_read_b64_tr_b16 v[56:57], v229 offset:15360
  ds_read_b64_tr_b16 v[58:59], v229 offset:16640
  buffer_load_dwordx4 v218, s[36:39], s74 offen offset:2048 lds
  s_waitcnt lgkmcnt(8)
  v_mfma_f32_32x32x16_bf16 a[0:15], v[40:43], v[160:163], a[0:15]
  ds_read_b64_tr_b16 v[60:61], v221 offset:20480
  ds_read_b64_tr_b16 v[62:63], v221 offset:21760
  buffer_store_dwordx4 a[224:227], v226, s[64:67], s20 offen offset:2048 sc1
  s_waitcnt lgkmcnt(8)
  v_mfma_f32_32x32x16_bf16 a[32:47], v[44:47], v[160:163], a[32:47]
  ds_read_b64_tr_b16 v[64:65], v221 offset:20560
  ds_read_b64_tr_b16 v[66:67], v221 offset:21840
  v_accvgpr_read_b32 v96, a128
  s_waitcnt lgkmcnt(8)
  v_mfma_f32_32x32x16_bf16 a[64:79], v[48:51], v[160:163], a[64:79]
  ds_read_b64_tr_b16 v[68:69], v221 offset:20640
  buffer_load_dwordx4 v219, s[36:39], s74 offen offset:3072 lds
  s_add_u32 s73, s73, 4096
  ds_read_b64_tr_b16 v[70:71], v221 offset:21920
  buffer_load_dwordx4 v[116:119], v225, s[52:55], s73 offen sc1
  v_accvgpr_read_b32 v97, a129
  s_waitcnt lgkmcnt(8)
  v_mfma_f32_32x32x16_bf16 a[96:111], v[52:55], v[160:163], a[96:111]
  ds_read_b64_tr_b16 v[72:73], v221 offset:20720
  ds_read_b64_tr_b16 v[74:75], v221 offset:22000
  s_waitcnt lgkmcnt(8)
  v_mfma_f32_32x32x16_bf16 a[160:175], v[56:59], v[160:163], a[160:175]
  ds_read_b64_tr_b16 v[76:77], v229 offset:20480
  ds_read_b64_tr_b16 v[78:79], v229 offset:21760
  v_accvgpr_read_b32 v98, a130
  s_waitcnt lgkmcnt(8)
  v_mfma_f32_32x32x16_bf16 a[0:15], v[60:63], v[164:167], a[0:15]
  ds_read_b64_tr_b16 v[40:41], v221 offset:25600
  s_add_u32 m0, s89, 126976
  ds_read_b64_tr_b16 v[42:43], v221 offset:26880
  buffer_load_dwordx4 v220, s[36:39], s74 offen lds
  v_accvgpr_read_b32 v99, a131
  s_waitcnt lgkmcnt(8)
  v_mfma_f32_32x32x16_bf16 a[32:47], v[64:67], v[164:167], a[32:47]
  ds_read_b64_tr_b16 v[44:45], v221 offset:25680
  ds_read_b64_tr_b16 v[46:47], v221 offset:26960
  v_accvgpr_read_b32 v100, a132
  s_waitcnt lgkmcnt(8)
  v_mfma_f32_32x32x16_bf16 a[64:79], v[68:71], v[164:167], a[64:79]
  ds_read_b64_tr_b16 v[48:49], v221 offset:25760
  ds_read_b64_tr_b16 v[50:51], v221 offset:27040
  s_waitcnt lgkmcnt(8)
  v_mfma_f32_32x32x16_bf16 a[96:111], v[72:75], v[164:167], a[96:111]
  ds_read_b64_tr_b16 v[52:53], v221 offset:25840
  s_add_u32 s74, s74, 81920
  s_add_u32 m0, s89, 143360
  ds_read_b64_tr_b16 v[54:55], v221 offset:27120
  buffer_load_dwordx4 v216, s[36:39], s74 offen lds
  buffer_load_dwordx4 v[120:123], v225, s[52:55], s73 offen offset:1024 sc1
  v_accvgpr_read_b32 v101, a133
  s_waitcnt lgkmcnt(8)
  v_mfma_f32_32x32x16_bf16 a[160:175], v[76:79], v[164:167], a[160:175]
  ds_read_b64_tr_b16 v[56:57], v229 offset:25600
  ds_read_b64_tr_b16 v[58:59], v229 offset:26880
  v_accvgpr_read_b32 v102, a134
  s_waitcnt lgkmcnt(8)
  v_mfma_f32_32x32x16_bf16 a[0:15], v[40:43], v[168:171], a[0:15]
  ds_read_b64_tr_b16 v[60:61], v221 offset:30720
  ds_read_b64_tr_b16 v[62:63], v221 offset:32000
  v_accvgpr_read_b32 v103, a135
  s_waitcnt lgkmcnt(8)
  v_mfma_f32_32x32x16_bf16 a[32:47], v[44:47], v[168:171], a[32:47]
  ds_read_b64_tr_b16 v[64:65], v221 offset:30800
  ds_read_b64_tr_b16 v[66:67], v221 offset:32080
  buffer_load_dwordx4 v217, s[36:39], s74 offen offset:1024 lds
  s_waitcnt lgkmcnt(8)
  v_mfma_f32_32x32x16_bf16 a[64:79], v[48:51], v[168:171], a[64:79]
  ds_read_b64_tr_b16 v[68:69], v221 offset:30880
  ds_read_b64_tr_b16 v[70:71], v221 offset:32160
  v_cvt_pk_bf16_f32 v80, v96, v97
  s_waitcnt lgkmcnt(8)
  v_mfma_f32_32x32x16_bf16 a[96:111], v[52:55], v[168:171], a[96:111]
  ds_read_b64_tr_b16 v[72:73], v221 offset:30960
  buffer_load_dwordx4 v[124:127], v225, s[52:55], s73 offen offset:2048 sc1
  ds_read_b64_tr_b16 v[74:75], v221 offset:32240
  v_cvt_pk_bf16_f32 v81, v98, v99
  s_waitcnt lgkmcnt(8)
  v_mfma_f32_32x32x16_bf16 a[160:175], v[56:59], v[168:171], a[160:175]
  ds_read_b64_tr_b16 v[76:77], v229 offset:30720
  buffer_load_dwordx4 v218, s[36:39], s74 offen offset:2048 lds
  ds_read_b64_tr_b16 v[78:79], v229 offset:32000
  v_cvt_pk_bf16_f32 v82, v100, v101
  s_waitcnt lgkmcnt(8)
  v_mfma_f32_32x32x16_bf16 a[0:15], v[60:63], v[172:175], a[0:15]
  ds_read_b64_tr_b16 v[40:41], v221 offset:35840
  ds_read_b64_tr_b16 v[42:43], v221 offset:37120
  s_waitcnt lgkmcnt(8)
  v_mfma_f32_32x32x16_bf16 a[32:47], v[64:67], v[172:175], a[32:47]
  ds_read_b64_tr_b16 v[44:45], v221 offset:35920
  ds_read_b64_tr_b16 v[46:47], v221 offset:37200
  v_cvt_pk_bf16_f32 v83, v102, v103
  s_waitcnt lgkmcnt(8)
  v_mfma_f32_32x32x16_bf16 a[64:79], v[68:71], v[172:175], a[64:79]
  ds_read_b64_tr_b16 v[48:49], v221 offset:36000
  buffer_load_dwordx4 v219, s[36:39], s74 offen offset:3072 lds
  ds_read_b64_tr_b16 v[50:51], v221 offset:37280
  buffer_store_dwordx4 v[80:83], v226, s[64:67], s20 offen sc1
  s_waitcnt lgkmcnt(8)
  v_mfma_f32_32x32x16_bf16 a[96:111], v[72:75], v[172:175], a[96:111]
  ds_read_b64_tr_b16 v[52:53], v221 offset:36080
  ds_read_b64_tr_b16 v[54:55], v221 offset:37360
  s_waitcnt lgkmcnt(8)
  v_mfma_f32_32x32x16_bf16 a[160:175], v[76:79], v[172:175], a[160:175]
  ds_read_b64_tr_b16 v[56:57], v229 offset:35840
  buffer_load_dwordx4 v[16:19], v225, s[52:55], s73 offen offset:3072 sc1
  ds_read_b64_tr_b16 v[58:59], v229 offset:37120
  v_accvgpr_read_b32 v104, a136
  s_waitcnt lgkmcnt(8)
  v_mfma_f32_32x32x16_bf16 a[0:15], v[40:43], v[176:179], a[0:15]
  ds_read_b64_tr_b16 v[60:61], v222 offset:0
  s_add_u32 m0, s89, 147456
  ds_read_b64_tr_b16 v[62:63], v222 offset:1280
  buffer_load_dwordx4 v220, s[36:39], s74 offen lds
  v_accvgpr_read_b32 v105, a137
  s_waitcnt lgkmcnt(8)
  v_mfma_f32_32x32x16_bf16 a[32:47], v[44:47], v[176:179], a[32:47]
  ds_read_b64_tr_b16 v[64:65], v222 offset:80
  ds_read_b64_tr_b16 v[66:67], v222 offset:1360
  v_accvgpr_read_b32 v106, a138
  s_waitcnt lgkmcnt(8)
  v_mfma_f32_32x32x16_bf16 a[64:79], v[48:51], v[176:179], a[64:79]
  ds_read_b64_tr_b16 v[68:69], v222 offset:160
  ds_read_b64_tr_b16 v[70:71], v222 offset:1440
  s_waitcnt lgkmcnt(8)
  v_mfma_f32_32x32x16_bf16 a[96:111], v[52:55], v[176:179], a[96:111]
  ds_read_b64_tr_b16 v[72:73], v222 offset:240
  ds_read_b64_tr_b16 v[74:75], v222 offset:1520
  v_accvgpr_read_b32 v107, a139
  s_waitcnt lgkmcnt(8)
  v_mfma_f32_32x32x16_bf16 a[160:175], v[56:59], v[176:179], a[160:175]
  ds_read_b64_tr_b16 v[76:77], v230 offset:0
  ds_read_b64_tr_b16 v[78:79], v230 offset:1280
  v_accvgpr_read_b32 v108, a140
  s_waitcnt vmcnt(39) lgkmcnt(8)
  v_mfma_f32_32x32x16_bf16 a[0:15], v[60:63], v[180:183], a[0:15]
  ds_read_b64_tr_b16 v[40:41], v222 offset:5120
  s_add_u32 s73, s88, 6
  s_and_b32 s73, s73, 7
  s_lshl2_add_u32 s73, s73, s7
  ds_read_b64_tr_b16 v[42:43], v222 offset:6400
  s_mul_i32 s73, s73, 8192
  buffer_load_dwordx4 v[20:23], v225, s[52:55], s73 offen sc1
  v_accvgpr_read_b32 v109, a141
  s_waitcnt lgkmcnt(8)
  v_mfma_f32_32x32x16_bf16 a[32:47], v[64:67], v[180:183], a[32:47]
  ds_read_b64_tr_b16 v[44:45], v222 offset:5200
  ds_read_b64_tr_b16 v[46:47], v222 offset:6480
  s_waitcnt lgkmcnt(8)
  v_mfma_f32_32x32x16_bf16 a[64:79], v[68:71], v[180:183], a[64:79]
  ds_read_b64_tr_b16 v[48:49], v222 offset:5280
  ds_read_b64_tr_b16 v[50:51], v222 offset:6560
  v_accvgpr_read_b32 v110, a142
  s_waitcnt lgkmcnt(8)
  v_mfma_f32_32x32x16_bf16 a[96:111], v[72:75], v[180:183], a[96:111]
  ds_read_b64_tr_b16 v[52:53], v222 offset:5360
  ds_read_b64_tr_b16 v[54:55], v222 offset:6640
  v_accvgpr_read_b32 v111, a143
  s_waitcnt lgkmcnt(8)
  v_mfma_f32_32x32x16_bf16 a[160:175], v[76:79], v[180:183], a[160:175]
  ds_read_b64_tr_b16 v[56:57], v230 offset:5120
  ds_read_b64_tr_b16 v[58:59], v230 offset:6400
  v_cvt_pk_bf16_f32 v84, v104, v105
  s_waitcnt vmcnt(38) lgkmcnt(8)
  v_mfma_f32_32x32x16_bf16 a[0:15], v[40:43], v[184:187], a[0:15]
  ds_read_b64_tr_b16 v[60:61], v222 offset:10240
  ds_read_b64_tr_b16 v[62:63], v222 offset:11520
  buffer_load_dwordx4 v[24:27], v225, s[52:55], s73 offen offset:1024 sc1
  s_waitcnt lgkmcnt(8)
  v_mfma_f32_32x32x16_bf16 a[32:47], v[44:47], v[184:187], a[32:47]
  ds_read_b64_tr_b16 v[64:65], v222 offset:10320
  ds_read_b64_tr_b16 v[66:67], v222 offset:11600
  v_cvt_pk_bf16_f32 v85, v106, v107
  s_waitcnt lgkmcnt(8)
  v_mfma_f32_32x32x16_bf16 a[64:79], v[48:51], v[184:187], a[64:79]
  ds_read_b64_tr_b16 v[68:69], v222 offset:10400
  ds_read_b64_tr_b16 v[70:71], v222 offset:11680
  v_cvt_pk_bf16_f32 v86, v108, v109
  s_waitcnt lgkmcnt(8)
  v_mfma_f32_32x32x16_bf16 a[96:111], v[52:55], v[184:187], a[96:111]
  s_waitcnt vmcnt(21)
  s_barrier
  buffer_store_dword v255, v254, s[64:67], s68 offen offset:32 sc1
  ds_read_b64_tr_b16 v[72:73], v222 offset:10480
  ds_read_b64_tr_b16 v[74:75], v222 offset:11760
  v_cvt_pk_bf16_f32 v87, v110, v111
  s_waitcnt lgkmcnt(8)
  v_mfma_f32_32x32x16_bf16 a[160:175], v[56:59], v[184:187], a[160:175]
  ds_read_b64_tr_b16 v[76:77], v230 offset:10240
  s_add_u32 s74, s88, 1
  s_and_b32 s74, s74, 7
  s_lshl2_add_u32 s74, s74, s7
  ds_read_b64_tr_b16 v[78:79], v230 offset:11520
  s_mul_i32 s74, s74, 163840
  s_add_u32 m0, s89, 0
  s_nop 0
  buffer_load_dwordx4 v216, s[36:39], s74 offen lds
  s_waitcnt lgkmcnt(8)
  v_mfma_f32_32x32x16_bf16 a[0:15], v[60:63], v[188:191], a[0:15]
  ds_read_b64_tr_b16 v[40:41], v222 offset:15360
  ds_read_b64_tr_b16 v[42:43], v222 offset:16640
  buffer_store_dwordx4 v[84:87], v226, s[64:67], s20 offen offset:1024 sc1
  s_waitcnt lgkmcnt(8)
  v_mfma_f32_32x32x16_bf16 a[32:47], v[64:67], v[188:191], a[32:47]
  ds_read_b64_tr_b16 v[44:45], v222 offset:15440
  buffer_load_dwordx4 v217, s[36:39], s74 offen offset:1024 lds
  ds_read_b64_tr_b16 v[46:47], v222 offset:16720
  buffer_load_dwordx4 v[28:31], v225, s[52:55], s73 offen offset:2048 sc1
  buffer_store_dwordx4 a[228:231], v226, s[64:67], s21 offen offset:2048 sc1
  s_waitcnt lgkmcnt(8)
  v_mfma_f32_32x32x16_bf16 a[64:79], v[68:71], v[188:191], a[64:79]
  ds_read_b64_tr_b16 v[48:49], v222 offset:15520
  ds_read_b64_tr_b16 v[50:51], v222 offset:16800
  s_waitcnt lgkmcnt(8)
  v_mfma_f32_32x32x16_bf16 a[96:111], v[72:75], v[188:191], a[96:111]
  ds_read_b64_tr_b16 v[52:53], v222 offset:15600
  ds_read_b64_tr_b16 v[54:55], v222 offset:16880
  v_accvgpr_read_b32 v96, a144
  s_waitcnt lgkmcnt(8)
  v_mfma_f32_32x32x16_bf16 a[160:175], v[76:79], v[188:191], a[160:175]
  ds_read_b64_tr_b16 v[56:57], v230 offset:15360
  buffer_load_dwordx4 v218, s[36:39], s74 offen offset:2048 lds
  ds_read_b64_tr_b16 v[58:59], v230 offset:16640
  v_accvgpr_read_b32 v97, a145
  s_waitcnt lgkmcnt(8)
  v_mfma_f32_32x32x16_bf16 a[0:15], v[40:43], v[196:199], a[0:15]
  ds_read_b64_tr_b16 v[60:61], v222 offset:20480
  ds_read_b64_tr_b16 v[62:63], v222 offset:21760
  v_accvgpr_read_b32 v98, a146
  s_waitcnt lgkmcnt(8)
  v_mfma_f32_32x32x16_bf16 a[32:47], v[44:47], v[196:199], a[32:47]
  ds_read_b64_tr_b16 v[64:65], v222 offset:20560
  ds_read_b64_tr_b16 v[66:67], v222 offset:21840
  buffer_load_dwordx4 v[32:35], v225, s[52:55], s73 offen offset:3072 sc1
  s_waitcnt lgkmcnt(8)
  v_mfma_f32_32x32x16_bf16 a[64:79], v[48:51], v[196:199], a[64:79]
  ds_read_b64_tr_b16 v[68:69], v222 offset:20640
  buffer_load_dwordx4 v219, s[36:39], s74 offen offset:3072 lds
  ds_read_b64_tr_b16 v[70:71], v222 offset:21920
  v_accvgpr_read_b32 v99, a147
  s_waitcnt lgkmcnt(8)
  v_mfma_f32_32x32x16_bf16 a[96:111], v[52:55], v[196:199], a[96:111]
  ds_read_b64_tr_b16 v[72:73], v222 offset:20720
  ds_read_b64_tr_b16 v[74:75], v222 offset:22000
  v_accvgpr_read_b32 v100, a148
  s_waitcnt lgkmcnt(8)
  v_mfma_f32_32x32x16_bf16 a[160:175], v[56:59], v[196:199], a[160:175]
  ds_read_b64_tr_b16 v[76:77], v230 offset:20480
  ds_read_b64_tr_b16 v[78:79], v230 offset:21760
  v_accvgpr_read_b32 v101, a149
  s_waitcnt lgkmcnt(8)
  v_mfma_f32_32x32x16_bf16 a[0:15], v[60:63], v[200:203], a[0:15]
  ds_read_b64_tr_b16 v[40:41], v222 offset:25600
  s_add_u32 m0, s89, 4096
  ds_read_b64_tr_b16 v[42:43], v222 offset:26880
  buffer_load_dwordx4 v220, s[36:39], s74 offen lds
  s_waitcnt lgkmcnt(8)
  v_mfma_f32_32x32x16_bf16 a[32:47], v[64:67], v[200:203], a[32:47]
  ds_read_b64_tr_b16 v[44:45], v222 offset:25680
  ds_read_b64_tr_b16 v[46:47], v222 offset:26960
  v_accvgpr_read_b32 v102, a150
  s_waitcnt lgkmcnt(8)
  v_mfma_f32_32x32x16_bf16 a[64:79], v[68:71], v[200:203], a[64:79]
  ds_read_b64_tr_b16 v[48:49], v222 offset:25760
  s_add_u32 s73, s73, 4096
  ds_read_b64_tr_b16 v[50:51], v222 offset:27040
  buffer_load_dwordx4 v[36:39], v225, s[52:55], s73 offen sc1
  v_accvgpr_read_b32 v103, a151
  s_waitcnt lgkmcnt(8)
  v_mfma_f32_32x32x16_bf16 a[96:111], v[72:75], v[200:203], a[96:111]
  ds_read_b64_tr_b16 v[52:53], v222 offset:25840
  s_add_u32 s74, s74, 81920
  s_add_u32 m0, s89, 20480
  ds_read_b64_tr_b16 v[54:55], v222 offset:27120
  buffer_load_dwordx4 v216, s[36:39], s74 offen lds
  v_cvt_pk_bf16_f32 v88, v96, v97
  s_waitcnt lgkmcnt(8)
  v_mfma_f32_32x32x16_bf16 a[160:175], v[76:79], v[200:203], a[160:175]
  ds_read_b64_tr_b16 v[56:57], v230 offset:25600
  ds_read_b64_tr_b16 v[58:59], v230 offset:26880
  s_waitcnt lgkmcnt(8)
  v_mfma_f32_32x32x16_bf16 a[0:15], v[40:43], v[204:207], a[0:15]
  ds_read_b64_tr_b16 v[60:61], v222 offset:30720
  s_andn2_b32 s76, s68, 127
  ds_read_b64_tr_b16 v[62:63], v222 offset:32000
  buffer_load_dword v3, v228, s[64:67], s76 offen sc1
  v_cvt_pk_bf16_f32 v89, v98, v99
  s_waitcnt lgkmcnt(8)
  v_mfma_f32_32x32x16_bf16 a[32:47], v[44:47], v[204:207], a[32:47]
  ds_read_b64_tr_b16 v[64:65], v222 offset:30800
  buffer_load_dwordx4 v217, s[36:39], s74 offen offset:1024 lds
  ds_read_b64_tr_b16 v[66:67], v222 offset:32080
  v_cvt_pk_bf16_f32 v90, v100, v101
  s_waitcnt lgkmcnt(8)
  v_mfma_f32_32x32x16_bf16 a[64:79], v[48:51], v[204:207], a[64:79]
  ds_read_b64_tr_b16 v[68:69], v222 offset:30880
  ds_read_b64_tr_b16 v[70:71], v222 offset:32160
  v_cvt_pk_bf16_f32 v91, v102, v103
  s_waitcnt lgkmcnt(8)
  v_mfma_f32_32x32x16_bf16 a[96:111], v[52:55], v[204:207], a[96:111]
  ds_read_b64_tr_b16 v[72:73], v222 offset:30960
  ds_read_b64_tr_b16 v[74:75], v222 offset:32240
  buffer_load_dwordx4 v[128:131], v225, s[52:55], s73 offen offset:1024 sc1
  s_waitcnt lgkmcnt(8)
  v_mfma_f32_32x32x16_bf16 a[160:175], v[56:59], v[204:207], a[160:175]
  ds_read_b64_tr_b16 v[76:77], v230 offset:30720
  buffer_load_dwordx4 v218, s[36:39], s74 offen offset:2048 lds
  ds_read_b64_tr_b16 v[78:79], v230 offset:32000
  buffer_store_dwordx4 v[88:91], v226, s[64:67], s21 offen sc1
  s_waitcnt lgkmcnt(8)
  v_mfma_f32_32x32x16_bf16 a[0:15], v[60:63], v[208:211], a[0:15]
  ds_read_b64_tr_b16 v[40:41], v222 offset:35840
  ds_read_b64_tr_b16 v[42:43], v222 offset:37120
  v_accvgpr_read_b32 v104, a152
  s_waitcnt lgkmcnt(8)
  v_mfma_f32_32x32x16_bf16 a[32:47], v[64:67], v[208:211], a[32:47]
  ds_read_b64_tr_b16 v[44:45], v222 offset:35920
  ds_read_b64_tr_b16 v[46:47], v222 offset:37200
  s_waitcnt lgkmcnt(8)
  v_mfma_f32_32x32x16_bf16 a[64:79], v[68:71], v[208:211], a[64:79]
  ds_read_b64_tr_b16 v[48:49], v222 offset:36000
  buffer_load_dwordx4 v219, s[36:39], s74 offen offset:3072 lds
  ds_read_b64_tr_b16 v[50:51], v222 offset:37280
  v_accvgpr_read_b32 v105, a153
  s_waitcnt lgkmcnt(8)
  v_mfma_f32_32x32x16_bf16 a[96:111], v[72:75], v[208:211], a[96:111]
  ds_read_b64_tr_b16 v[52:53], v222 offset:36080
  buffer_load_dwordx4 v[132:135], v225, s[52:55], s73 offen offset:2048 sc1
  ds_read_b64_tr_b16 v[54:55], v222 offset:37360
  v_accvgpr_read_b32 v106, a154
  s_waitcnt lgkmcnt(8)
  v_mfma_f32_32x32x16_bf16 a[160:175], v[76:79], v[208:211], a[160:175]
  ds_read_b64_tr_b16 v[56:57], v230 offset:35840
  ds_read_b64_tr_b16 v[58:59], v230 offset:37120
  v_accvgpr_read_b32 v107, a155
  s_waitcnt lgkmcnt(8)
  v_mfma_f32_32x32x16_bf16 a[0:15], v[40:43], v[232:235], a[0:15]
  ds_read_b64_tr_b16 v[60:61], v223 offset:0
  s_add_u32 m0, s89, 24576
  ds_read_b64_tr_b16 v[62:63], v223 offset:1280
  buffer_load_dwordx4 v220, s[36:39], s74 offen lds
  s_waitcnt lgkmcnt(8)
  v_mfma_f32_32x32x16_bf16 a[32:47], v[44:47], v[232:235], a[32:47]
  ds_read_b64_tr_b16 v[64:65], v223 offset:80
  ds_read_b64_tr_b16 v[66:67], v223 offset:1360
  v_accvgpr_read_b32 v108, a156
  s_waitcnt lgkmcnt(8)
  v_mfma_f32_32x32x16_bf16 a[64:79], v[48:51], v[232:235], a[64:79]
  ds_read_b64_tr_b16 v[68:69], v223 offset:160
  ds_read_b64_tr_b16 v[70:71], v223 offset:1440
  v_accvgpr_read_b32 v109, a157
  s_waitcnt lgkmcnt(8)
  v_mfma_f32_32x32x16_bf16 a[96:111], v[52:55], v[232:235], a[96:111]
  ds_read_b64_tr_b16 v[72:73], v223 offset:240
  ds_read_b64_tr_b16 v[74:75], v223 offset:1520
  v_accvgpr_read_b32 v110, a158
  s_waitcnt lgkmcnt(8)
  v_mfma_f32_32x32x16_bf16 a[160:175], v[56:59], v[232:235], a[160:175]
  ds_read_b64_tr_b16 v[76:77], v231 offset:0
  ds_read_b64_tr_b16 v[78:79], v231 offset:1280
  buffer_load_dwordx4 v[136:139], v225, s[52:55], s73 offen offset:3072 sc1
  s_waitcnt lgkmcnt(8)
  v_mfma_f32_32x32x16_bf16 a[0:15], v[60:63], v[236:239], a[0:15]
  ds_read_b64_tr_b16 v[40:41], v223 offset:5120
  ds_read_b64_tr_b16 v[42:43], v223 offset:6400
  v_accvgpr_read_b32 v111, a159
  s_waitcnt lgkmcnt(8)
  v_mfma_f32_32x32x16_bf16 a[32:47], v[64:67], v[236:239], a[32:47]
  ds_read_b64_tr_b16 v[44:45], v223 offset:5200
  ds_read_b64_tr_b16 v[46:47], v223 offset:6480
  v_cvt_pk_bf16_f32 v92, v104, v105
  s_waitcnt lgkmcnt(8)
  v_mfma_f32_32x32x16_bf16 a[64:79], v[68:71], v[236:239], a[64:79]
  ds_read_b64_tr_b16 v[48:49], v223 offset:5280
  ds_read_b64_tr_b16 v[50:51], v223 offset:6560
  v_cvt_pk_bf16_f32 v93, v106, v107
  s_waitcnt lgkmcnt(8)
  v_mfma_f32_32x32x16_bf16 a[96:111], v[72:75], v[236:239], a[96:111]
  ds_read_b64_tr_b16 v[52:53], v223 offset:5360
  ds_read_b64_tr_b16 v[54:55], v223 offset:6640
  s_waitcnt lgkmcnt(8)
  v_mfma_f32_32x32x16_bf16 a[160:175], v[76:79], v[236:239], a[160:175]
  ds_read_b64_tr_b16 v[56:57], v231 offset:5120
  ds_read_b64_tr_b16 v[58:59], v231 offset:6400
  v_cvt_pk_bf16_f32 v94, v108, v109
  s_waitcnt vmcnt(41) lgkmcnt(8)
  v_mfma_f32_32x32x16_bf16 a[0:15], v[40:43], v[240:243], a[0:15]
  s_waitcnt vmcnt(8)
  v_cmp_ne_u32 vcc, 0, v3
  s_nop 1
  s_and_b32 s82, vcc_lo, s6
  s_cmp_eq_u32 s82, s6
  s_cbranch_scc0 L_spinO2
L_backO2:
  ds_read_b64_tr_b16 v[60:61], v223 offset:10240
  s_add_u32 s73, s88, 1
  s_and_b32 s73, s73, 7
  s_lshl2_add_u32 s73, s73, s7
  ds_read_b64_tr_b16 v[62:63], v223 offset:11520
  s_mul_i32 s73, s73, 8192
  buffer_load_dwordx4 v[140:143], v225, s[52:55], s73 offen sc1
  v_cvt_pk_bf16_f32 v95, v110, v111
  s_waitcnt lgkmcnt(6)
  v_mfma_f32_32x32x16_bf16 a[32:47], v[44:47], v[240:243], a[32:47]
  ds_read_b64_tr_b16 v[64:65], v223 offset:10320
  ds_read_b64_tr_b16 v[66:67], v223 offset:11600
  buffer_store_dwordx4 v[92:95], v226, s[64:67], s21 offen offset:1024 sc1
  v_mfma_f32_32x32x16_bf16 a[64:79], v[48:51], v[240:243], a[64:79]
  ds_read_b64_tr_b16 v[68:69], v223 offset:10400
  ds_read_b64_tr_b16 v[70:71], v223 offset:11680
  s_waitcnt lgkmcnt(7)
  v_mfma_f32_32x32x16_bf16 a[96:111], v[52:55], v[240:243], a[96:111]
  s_barrier
  ds_read_b64_tr_b16 v[72:73], v223 offset:10480
  buffer_load_dwordx4 v[144:147], v225, s[52:55], s73 offen offset:1024 sc1
  ds_read_b64_tr_b16 v[74:75], v223 offset:11760
  buffer_store_dwordx4 a[232:235], v226, s[64:67], s22 offen offset:2048 sc1
  s_waitcnt lgkmcnt(8)
  v_mfma_f32_32x32x16_bf16 a[160:175], v[56:59], v[240:243], a[160:175]
  ds_read_b64_tr_b16 v[76:77], v231 offset:10240
  s_add_u32 s74, s88, 3
  s_and_b32 s74, s74, 7
  s_lshl2_add_u32 s74, s74, s7
  ds_read_b64_tr_b16 v[78:79], v231 offset:11520
  s_mul_i32 s74, s74, 163840
  s_add_u32 m0, s89, 40960
  s_nop 0
  buffer_load_dwordx4 v216, s[36:39], s74 offen lds
  v_accvgpr_read_b32 v96, a192
  s_waitcnt lgkmcnt(8)
  v_mfma_f32_32x32x16_bf16 a[0:15], v[60:63], v[244:247], a[0:15]
  ds_read_b64_tr_b16 v[40:41], v223 offset:15360
  ds_read_b64_tr_b16 v[42:43], v223 offset:16640
  s_waitcnt lgkmcnt(8)
  v_mfma_f32_32x32x16_bf16 a[32:47], v[64:67], v[244:247], a[32:47]
  ds_read_b64_tr_b16 v[44:45], v223 offset:15440
  buffer_load_dwordx4 v217, s[36:39], s74 offen offset:1024 lds
  ds_read_b64_tr_b16 v[46:47], v223 offset:16720
  v_accvgpr_read_b32 v97, a193
  s_waitcnt lgkmcnt(8)
  v_mfma_f32_32x32x16_bf16 a[64:79], v[68:71], v[244:247], a[64:79]
  ds_read_b64_tr_b16 v[48:49], v223 offset:15520
  buffer_load_dwordx4 v[148:151], v225, s[52:55], s73 offen offset:2048 sc1
  ds_read_b64_tr_b16 v[50:51], v223 offset:16800
  v_accvgpr_read_b32 v98, a194
  s_waitcnt lgkmcnt(8)
  v_mfma_f32_32x32x16_bf16 a[96:111], v[72:75], v[244:247], a[96:111]
  ds_read_b64_tr_b16 v[52:53], v223 offset:15600
  ds_read_b64_tr_b16 v[54:55], v223 offset:16880
  v_accvgpr_read_b32 v99, a195
  s_waitcnt lgkmcnt(8)
  v_mfma_f32_32x32x16_bf16 a[160:175], v[76:79], v[244:247], a[160:175]
  ds_read_b64_tr_b16 v[56:57], v231 offset:15360
  ds_read_b64_tr_b16 v[58:59], v231 offset:16640
  buffer_load_dwordx4 v218, s[36:39], s74 offen offset:2048 lds
  s_waitcnt lgkmcnt(8)
  v_mfma_f32_32x32x16_bf16 a[0:15], v[40:43], v[112:115], a[0:15]
  ds_read_b64_tr_b16 v[60:61], v223 offset:20480
  buffer_load_dwordx4 v[152:155], v225, s[52:55], s73 offen offset:3072 sc1
  ds_read_b64_tr_b16 v[62:63], v223 offset:21760
  v_accvgpr_read_b32 v100, a196
  s_waitcnt lgkmcnt(8)
  v_mfma_f32_32x32x16_bf16 a[32:47], v[44:47], v[112:115], a[32:47]
  ds_read_b64_tr_b16 v[64:65], v223 offset:20560
  ds_read_b64_tr_b16 v[66:67], v223 offset:21840
  v_accvgpr_read_b32 v101, a197
  s_waitcnt lgkmcnt(8)
  v_mfma_f32_32x32x16_bf16 a[64:79], v[48:51], v[112:115], a[64:79]
  ds_read_b64_tr_b16 v[68:69], v223 offset:20640
  buffer_load_dwordx4 v219, s[36:39], s74 offen offset:3072 lds
  ds_read_b64_tr_b16 v[70:71], v223 offset:21920
  v_accvgpr_read_b32 v102, a198
  s_waitcnt lgkmcnt(8)
  v_mfma_f32_32x32x16_bf16 a[96:111], v[52:55], v[112:115], a[96:111]
  ds_read_b64_tr_b16 v[72:73], v223 offset:20720
  ds_read_b64_tr_b16 v[74:75], v223 offset:22000
  s_waitcnt lgkmcnt(8)
  v_mfma_f32_32x32x16_bf16 a[160:175], v[56:59], v[112:115], a[160:175]
  ds_read_b64_tr_b16 v[76:77], v231 offset:20480
  s_add_u32 s73, s73, 4096
  ds_read_b64_tr_b16 v[78:79], v231 offset:21760
  buffer_load_dwordx4 v[156:159], v225, s[52:55], s73 offen sc1
  v_accvgpr_read_b32 v103, a199
  s_waitcnt lgkmcnt(8)
  v_mfma_f32_32x32x16_bf16 a[0:15], v[60:63], v[116:119], a[0:15]
  ds_read_b64_tr_b16 v[40:41], v223 offset:25600
  s_add_u32 m0, s89, 45056
  ds_read_b64_tr_b16 v[42:43], v223 offset:26880
  buffer_load_dwordx4 v220, s[36:39], s74 offen lds
  v_cvt_pk_bf16_f32 v80, v96, v97
  s_waitcnt lgkmcnt(8)
  v_mfma_f32_32x32x16_bf16 a[32:47], v[64:67], v[116:119], a[32:47]
  ds_read_b64_tr_b16 v[44:45], v223 offset:25680
  ds_read_b64_tr_b16 v[46:47], v223 offset:26960
  v_cvt_pk_bf16_f32 v81, v98, v99
  s_waitcnt lgkmcnt(8)
  v_mfma_f32_32x32x16_bf16 a[64:79], v[68:71], v[116:119], a[64:79]
  ds_read_b64_tr_b16 v[48:49], v223 offset:25760
  ds_read_b64_tr_b16 v[50:51], v223 offset:27040
  s_waitcnt lgkmcnt(8)
  v_mfma_f32_32x32x16_bf16 a[96:111], v[72:75], v[116:119], a[96:111]
  ds_read_b64_tr_b16 v[52:53], v223 offset:25840
  s_add_u32 s74, s74, 81920
  s_add_u32 m0, s89, 61440
  ds_read_b64_tr_b16 v[54:55], v223 offset:27120
  buffer_load_dwordx4 v216, s[36:39], s74 offen lds
  buffer_load_dwordx4 v[160:163], v225, s[52:55], s73 offen offset:1024 sc1
  v_cvt_pk_bf16_f32 v82, v100, v101
  s_waitcnt lgkmcnt(8)
  v_mfma_f32_32x32x16_bf16 a[160:175], v[76:79], v[116:119], a[160:175]
  ds_read_b64_tr_b16 v[56:57], v231 offset:25600
  ds_read_b64_tr_b16 v[58:59], v231 offset:26880
  v_cvt_pk_bf16_f32 v83, v102, v103
  s_waitcnt lgkmcnt(8)
  v_mfma_f32_32x32x16_bf16 a[0:15], v[40:43], v[120:123], a[0:15]
  ds_read_b64_tr_b16 v[60:61], v223 offset:30720
  ds_read_b64_tr_b16 v[62:63], v223 offset:32000
  buffer_store_dwordx4 v[80:83], v226, s[64:67], s22 offen sc1
  s_waitcnt lgkmcnt(8)
  v_mfma_f32_32x32x16_bf16 a[32:47], v[44:47], v[120:123], a[32:47]
  ds_read_b64_tr_b16 v[64:65], v223 offset:30800
  buffer_load_dwordx4 v217, s[36:39], s74 offen offset:1024 lds
  ds_read_b64_tr_b16 v[66:67], v223 offset:32080
  buffer_load_dwordx4 v[164:167], v225, s[52:55], s73 offen offset:2048 sc1
  s_waitcnt lgkmcnt(8)
  v_mfma_f32_32x32x16_bf16 a[64:79], v[48:51], v[120:123], a[64:79]
  ds_read_b64_tr_b16 v[68:69], v223 offset:30880
  ds_read_b64_tr_b16 v[70:71], v223 offset:32160
  v_accvgpr_read_b32 v104, a200
  s_waitcnt lgkmcnt(8)
  v_mfma_f32_32x32x16_bf16 a[96:111], v[52:55], v[120:123], a[96:111]
  ds_read_b64_tr_b16 v[72:73], v223 offset:30960
  ds_read_b64_tr_b16 v[74:75], v223 offset:32240
  v_accvgpr_read_b32 v105, a201
  s_waitcnt lgkmcnt(8)
  v_mfma_f32_32x32x16_bf16 a[160:175], v[56:59], v[120:123], a[160:175]
  ds_read_b64_tr_b16 v[76:77], v231 offset:30720
  ds_read_b64_tr_b16 v[78:79], v231 offset:32000
  buffer_load_dwordx4 v218, s[36:39], s74 offen offset:2048 lds
  s_waitcnt lgkmcnt(8)
  v_mfma_f32_32x32x16_bf16 a[0:15], v[60:63], v[124:127], a[0:15]
  ds_read_b64_tr_b16 v[40:41], v223 offset:35840
  buffer_load_dwordx4 v[168:171], v225, s[52:55], s73 offen offset:3072 sc1
  ds_read_b64_tr_b16 v[42:43], v223 offset:37120
  v_accvgpr_read_b32 v106, a202
  s_waitcnt lgkmcnt(8)
  v_mfma_f32_32x32x16_bf16 a[32:47], v[64:67], v[124:127], a[32:47]
  ds_read_b64_tr_b16 v[44:45], v223 offset:35920
  ds_read_b64_tr_b16 v[46:47], v223 offset:37200
  v_accvgpr_read_b32 v107, a203
  s_waitcnt lgkmcnt(8)
  v_mfma_f32_32x32x16_bf16 a[64:79], v[68:71], v[124:127], a[64:79]
  ds_read_b64_tr_b16 v[48:49], v223 offset:36000
  buffer_load_dwordx4 v219, s[36:39], s74 offen offset:3072 lds
  ds_read_b64_tr_b16 v[50:51], v223 offset:37280
  v_accvgpr_read_b32 v108, a204
  s_waitcnt lgkmcnt(8)
  v_mfma_f32_32x32x16_bf16 a[96:111], v[72:75], v[124:127], a[96:111]
  ds_read_b64_tr_b16 v[52:53], v223 offset:36080
  ds_read_b64_tr_b16 v[54:55], v223 offset:37360
  s_waitcnt lgkmcnt(8)
  v_mfma_f32_32x32x16_bf16 a[160:175], v[76:79], v[124:127], a[160:175]
  ds_read_b64_tr_b16 v[56:57], v231 offset:35840
  s_add_u32 s73, s88, 3
  s_and_b32 s73, s73, 7
  s_lshl2_add_u32 s73, s73, s7
  ds_read_b64_tr_b16 v[58:59], v231 offset:37120
  s_mul_i32 s73, s73, 8192
  buffer_load_dwordx4 a[176:179], v225, s[52:55], s73 offen sc1
  v_accvgpr_read_b32 v109, a205
  s_waitcnt lgkmcnt(8)
  v_mfma_f32_32x32x16_bf16 a[0:15], v[40:43], v[16:19], a[0:15]
  ds_read_b64_tr_b16 v[60:61], v224 offset:0
  s_add_u32 m0, s89, 65536
  ds_read_b64_tr_b16 v[62:63], v224 offset:1280
  buffer_load_dwordx4 v220, s[36:39], s74 offen lds
  v_accvgpr_read_b32 v110, a206
  s_waitcnt lgkmcnt(8)
  v_mfma_f32_32x32x16_bf16 a[32:47], v[44:47], v[16:19], a[32:47]
  ds_read_b64_tr_b16 v[64:65], v224 offset:80
  ds_read_b64_tr_b16 v[66:67], v224 offset:1360
  v_accvgpr_read_b32 v111, a207
  s_waitcnt lgkmcnt(8)
  v_mfma_f32_32x32x16_bf16 a[64:79], v[48:51], v[16:19], a[64:79]
  ds_read_b64_tr_b16 v[68:69], v224 offset:160
  ds_read_b64_tr_b16 v[70:71], v224 offset:1440
  buffer_load_dwordx4 a[180:183], v225, s[52:55], s73 offen offset:1024 sc1
  s_waitcnt lgkmcnt(8)
  v_mfma_f32_32x32x16_bf16 a[96:111], v[52:55], v[16:19], a[96:111]
  ds_read_b64_tr_b16 v[72:73], v224 offset:240
  ds_read_b64_tr_b16 v[74:75], v224 offset:1520
  v_cvt_pk_bf16_f32 v84, v104, v105
  s_waitcnt lgkmcnt(8)
  v_mfma_f32_32x32x16_bf16 a[160:175], v[56:59], v[16:19], a[160:175]
  ds_read_b64_tr_b16 v[76:77], v8 offset:0
  ds_read_b64_tr_b16 v[78:79], v8 offset:1280
  v_cvt_pk_bf16_f32 v85, v106, v107
  s_waitcnt lgkmcnt(8)
  v_mfma_f32_32x32x16_bf16 a[0:15], v[60:63], v[20:23], a[0:15]
  ds_read_b64_tr_b16 v[40:41], v224 offset:5120
  ds_read_b64_tr_b16 v[42:43], v224 offset:6400
  v_cvt_pk_bf16_f32 v86, v108, v109
  s_waitcnt lgkmcnt(8)
  v_mfma_f32_32x32x16_bf16 a[32:47], v[64:67], v[20:23], a[32:47]
  ds_read_b64_tr_b16 v[44:45], v224 offset:5200
  ds_read_b64_tr_b16 v[46:47], v224 offset:6480
  buffer_load_dwordx4 a[184:187], v225, s[52:55], s73 offen offset:2048 sc1
  s_waitcnt lgkmcnt(8)
  v_mfma_f32_32x32x16_bf16 a[64:79], v[68:71], v[20:23], a[64:79]
  ds_read_b64_tr_b16 v[48:49], v224 offset:5280
  ds_read_b64_tr_b16 v[50:51], v224 offset:6560
  v_cvt_pk_bf16_f32 v87, v110, v111
  s_waitcnt lgkmcnt(8)
  v_mfma_f32_32x32x16_bf16 a[96:111], v[72:75], v[20:23], a[96:111]
  ds_read_b64_tr_b16 v[52:53], v224 offset:5360
  ds_read_b64_tr_b16 v[54:55], v224 offset:6640
  buffer_store_dwordx4 v[84:87], v226, s[64:67], s22 offen offset:1024 sc1
  s_waitcnt lgkmcnt(8)
  v_mfma_f32_32x32x16_bf16 a[160:175], v[76:79], v[20:23], a[160:175]
  ds_read_b64_tr_b16 v[56:57], v8 offset:5120
  ds_read_b64_tr_b16 v[58:59], v8 offset:6400
  s_waitcnt lgkmcnt(8)
  v_mfma_f32_32x32x16_bf16 a[0:15], v[40:43], v[24:27], a[0:15]
  ds_read_b64_tr_b16 v[60:61], v224 offset:10240
  ds_read_b64_tr_b16 v[62:63], v224 offset:11520
  buffer_load_dwordx4 a[188:191], v225, s[52:55], s73 offen offset:3072 sc1
  s_waitcnt lgkmcnt(8)
  v_mfma_f32_32x32x16_bf16 a[32:47], v[44:47], v[24:27], a[32:47]
  ds_read_b64_tr_b16 v[64:65], v224 offset:10320
  s_add_u32 s20, s20, 36864
  ds_read_b64_tr_b16 v[66:67], v224 offset:11600
  s_add_u32 s21, s21, 36864
  s_add_u32 s22, s22, 36864
  s_waitcnt lgkmcnt(8)
  v_mfma_f32_32x32x16_bf16 a[64:79], v[48:51], v[24:27], a[64:79]
  ds_read_b64_tr_b16 v[68:69], v224 offset:10400
  ds_read_b64_tr_b16 v[70:71], v224 offset:11680
  s_waitcnt lgkmcnt(8)
  v_mfma_f32_32x32x16_bf16 a[96:111], v[52:55], v[24:27], a[96:111]
  s_waitcnt vmcnt(27)
  s_barrier
  ds_read_b64_tr_b16 v[72:73], v224 offset:10480
  s_add_u32 s73, s73, 4096
  ds_read_b64_tr_b16 v[74:75], v224 offset:11760
  buffer_load_dwordx4 a[240:243], v225, s[52:55], s73 offen sc1
  s_waitcnt lgkmcnt(8)
  v_mfma_f32_32x32x16_bf16 a[160:175], v[56:59], v[24:27], a[160:175]
  ds_read_b64_tr_b16 v[76:77], v8 offset:10240
  s_add_u32 s74, s88, 5
  s_and_b32 s74, s74, 7
  s_lshl2_add_u32 s74, s74, s7
  ds_read_b64_tr_b16 v[78:79], v8 offset:11520
  s_mul_i32 s74, s74, 163840
  s_add_u32 m0, s89, 81920
  s_nop 0
  buffer_load_dwordx4 v216, s[36:39], s74 offen lds
  s_waitcnt lgkmcnt(7)
  v_mfma_f32_32x32x16_bf16 a[0:15], v[60:63], v[28:31], a[0:15]
  ds_read_b64_tr_b16 v[40:41], v224 offset:15360
  ds_read_b64_tr_b16 v[42:43], v224 offset:16640
  s_waitcnt lgkmcnt(8)
  v_mfma_f32_32x32x16_bf16 a[32:47], v[64:67], v[28:31], a[32:47]
  ds_read_b64_tr_b16 v[44:45], v224 offset:15440
  ds_read_b64_tr_b16 v[46:47], v224 offset:16720
  buffer_load_dwordx4 v217, s[36:39], s74 offen offset:1024 lds
  s_waitcnt lgkmcnt(8)
  v_mfma_f32_32x32x16_bf16 a[64:79], v[68:71], v[28:31], a[64:79]
  ds_read_b64_tr_b16 v[48:49], v224 offset:15520
  ds_read_b64_tr_b16 v[50:51], v224 offset:16800
  buffer_load_dwordx4 a[244:247], v225, s[52:55], s73 offen offset:1024 sc1
  s_waitcnt lgkmcnt(8)
  v_mfma_f32_32x32x16_bf16 a[96:111], v[72:75], v[28:31], a[96:111]
  ds_read_b64_tr_b16 v[52:53], v224 offset:15600
  ds_read_b64_tr_b16 v[54:55], v224 offset:16880
  s_waitcnt lgkmcnt(8)
  v_mfma_f32_32x32x16_bf16 a[160:175], v[76:79], v[28:31], a[160:175]
  ds_read_b64_tr_b16 v[56:57], v8 offset:15360
  ds_read_b64_tr_b16 v[58:59], v8 offset:16640
  buffer_load_dwordx4 v218, s[36:39], s74 offen offset:2048 lds
  s_waitcnt lgkmcnt(8)
  v_mfma_f32_32x32x16_bf16 a[0:15], v[40:43], v[32:35], a[0:15]
  ds_read_b64_tr_b16 v[60:61], v224 offset:20480
  ds_read_b64_tr_b16 v[62:63], v224 offset:21760
  s_waitcnt lgkmcnt(8)
  v_mfma_f32_32x32x16_bf16 a[32:47], v[44:47], v[32:35], a[32:47]
  ds_read_b64_tr_b16 v[64:65], v224 offset:20560
  ds_read_b64_tr_b16 v[66:67], v224 offset:21840
  buffer_load_dwordx4 a[248:251], v225, s[52:55], s73 offen offset:2048 sc1
  s_waitcnt lgkmcnt(8)
  v_mfma_f32_32x32x16_bf16 a[64:79], v[48:51], v[32:35], a[64:79]
  ds_read_b64_tr_b16 v[68:69], v224 offset:20640
  ds_read_b64_tr_b16 v[70:71], v224 offset:21920
  buffer_load_dwordx4 v219, s[36:39], s74 offen offset:3072 lds
  s_waitcnt lgkmcnt(8)
  v_mfma_f32_32x32x16_bf16 a[96:111], v[52:55], v[32:35], a[96:111]
  ds_read_b64_tr_b16 v[72:73], v224 offset:20720
  ds_read_b64_tr_b16 v[74:75], v224 offset:22000
  s_waitcnt lgkmcnt(8)
  v_mfma_f32_32x32x16_bf16 a[160:175], v[56:59], v[32:35], a[160:175]
  ds_read_b64_tr_b16 v[76:77], v8 offset:20480
  ds_read_b64_tr_b16 v[78:79], v8 offset:21760
  buffer_load_dwordx4 a[252:255], v225, s[52:55], s73 offen offset:3072 sc1
  s_waitcnt lgkmcnt(8)
  v_mfma_f32_32x32x16_bf16 a[0:15], v[60:63], v[36:39], a[0:15]
  ds_read_b64_tr_b16 v[40:41], v224 offset:25600
  s_add_u32 m0, s89, 86016
  ds_read_b64_tr_b16 v[42:43], v224 offset:26880
  buffer_load_dwordx4 v220, s[36:39], s74 offen lds
  s_waitcnt lgkmcnt(8)
  v_mfma_f32_32x32x16_bf16 a[32:47], v[64:67], v[36:39], a[32:47]
  ds_read_b64_tr_b16 v[44:45], v224 offset:25680
  ds_read_b64_tr_b16 v[46:47], v224 offset:26960
  s_waitcnt lgkmcnt(8)
  v_mfma_f32_32x32x16_bf16 a[64:79], v[68:71], v[36:39], a[64:79]
  ds_read_b64_tr_b16 v[48:49], v224 offset:25760
  ds_read_b64_tr_b16 v[50:51], v224 offset:27040
  s_waitcnt lgkmcnt(8)
  v_mfma_f32_32x32x16_bf16 a[96:111], v[72:75], v[36:39], a[96:111]
  ds_read_b64_tr_b16 v[52:53], v224 offset:25840
  s_add_u32 s74, s74, 81920
  s_add_u32 m0, s89, 102400
  s_nop 0
  buffer_load_dwordx4 v216, s[36:39], s74 offen lds
  s_add_u32 s73, s88, 5
  ds_read_b64_tr_b16 v[54:55], v224 offset:27120
  s_and_b32 s73, s73, 7
  s_lshl2_add_u32 s73, s73, s7
  s_mul_i32 s73, s73, 8192
  buffer_load_dwordx4 a[16:19], v225, s[52:55], s73 offen sc1
  s_waitcnt lgkmcnt(8)
  v_mfma_f32_32x32x16_bf16 a[160:175], v[76:79], v[36:39], a[160:175]
  ds_read_b64_tr_b16 v[56:57], v8 offset:25600
  ds_read_b64_tr_b16 v[58:59], v8 offset:26880
  s_waitcnt lgkmcnt(8)
  v_mfma_f32_32x32x16_bf16 a[0:15], v[40:43], v[128:131], a[0:15]
  ds_read_b64_tr_b16 v[60:61], v224 offset:30720
  ds_read_b64_tr_b16 v[62:63], v224 offset:32000
  s_waitcnt lgkmcnt(8)
  v_mfma_f32_32x32x16_bf16 a[32:47], v[44:47], v[128:131], a[32:47]
  ds_read_b64_tr_b16 v[64:65], v224 offset:30800
  ds_read_b64_tr_b16 v[66:67], v224 offset:32080
  buffer_load_dwordx4 v217, s[36:39], s74 offen offset:1024 lds
  s_waitcnt lgkmcnt(8)
  v_mfma_f32_32x32x16_bf16 a[64:79], v[48:51], v[128:131], a[64:79]
  ds_read_b64_tr_b16 v[68:69], v224 offset:30880
  ds_read_b64_tr_b16 v[70:71], v224 offset:32160
  buffer_load_dwordx4 a[20:23], v225, s[52:55], s73 offen offset:1024 sc1
  s_waitcnt lgkmcnt(8)
  v_mfma_f32_32x32x16_bf16 a[96:111], v[52:55], v[128:131], a[96:111]
  ds_read_b64_tr_b16 v[72:73], v224 offset:30960
  ds_read_b64_tr_b16 v[74:75], v224 offset:32240
  s_waitcnt lgkmcnt(8)
  v_mfma_f32_32x32x16_bf16 a[160:175], v[56:59], v[128:131], a[160:175]
  ds_read_b64_tr_b16 v[76:77], v8 offset:30720
  ds_read_b64_tr_b16 v[78:79], v8 offset:32000
  buffer_load_dwordx4 v218, s[36:39], s74 offen offset:2048 lds
  s_waitcnt lgkmcnt(8)
  v_mfma_f32_32x32x16_bf16 a[0:15], v[60:63], v[132:135], a[0:15]
  ds_read_b64_tr_b16 v[40:41], v224 offset:35840
  ds_read_b64_tr_b16 v[42:43], v224 offset:37120
  buffer_load_dwordx4 a[24:27], v225, s[52:55], s73 offen offset:2048 sc1
  s_waitcnt lgkmcnt(8)
  v_mfma_f32_32x32x16_bf16 a[32:47], v[64:67], v[132:135], a[32:47]
  ds_read_b64_tr_b16 v[44:45], v224 offset:35920
  ds_read_b64_tr_b16 v[46:47], v224 offset:37200
  s_waitcnt lgkmcnt(8)
  v_mfma_f32_32x32x16_bf16 a[64:79], v[68:71], v[132:135], a[64:79]
  ds_read_b64_tr_b16 v[48:49], v224 offset:36000
  ds_read_b64_tr_b16 v[50:51], v224 offset:37280
  buffer_load_dwordx4 v219, s[36:39], s74 offen offset:3072 lds
  s_waitcnt lgkmcnt(8)
  v_mfma_f32_32x32x16_bf16 a[96:111], v[72:75], v[132:135], a[96:111]
  ds_read_b64_tr_b16 v[52:53], v224 offset:36080
  ds_read_b64_tr_b16 v[54:55], v224 offset:37360
  s_waitcnt lgkmcnt(8)
  v_mfma_f32_32x32x16_bf16 a[160:175], v[76:79], v[132:135], a[160:175]
  ds_read_b64_tr_b16 v[56:57], v8 offset:35840
  ds_read_b64_tr_b16 v[58:59], v8 offset:37120
  buffer_load_dwordx4 a[28:31], v225, s[52:55], s73 offen offset:3072 sc1
  s_waitcnt vmcnt(43) lgkmcnt(8)
  v_mfma_f32_32x32x16_bf16 a[0:15], v[40:43], v[136:139], a[0:15]
  ds_read_b64_tr_b16 v[60:61], v221 offset:0
  s_add_u32 m0, s89, 106496
  ds_read_b64_tr_b16 v[62:63], v221 offset:1280
  buffer_load_dwordx4 v220, s[36:39], s74 offen lds
  s_waitcnt lgkmcnt(8)
  v_mfma_f32_32x32x16_bf16 a[32:47], v[44:47], v[136:139], a[32:47]
  ds_read_b64_tr_b16 v[64:65], v221 offset:80
  ds_read_b64_tr_b16 v[66:67], v221 offset:1360
  s_waitcnt lgkmcnt(8)
  v_mfma_f32_32x32x16_bf16 a[64:79], v[48:51], v[136:139], a[64:79]
  ds_read_b64_tr_b16 v[68:69], v221 offset:160
  ds_read_b64_tr_b16 v[70:71], v221 offset:1440
  s_waitcnt lgkmcnt(8)
  v_mfma_f32_32x32x16_bf16 a[96:111], v[52:55], v[136:139], a[96:111]
  ds_read_b64_tr_b16 v[72:73], v229 offset:0
  s_add_u32 s73, s73, 4096
  ds_read_b64_tr_b16 v[74:75], v229 offset:1280
  buffer_load_dwordx4 a[48:51], v225, s[52:55], s73 offen sc1
  s_waitcnt lgkmcnt(8)
  v_mfma_f32_32x32x16_bf16 a[160:175], v[56:59], v[136:139], a[160:175]
  ds_read_b64_tr_b16 v[76:77], v221 offset:5120
  ds_read_b64_tr_b16 v[78:79], v221 offset:6400
  s_waitcnt vmcnt(44) lgkmcnt(8)
  v_mfma_f32_32x32x16_bf16 a[0:15], v[60:63], v[140:143], a[0:15]
  ds_read_b64_tr_b16 v[40:41], v221 offset:5200
  ds_read_b64_tr_b16 v[42:43], v221 offset:6480
  s_waitcnt lgkmcnt(8)
  v_mfma_f32_32x32x16_bf16 a[32:47], v[64:67], v[140:143], a[32:47]
  ds_read_b64_tr_b16 v[44:45], v221 offset:5280
  ds_read_b64_tr_b16 v[46:47], v221 offset:6560
  buffer_load_dwordx4 a[52:55], v225, s[52:55], s73 offen offset:1024 sc1
  s_waitcnt lgkmcnt(8)
  v_mfma_f32_32x32x16_bf16 a[64:79], v[68:71], v[140:143], a[64:79]
  ds_read_b64_tr_b16 v[48:49], v229 offset:5120
  ds_read_b64_tr_b16 v[50:51], v229 offset:6400
  s_waitcnt lgkmcnt(8)
  v_mfma_f32_32x32x16_bf16 a[160:175], v[72:75], v[140:143], a[160:175]
  ds_read_b64_tr_b16 v[52:53], v221 offset:10240
  ds_read_b64_tr_b16 v[54:55], v221 offset:11520
  s_waitcnt vmcnt(43) lgkmcnt(8)
  v_mfma_f32_32x32x16_bf16 a[0:15], v[76:79], v[144:147], a[0:15]
  ds_read_b64_tr_b16 v[56:57], v221 offset:10320
  ds_read_b64_tr_b16 v[58:59], v221 offset:11600
  s_waitcnt lgkmcnt(8)
  v_mfma_f32_32x32x16_bf16 a[32:47], v[40:43], v[144:147], a[32:47]
  ds_read_b64_tr_b16 v[60:61], v221 offset:10400
  ds_read_b64_tr_b16 v[62:63], v221 offset:11680
  buffer_load_dwordx4 a[56:59], v225, s[52:55], s73 offen offset:2048 sc1
  s_waitcnt lgkmcnt(8)
  v_mfma_f32_32x32x16_bf16 a[64:79], v[44:47], v[144:147], a[64:79]
  ds_read_b64_tr_b16 v[64:65], v229 offset:10240
  ds_read_b64_tr_b16 v[66:67], v229 offset:11520
  s_waitcnt lgkmcnt(8)
  v_mfma_f32_32x32x16_bf16 a[160:175], v[48:51], v[144:147], a[160:175]
  ds_read_b64_tr_b16 v[68:69], v221 offset:15360
  ds_read_b64_tr_b16 v[70:71], v221 offset:16640
  s_waitcnt vmcnt(40) lgkmcnt(8)
  v_mfma_f32_32x32x16_bf16 a[0:15], v[52:55], v[148:151], a[0:15]
  s_waitcnt vmcnt(22)
  s_barrier
  buffer_store_dword v255, v254, s[64:67], s69 offen sc1
  ds_read_b64_tr_b16 v[72:73], v221 offset:15440
  ds_read_b64_tr_b16 v[74:75], v221 offset:16720
  s_waitcnt lgkmcnt(8)
  v_mfma_f32_32x32x16_bf16 a[32:47], v[56:59], v[148:151], a[32:47]
  ds_read_b64_tr_b16 v[76:77], v221 offset:15520
  s_add_u32 s74, s88, 7
  s_and_b32 s74, s74, 7
  s_lshl2_add_u32 s74, s74, s7
  ds_read_b64_tr_b16 v[78:79], v221 offset:16800
  s_mul_i32 s74, s74, 163840
  s_add_u32 m0, s89, 122880
  s_nop 0
  buffer_load_dwordx4 v216, s[36:39], s74 offen lds
  buffer_load_dwordx4 a[60:63], v225, s[52:55], s73 offen offset:3072 sc1
  s_waitcnt lgkmcnt(8)
  v_mfma_f32_32x32x16_bf16 a[64:79], v[60:63], v[148:151], a[64:79]
  ds_read_b64_tr_b16 v[40:41], v229 offset:15360
  ds_read_b64_tr_b16 v[42:43], v229 offset:16640
  s_waitcnt lgkmcnt(8)
  v_mfma_f32_32x32x16_bf16 a[160:175], v[64:67], v[148:151], a[160:175]
  ds_read_b64_tr_b16 v[44:45], v221 offset:20480
  ds_read_b64_tr_b16 v[46:47], v221 offset:21760
  buffer_load_dwordx4 v217, s[36:39], s74 offen offset:1024 lds
  s_waitcnt lgkmcnt(8)
  v_mfma_f32_32x32x16_bf16 a[0:15], v[68:71], v[152:155], a[0:15]
  ds_read_b64_tr_b16 v[48:49], v221 offset:20560
  s_add_u32 s73, s88, 7
  s_and_b32 s73, s73, 7
  ds_read_b64_tr_b16 v[50:51], v221 offset:21840
  s_lshl2_add_u32 s73, s73, s7
  s_mul_i32 s73, s73, 8192
  buffer_load_dwordx4 a[80:83], v225, s[52:55], s73 offen sc1
  s_waitcnt lgkmcnt(7)
  v_mfma_f32_32x32x16_bf16 a[32:47], v[72:75], v[152:155], a[32:47]
  ds_read_b64_tr_b16 v[52:53], v221 offset:20640
  ds_read_b64_tr_b16 v[54:55], v221 offset:21920
  s_waitcnt lgkmcnt(8)
  v_mfma_f32_32x32x16_bf16 a[64:79], v[76:79], v[152:155], a[64:79]
  ds_read_b64_tr_b16 v[56:57], v229 offset:20480
  ds_read_b64_tr_b16 v[58:59], v229 offset:21760
  buffer_load_dwordx4 v218, s[36:39], s74 offen offset:2048 lds
  s_waitcnt lgkmcnt(8)
  v_mfma_f32_32x32x16_bf16 a[160:175], v[40:43], v[152:155], a[160:175]
  ds_read_b64_tr_b16 v[60:61], v221 offset:25600
  ds_read_b64_tr_b16 v[62:63], v221 offset:26880
  s_waitcnt lgkmcnt(8)
  v_mfma_f32_32x32x16_bf16 a[0:15], v[44:47], v[156:159], a[0:15]
  ds_read_b64_tr_b16 v[64:65], v221 offset:25680
  ds_read_b64_tr_b16 v[66:67], v221 offset:26960
  buffer_load_dwordx4 a[84:87], v225, s[52:55], s73 offen offset:1024 sc1
  s_waitcnt lgkmcnt(8)
  v_mfma_f32_32x32x16_bf16 a[32:47], v[48:51], v[156:159], a[32:47]
  ds_read_b64_tr_b16 v[68:69], v221 offset:25760
  ds_read_b64_tr_b16 v[70:71], v221 offset:27040
  buffer_load_dwordx4 v219, s[36:39], s74 offen offset:3072 lds
  s_waitcnt lgkmcnt(8)
  v_mfma_f32_32x32x16_bf16 a[64:79], v[52:55], v[156:159], a[64:79]
  ds_read_b64_tr_b16 v[72:73], v229 offset:25600
  ds_read_b64_tr_b16 v[74:75], v229 offset:26880
  s_waitcnt lgkmcnt(8)
  v_mfma_f32_32x32x16_bf16 a[160:175], v[56:59], v[156:159], a[160:175]
  ds_read_b64_tr_b16 v[76:77], v221 offset:30720
  ds_read_b64_tr_b16 v[78:79], v221 offset:32000
  s_waitcnt lgkmcnt(8)
  v_mfma_f32_32x32x16_bf16 a[0:15], v[60:63], v[160:163], a[0:15]
  ds_read_b64_tr_b16 v[40:41], v221 offset:30800
  s_add_u32 m0, s89, 126976
  ds_read_b64_tr_b16 v[42:43], v221 offset:32080
  buffer_load_dwordx4 v220, s[36:39], s74 offen lds
  buffer_load_dwordx4 a[88:91], v225, s[52:55], s73 offen offset:2048 sc1
  s_waitcnt lgkmcnt(8)
  v_mfma_f32_32x32x16_bf16 a[32:47], v[64:67], v[160:163], a[32:47]
  ds_read_b64_tr_b16 v[44:45], v221 offset:30880
  ds_read_b64_tr_b16 v[46:47], v221 offset:32160
  s_waitcnt lgkmcnt(8)
  v_mfma_f32_32x32x16_bf16 a[64:79], v[68:71], v[160:163], a[64:79]
  ds_read_b64_tr_b16 v[48:49], v229 offset:30720
  ds_read_b64_tr_b16 v[50:51], v229 offset:32000
  s_waitcnt lgkmcnt(8)
  v_mfma_f32_32x32x16_bf16 a[160:175], v[72:75], v[160:163], a[160:175]
  ds_read_b64_tr_b16 v[52:53], v221 offset:35840
  s_add_u32 s74, s74, 81920
  s_add_u32 m0, s89, 143360
  ds_read_b64_tr_b16 v[54:55], v221 offset:37120
  buffer_load_dwordx4 v216, s[36:39], s74 offen lds
  buffer_load_dwordx4 a[92:95], v225, s[52:55], s73 offen offset:3072 sc1
  s_waitcnt lgkmcnt(8)
  v_mfma_f32_32x32x16_bf16 a[0:15], v[76:79], v[164:167], a[0:15]
  ds_read_b64_tr_b16 v[56:57], v221 offset:35920
  ds_read_b64_tr_b16 v[58:59], v221 offset:37200
  s_waitcnt lgkmcnt(8)
  v_mfma_f32_32x32x16_bf16 a[32:47], v[40:43], v[164:167], a[32:47]
  ds_read_b64_tr_b16 v[60:61], v221 offset:36000
  ds_read_b64_tr_b16 v[62:63], v221 offset:37280
  s_waitcnt lgkmcnt(8)
  v_mfma_f32_32x32x16_bf16 a[64:79], v[44:47], v[164:167], a[64:79]
  ds_read_b64_tr_b16 v[64:65], v229 offset:35840
  ds_read_b64_tr_b16 v[66:67], v229 offset:37120
  buffer_load_dwordx4 v217, s[36:39], s74 offen offset:1024 lds
  s_waitcnt lgkmcnt(8)
  v_mfma_f32_32x32x16_bf16 a[160:175], v[48:51], v[164:167], a[160:175]
  ds_read_b64_tr_b16 v[68:69], v230 offset:0
  s_add_u32 s73, s73, 4096
  ds_read_b64_tr_b16 v[70:71], v230 offset:1280
  buffer_load_dwordx4 a[112:115], v225, s[52:55], s73 offen sc1
  s_waitcnt lgkmcnt(8)
  v_mfma_f32_32x32x16_bf16 a[0:15], v[52:55], v[168:171], a[0:15]
  ds_read_b64_tr_b16 v[72:73], v230 offset:5120
  ds_read_b64_tr_b16 v[74:75], v230 offset:6400
  s_waitcnt lgkmcnt(8)
  v_mfma_f32_32x32x16_bf16 a[32:47], v[56:59], v[168:171], a[32:47]
  ds_read_b64_tr_b16 v[76:77], v230 offset:10240
  ds_read_b64_tr_b16 v[78:79], v230 offset:11520
  buffer_load_dwordx4 v218, s[36:39], s74 offen offset:2048 lds
  s_waitcnt lgkmcnt(8)
  v_mfma_f32_32x32x16_bf16 a[64:79], v[60:63], v[168:171], a[64:79]
  ds_read_b64_tr_b16 v[40:41], v230 offset:15360
  ds_read_b64_tr_b16 v[42:43], v230 offset:16640
  s_waitcnt lgkmcnt(8)
  v_mfma_f32_32x32x16_bf16 a[160:175], v[64:67], v[168:171], a[160:175]
  ds_read_b64_tr_b16 v[44:45], v230 offset:20480
  ds_read_b64_tr_b16 v[46:47], v230 offset:21760
  buffer_load_dwordx4 a[116:119], v225, s[52:55], s73 offen offset:1024 sc1
  s_waitcnt lgkmcnt(8)
  v_mfma_f32_32x32x16_bf16 a[160:175], v[68:71], a[176:179], a[160:175]
  ds_read_b64_tr_b16 v[48:49], v230 offset:25600
  buffer_load_dwordx4 v219, s[36:39], s74 offen offset:3072 lds
  ds_read_b64_tr_b16 v[50:51], v230 offset:26880
  s_andn2_b32 s76, s69, 127
  buffer_load_dword v3, v228, s[64:67], s76 offen sc1
  s_waitcnt lgkmcnt(8)
  v_mfma_f32_32x32x16_bf16 a[160:175], v[72:75], a[180:183], a[160:175]
  ds_read_b64_tr_b16 v[52:53], v230 offset:30720
  ds_read_b64_tr_b16 v[54:55], v230 offset:32000
  s_waitcnt lgkmcnt(8)
  v_mfma_f32_32x32x16_bf16 a[160:175], v[76:79], a[184:187], a[160:175]
  ds_read_b64_tr_b16 v[56:57], v230 offset:35840
  buffer_load_dwordx4 a[120:123], v225, s[52:55], s73 offen offset:2048 sc1
  ds_read_b64_tr_b16 v[58:59], v230 offset:37120
  buffer_load_dwordx4 v[100:103], v227, s[48:51], s72 offen
  s_waitcnt vmcnt(41) lgkmcnt(8)
  v_mfma_f32_32x32x16_bf16 a[160:175], v[40:43], a[188:191], a[160:175]
  ds_read_b64_tr_b16 v[60:61], v222 offset:0
  s_add_u32 m0, s89, 147456
  ds_read_b64_tr_b16 v[62:63], v222 offset:1280
  buffer_load_dwordx4 v220, s[36:39], s74 offen lds
  s_waitcnt vmcnt(41) lgkmcnt(8)
  v_mfma_f32_32x32x16_bf16 a[160:175], v[44:47], a[240:243], a[160:175]
  ds_read_b64_tr_b16 v[64:65], v222 offset:5120
  ds_read_b64_tr_b16 v[66:67], v222 offset:6400
  buffer_load_dwordx4 v[104:107], v227, s[48:51], s72 offen offset:16
  s_waitcnt vmcnt(39) lgkmcnt(8)
  v_mfma_f32_32x32x16_bf16 a[160:175], v[48:51], a[244:247], a[160:175]
  ds_read_b64_tr_b16 v[68:69], v222 offset:10240
  ds_read_b64_tr_b16 v[70:71], v222 offset:11520
  s_waitcnt vmcnt(37) lgkmcnt(8)
  v_mfma_f32_32x32x16_bf16 a[160:175], v[52:55], a[248:251], a[160:175]
  ds_read_b64_tr_b16 v[72:73], v222 offset:15360
  buffer_load_dwordx4 a[124:127], v225, s[52:55], s73 offen offset:3072 sc1
  ds_read_b64_tr_b16 v[74:75], v222 offset:16640
  buffer_load_dwordx2 v[108:109], v9, s[48:51], s72 offen
  s_waitcnt vmcnt(37) lgkmcnt(8)
  v_mfma_f32_32x32x16_bf16 a[160:175], v[56:59], a[252:255], a[160:175]
  ds_read_b64_tr_b16 v[76:77], v222 offset:20480
  ds_read_b64_tr_b16 v[78:79], v222 offset:21760
  s_waitcnt lgkmcnt(8)
  v_mfma_f32_32x32x16_bf16 a[0:15], v[60:63], a[176:179], a[0:15]
  ds_read_b64_tr_b16 v[40:41], v222 offset:25600
  ds_read_b64_tr_b16 v[42:43], v222 offset:26880
  s_waitcnt lgkmcnt(8)
  v_mfma_f32_32x32x16_bf16 a[0:15], v[64:67], a[180:183], a[0:15]
  ds_read_b64_tr_b16 v[44:45], v222 offset:30720
  ds_read_b64_tr_b16 v[46:47], v222 offset:32000
  s_waitcnt lgkmcnt(8)
  v_mfma_f32_32x32x16_bf16 a[0:15], v[68:71], a[184:187], a[0:15]
  ds_read_b64_tr_b16 v[48:49], v222 offset:35840
  ds_read_b64_tr_b16 v[50:51], v222 offset:37120
  s_waitcnt lgkmcnt(8)
  v_mfma_f32_32x32x16_bf16 a[0:15], v[72:75], a[188:191], a[0:15]
  ds_read_b64_tr_b16 v[52:53], v222 offset:80
  ds_read_b64_tr_b16 v[54:55], v222 offset:1360
  s_waitcnt lgkmcnt(8)
  v_mfma_f32_32x32x16_bf16 a[0:15], v[76:79], a[240:243], a[0:15]
  ds_read_b64_tr_b16 v[56:57], v222 offset:5200
  ds_read_b64_tr_b16 v[58:59], v222 offset:6480
  s_waitcnt lgkmcnt(8)
  v_mfma_f32_32x32x16_bf16 a[0:15], v[40:43], a[244:247], a[0:15]
  ds_read_b64_tr_b16 v[60:61], v222 offset:10320
  ds_read_b64_tr_b16 v[62:63], v222 offset:11600
  s_waitcnt lgkmcnt(8)
  v_mfma_f32_32x32x16_bf16 a[0:15], v[44:47], a[248:251], a[0:15]
  ds_read_b64_tr_b16 v[64:65], v222 offset:15440
  ds_read_b64_tr_b16 v[66:67], v222 offset:16720
  s_waitcnt lgkmcnt(8)
  v_mfma_f32_32x32x16_bf16 a[0:15], v[48:51], a[252:255], a[0:15]
  ds_read_b64_tr_b16 v[68:69], v222 offset:20560
  ds_read_b64_tr_b16 v[70:71], v222 offset:21840
  s_waitcnt lgkmcnt(8)
  v_mfma_f32_32x32x16_bf16 a[32:47], v[52:55], a[176:179], a[32:47]
  s_waitcnt vmcnt(27)
  s_barrier
  ds_read_b64_tr_b16 v[72:73], v222 offset:25680
  ds_read_b64_tr_b16 v[74:75], v222 offset:26960
  s_waitcnt lgkmcnt(8)
  v_mfma_f32_32x32x16_bf16 a[32:47], v[56:59], a[180:183], a[32:47]
  ds_read_b64_tr_b16 v[76:77], v222 offset:30800
  ds_read_b64_tr_b16 v[78:79], v222 offset:32080
  s_waitcnt lgkmcnt(8)
  v_mfma_f32_32x32x16_bf16 a[32:47], v[60:63], a[184:187], a[32:47]
  ds_read_b64_tr_b16 v[40:41], v222 offset:35920
  ds_read_b64_tr_b16 v[42:43], v222 offset:37200
  s_waitcnt lgkmcnt(8)
  v_mfma_f32_32x32x16_bf16 a[32:47], v[64:67], a[188:191], a[32:47]
  ds_read_b64_tr_b16 v[44:45], v231 offset:0
  ds_read_b64_tr_b16 v[46:47], v231 offset:1280
  s_waitcnt lgkmcnt(8)
  v_mfma_f32_32x32x16_bf16 a[32:47], v[68:71], a[240:243], a[32:47]
  s_waitcnt vmcnt(6)
  v_cmp_ne_u32 vcc, 0, v3
  s_nop 1
  s_and_b32 s82, vcc_lo, 15
  s_cmp_eq_u32 s82, 15
  s_cbranch_scc0 L_spinD
L_backD:
  ds_read_b64_tr_b16 v[48:49], v231 offset:5120
  s_add_u32 s83, s23, 0
  ds_read_b64_tr_b16 v[50:51], v231 offset:6400
  buffer_load_dwordx4 v[172:175], v226, s[64:67], s83 offen sc1
  s_waitcnt lgkmcnt(8)
  v_mfma_f32_32x32x16_bf16 a[32:47], v[72:75], a[244:247], a[32:47]
  ds_read_b64_tr_b16 v[52:53], v231 offset:10240
  ds_read_b64_tr_b16 v[54:55], v231 offset:11520
  buffer_load_dwordx4 v[176:179], v226, s[64:67], s83 offen offset:1024 sc1
  s_waitcnt lgkmcnt(8)
  v_mfma_f32_32x32x16_bf16 a[32:47], v[76:79], a[248:251], a[32:47]
  ds_read_b64_tr_b16 v[56:57], v231 offset:15360
  ds_read_b64_tr_b16 v[58:59], v231 offset:16640
  buffer_load_dwordx4 v[180:183], v226, s[64:67], s83 offen offset:2048 sc1
  s_waitcnt lgkmcnt(8)
  v_mfma_f32_32x32x16_bf16 a[32:47], v[40:43], a[252:255], a[32:47]
  ds_read_b64_tr_b16 v[60:61], v231 offset:20480
  s_add_u32 s83, s23, 12288
  ds_read_b64_tr_b16 v[62:63], v231 offset:21760
  buffer_load_dwordx4 v[184:187], v226, s[64:67], s83 offen sc1
  s_waitcnt lgkmcnt(8)
  v_mfma_f32_32x32x16_bf16 a[160:175], v[44:47], a[16:19], a[160:175]
  ds_read_b64_tr_b16 v[64:65], v231 offset:25600
  ds_read_b64_tr_b16 v[66:67], v231 offset:26880
  buffer_load_dwordx4 v[188:191], v226, s[64:67], s83 offen offset:1024 sc1
  s_waitcnt lgkmcnt(8)
  v_mfma_f32_32x32x16_bf16 a[160:175], v[48:51], a[20:23], a[160:175]
  ds_read_b64_tr_b16 v[68:69], v231 offset:30720
  ds_read_b64_tr_b16 v[70:71], v231 offset:32000
  buffer_load_dwordx4 v[192:195], v226, s[64:67], s83 offen offset:2048 sc1
  s_waitcnt lgkmcnt(8)
  v_mfma_f32_32x32x16_bf16 a[160:175], v[52:55], a[24:27], a[160:175]
  ds_read_b64_tr_b16 v[72:73], v231 offset:35840
  s_add_u32 s83, s23, 24576
  ds_read_b64_tr_b16 v[74:75], v231 offset:37120
  buffer_load_dwordx4 v[196:199], v226, s[64:67], s83 offen sc1
  s_waitcnt lgkmcnt(8)
  v_mfma_f32_32x32x16_bf16 a[160:175], v[56:59], a[28:31], a[160:175]
  ds_read_b64_tr_b16 v[76:77], v223 offset:0
  ds_read_b64_tr_b16 v[78:79], v223 offset:1280
  buffer_load_dwordx4 v[200:203], v226, s[64:67], s83 offen offset:1024 sc1
  s_waitcnt lgkmcnt(8)
  v_mfma_f32_32x32x16_bf16 a[160:175], v[60:63], a[48:51], a[160:175]
  ds_read_b64_tr_b16 v[40:41], v223 offset:5120
  ds_read_b64_tr_b16 v[42:43], v223 offset:6400
  buffer_load_dwordx4 v[204:207], v226, s[64:67], s83 offen offset:2048 sc1
  s_waitcnt lgkmcnt(8)
  v_mfma_f32_32x32x16_bf16 a[160:175], v[64:67], a[52:55], a[160:175]
  ds_read_b64_tr_b16 v[44:45], v223 offset:10240
  ds_read_b64_tr_b16 v[46:47], v223 offset:11520
  s_waitcnt lgkmcnt(8)
  v_mfma_f32_32x32x16_bf16 a[160:175], v[68:71], a[56:59], a[160:175]
  ds_read_b64_tr_b16 v[48:49], v223 offset:15360
  ds_read_b64_tr_b16 v[50:51], v223 offset:16640
  s_waitcnt lgkmcnt(8)
  v_mfma_f32_32x32x16_bf16 a[160:175], v[72:75], a[60:63], a[160:175]
  ds_read_b64_tr_b16 v[52:53], v223 offset:20480
  ds_read_b64_tr_b16 v[54:55], v223 offset:21760
  s_waitcnt lgkmcnt(8)
  v_mfma_f32_32x32x16_bf16 a[0:15], v[76:79], a[16:19], a[0:15]
  ds_read_b64_tr_b16 v[56:57], v223 offset:25600
  ds_read_b64_tr_b16 v[58:59], v223 offset:26880
  s_waitcnt lgkmcnt(8)
  v_mfma_f32_32x32x16_bf16 a[0:15], v[40:43], a[20:23], a[0:15]
  ds_read_b64_tr_b16 v[60:61], v223 offset:30720
  ds_read_b64_tr_b16 v[62:63], v223 offset:32000
  s_waitcnt lgkmcnt(8)
  v_mfma_f32_32x32x16_bf16 a[0:15], v[44:47], a[24:27], a[0:15]
  s_waitcnt vmcnt(12)
  s_barrier
  ds_read_b64_tr_b16 v[64:65], v223 offset:35840
  ds_read_b64_tr_b16 v[66:67], v223 offset:37120
  s_waitcnt lgkmcnt(8)
  v_mfma_f32_32x32x16_bf16 a[0:15], v[48:51], a[28:31], a[0:15]
  ds_read_b64_tr_b16 v[68:69], v8 offset:0
  ds_read_b64_tr_b16 v[70:71], v8 offset:1280
  s_waitcnt lgkmcnt(8)
  v_mfma_f32_32x32x16_bf16 a[0:15], v[52:55], a[48:51], a[0:15]
  ds_read_b64_tr_b16 v[72:73], v8 offset:5120
  ds_read_b64_tr_b16 v[74:75], v8 offset:6400
  s_waitcnt lgkmcnt(8)
  v_mfma_f32_32x32x16_bf16 a[0:15], v[56:59], a[52:55], a[0:15]
  ds_read_b64_tr_b16 v[76:77], v8 offset:10240
  ds_read_b64_tr_b16 v[78:79], v8 offset:11520
  s_waitcnt lgkmcnt(8)
  v_mfma_f32_32x32x16_bf16 a[0:15], v[60:63], a[56:59], a[0:15]
  ds_read_b64_tr_b16 v[40:41], v8 offset:15360
  ds_read_b64_tr_b16 v[42:43], v8 offset:16640
  s_waitcnt lgkmcnt(8)
  v_mfma_f32_32x32x16_bf16 a[0:15], v[64:67], a[60:63], a[0:15]
  ds_read_b64_tr_b16 v[44:45], v8 offset:20480
  ds_read_b64_tr_b16 v[46:47], v8 offset:21760
  s_waitcnt lgkmcnt(8)
  v_mfma_f32_32x32x16_bf16 a[160:175], v[68:71], a[80:83], a[160:175]
  ds_read_b64_tr_b16 v[48:49], v8 offset:25600
  ds_read_b64_tr_b16 v[50:51], v8 offset:26880
  buffer_load_dword v3, v254, s[56:59], s72 offen
  s_waitcnt lgkmcnt(8)
  v_mfma_f32_32x32x16_bf16 a[160:175], v[72:75], a[84:87], a[160:175]
  ds_read_b64_tr_b16 v[52:53], v8 offset:30720
  ds_read_b64_tr_b16 v[54:55], v8 offset:32000
  s_waitcnt lgkmcnt(8)
  v_mfma_f32_32x32x16_bf16 a[160:175], v[76:79], a[88:91], a[160:175]
  ds_read_b64_tr_b16 v[56:57], v8 offset:35840
  ds_read_b64_tr_b16 v[58:59], v8 offset:37120
  s_waitcnt lgkmcnt(8)
  v_mfma_f32_32x32x16_bf16 a[160:175], v[40:43], a[92:95], a[160:175]
  ds_read_b64_tr_b16 v[60:61], v224 offset:0
  ds_read_b64_tr_b16 v[62:63], v224 offset:1280
  s_waitcnt lgkmcnt(8)
  v_mfma_f32_32x32x16_bf16 a[160:175], v[44:47], a[112:115], a[160:175]
  ds_read_b64_tr_b16 v[64:65], v224 offset:5120
  ds_read_b64_tr_b16 v[66:67], v224 offset:6400
  s_waitcnt lgkmcnt(8)
  v_mfma_f32_32x32x16_bf16 a[160:175], v[48:51], a[116:119], a[160:175]
  ds_read_b64_tr_b16 v[68:69], v224 offset:10240
  ds_read_b64_tr_b16 v[70:71], v224 offset:11520
  s_waitcnt lgkmcnt(8)
  v_mfma_f32_32x32x16_bf16 a[160:175], v[52:55], a[120:123], a[160:175]
  ds_read_b64_tr_b16 v[72:73], v224 offset:15360
  ds_read_b64_tr_b16 v[74:75], v224 offset:16640
  s_waitcnt vmcnt(11) lgkmcnt(8)
  v_mfma_f32_32x32x16_bf16 a[160:175], v[56:59], a[124:127], a[160:175]
  ds_read_b64_tr_b16 v[76:77], v224 offset:20480
  ds_read_b64_tr_b16 v[78:79], v224 offset:21760
  s_waitcnt lgkmcnt(8)
  v_mfma_f32_32x32x16_bf16 a[0:15], v[60:63], a[80:83], a[0:15]
  ds_read_b64_tr_b16 v[40:41], v224 offset:25600
  ds_read_b64_tr_b16 v[42:43], v224 offset:26880
  s_waitcnt lgkmcnt(8)
  v_mfma_f32_32x32x16_bf16 a[0:15], v[64:67], a[84:87], a[0:15]
  ds_read_b64_tr_b16 v[44:45], v224 offset:30720
  ds_read_b64_tr_b16 v[46:47], v224 offset:32000
  s_nop 1
  buffer_store_dwordx4 a[160:163], v226, s[64:67], s20 offen offset:2048 sc1
  s_waitcnt lgkmcnt(8)
  v_mfma_f32_32x32x16_bf16 a[0:15], v[68:71], a[88:91], a[0:15]
  ds_read_b64_tr_b16 v[48:49], v224 offset:35840
  ds_read_b64_tr_b16 v[50:51], v224 offset:37120
  s_waitcnt lgkmcnt(8)
  v_mfma_f32_32x32x16_bf16 a[0:15], v[72:75], a[92:95], a[0:15]
  ds_read_b64_tr_b16 v[52:53], v223 offset:80
  ds_read_b64_tr_b16 v[54:55], v223 offset:1360
  buffer_store_dwordx4 a[164:167], v226, s[64:67], s21 offen offset:2048 sc1
  s_waitcnt lgkmcnt(8)
  v_mfma_f32_32x32x16_bf16 a[0:15], v[76:79], a[112:115], a[0:15]
  ds_read_b64_tr_b16 v[56:57], v223 offset:5200
  ds_read_b64_tr_b16 v[58:59], v223 offset:6480
  s_waitcnt lgkmcnt(8)
  v_mfma_f32_32x32x16_bf16 a[0:15], v[40:43], a[116:119], a[0:15]
  ds_read_b64_tr_b16 v[60:61], v223 offset:10320
  ds_read_b64_tr_b16 v[62:63], v223 offset:11600
  buffer_store_dwordx4 a[168:171], v226, s[64:67], s22 offen offset:2048 sc1
  s_waitcnt lgkmcnt(8)
  v_mfma_f32_32x32x16_bf16 a[0:15], v[44:47], a[120:123], a[0:15]
  ds_read_b64_tr_b16 v[64:65], v223 offset:15440
  ds_read_b64_tr_b16 v[66:67], v223 offset:16720
  s_waitcnt lgkmcnt(8)
  v_mfma_f32_32x32x16_bf16 a[0:15], v[48:51], a[124:127], a[0:15]
  ds_read_b64_tr_b16 v[68:69], v223 offset:20560
  ds_read_b64_tr_b16 v[70:71], v223 offset:21840
  s_waitcnt lgkmcnt(8)
  v_mfma_f32_32x32x16_bf16 a[32:47], v[52:55], a[16:19], a[32:47]
  ds_read_b64_tr_b16 v[72:73], v223 offset:25680
  ds_read_b64_tr_b16 v[74:75], v223 offset:26960
  s_waitcnt lgkmcnt(8)
  v_mfma_f32_32x32x16_bf16 a[32:47], v[56:59], a[20:23], a[32:47]
  ds_read_b64_tr_b16 v[76:77], v223 offset:30800
  ds_read_b64_tr_b16 v[78:79], v223 offset:32080
  s_nop 1
  v_accvgpr_read_b32 v232, a0
  v_accvgpr_read_b32 v233, a1
  v_accvgpr_read_b32 v234, a2
  v_accvgpr_read_b32 v235, a3
  v_accvgpr_read_b32 v236, a4
  v_accvgpr_read_b32 v237, a5
  s_waitcnt lgkmcnt(8)
  v_mfma_f32_32x32x16_bf16 a[32:47], v[60:63], a[24:27], a[32:47]
  ds_read_b64_tr_b16 v[40:41], v223 offset:35920
  ds_read_b64_tr_b16 v[42:43], v223 offset:37200
  v_accvgpr_read_b32 v238, a6
  v_accvgpr_read_b32 v239, a7
  v_cvt_pk_bf16_f32 v112, v232, v233
  v_cvt_pk_bf16_f32 v113, v234, v235
  v_cvt_pk_bf16_f32 v114, v236, v237
  v_accvgpr_read_b32 v80, a208
  v_accvgpr_read_b32 v81, a209
  v_accvgpr_read_b32 v82, a210
  v_accvgpr_read_b32 v83, a211
  s_waitcnt lgkmcnt(6)
  v_mfma_f32_32x32x16_bf16 a[32:47], v[64:67], a[28:31], a[32:47]
  ds_read_b64_tr_b16 v[44:45], v224 offset:80
  v_cvt_pk_bf16_f32 v115, v238, v239
  v_accvgpr_read_b32 v240, a8
  v_accvgpr_read_b32 v241, a9
  v_accvgpr_read_b32 v242, a10
  v_accvgpr_read_b32 v84, a212
  v_accvgpr_read_b32 v85, a213
  v_accvgpr_read_b32 v86, a214
  v_mfma_f32_32x32x16_bf16 a[32:47], v[68:71], a[48:51], a[32:47]
  buffer_store_dwordx4 v[112:115], v226, s[64:67], s20 offen sc1
  ds_read_b64_tr_b16 v[46:47], v224 offset:1360
  ds_read_b64_tr_b16 v[48:49], v224 offset:5200
  ds_read_b64_tr_b16 v[50:51], v224 offset:6480
  v_accvgpr_read_b32 v243, a11
  v_accvgpr_read_b32 v244, a12
  v_accvgpr_read_b32 v245, a13
  v_accvgpr_read_b32 v246, a14
  v_accvgpr_read_b32 v247, a15
  v_accvgpr_read_b32 v87, a215
  v_accvgpr_read_b32 v88, a216
  v_accvgpr_read_b32 v89, a217
  v_accvgpr_read_b32 v90, a218
  s_waitcnt lgkmcnt(4)
  v_mfma_f32_32x32x16_bf16 a[32:47], v[72:75], a[52:55], a[32:47]
  ds_read_b64_tr_b16 v[52:53], v224 offset:10320
  ds_read_b64_tr_b16 v[54:55], v224 offset:11600
  v_cvt_pk_bf16_f32 v116, v240, v241
  v_cvt_pk_bf16_f32 v117, v242, v243
  v_cvt_pk_bf16_f32 v118, v244, v245
  v_cvt_pk_bf16_f32 v119, v246, v247
  v_accvgpr_read_b32 v91, a219
  v_accvgpr_read_b32 v92, a220
  v_accvgpr_read_b32 v93, a221
  v_mfma_f32_32x32x16_bf16 a[32:47], v[76:79], a[56:59], a[32:47]
  buffer_store_dwordx4 v[116:119], v226, s[64:67], s20 offen offset:1024 sc1
  ds_read_b64_tr_b16 v[56:57], v224 offset:15440
  ds_read_b64_tr_b16 v[58:59], v224 offset:16720
  v_accvgpr_read_b32 v94, a222
  v_accvgpr_read_b32 v95, a223
  v_accvgpr_read_b32 v96, a236
  v_mfma_f32_32x32x16_bf16 a[32:47], v[40:43], a[60:63], a[32:47]
  ds_read_b64_tr_b16 v[60:61], v224 offset:20560
  ds_read_b64_tr_b16 v[62:63], v224 offset:21840
  v_accvgpr_read_b32 v97, a237
  v_accvgpr_read_b32 v98, a238
  v_accvgpr_read_b32 v99, a239
  s_waitcnt vmcnt(14)
  v_lshlrev_b32 v12, 16, v172
  s_waitcnt lgkmcnt(6)
  v_mfma_f32_32x32x16_bf16 a[32:47], v[44:47], a[80:83], a[32:47]
  ds_read_b64_tr_b16 v[64:65], v224 offset:25680
  ds_read_b64_tr_b16 v[66:67], v224 offset:26960
  v_lshlrev_b32 v13, 16, v173
  v_lshlrev_b32 v14, 16, v174
  v_lshlrev_b32 v15, 16, v175
  v_mfma_f32_32x32x16_bf16 a[32:47], v[48:51], a[84:87], a[32:47]
  ds_read_b64_tr_b16 v[68:69], v224 offset:30800
  ds_read_b64_tr_b16 v[70:71], v224 offset:32080
  v_and_b32 v172, s80, v172
  v_and_b32 v173, s80, v173
  v_and_b32 v174, s80, v174
  s_waitcnt lgkmcnt(8)
  v_mfma_f32_32x32x16_bf16 a[32:47], v[52:55], a[88:91], a[32:47]
  ds_read_b64_tr_b16 v[72:73], v224 offset:35920
  ds_read_b64_tr_b16 v[74:75], v224 offset:37200
  v_and_b32 v175, s80, v175
  v_add_f32 v80, v80, v12
  v_add_f32 v82, v82, v13
  v_add_f32 v84, v84, v14
  s_waitcnt lgkmcnt(7)
  v_mfma_f32_32x32x16_bf16 a[32:47], v[56:59], a[92:95], a[32:47]
  ds_read_b64_tr_b16 v[76:77], v222 offset:160
  ds_read_b64_tr_b16 v[78:79], v222 offset:1440
  v_add_f32 v86, v86, v15
  v_add_f32 v81, v81, v172
  v_add_f32 v83, v83, v173
  s_waitcnt lgkmcnt(8)
  v_mfma_f32_32x32x16_bf16 a[32:47], v[60:63], a[112:115], a[32:47]
  ds_read_b64_tr_b16 v[40:41], v222 offset:5280
  ds_read_b64_tr_b16 v[42:43], v222 offset:6560
  v_add_f32 v85, v85, v174
  v_add_f32 v87, v87, v175
  s_waitcnt vmcnt(13)
  v_lshlrev_b32 v12, 16, v176
  s_waitcnt lgkmcnt(7)
  v_mfma_f32_32x32x16_bf16 a[32:47], v[64:67], a[116:119], a[32:47]
  ds_read_b64_tr_b16 v[44:45], v222 offset:10400
  ds_read_b64_tr_b16 v[46:47], v222 offset:11680
  v_lshlrev_b32 v13, 16, v177
  v_lshlrev_b32 v14, 16, v178
  v_lshlrev_b32 v15, 16, v179
  v_and_b32 v176, s80, v176
  s_waitcnt lgkmcnt(6)
  v_mfma_f32_32x32x16_bf16 a[32:47], v[68:71], a[120:123], a[32:47]
  ds_read_b64_tr_b16 v[48:49], v222 offset:15520
  ds_read_b64_tr_b16 v[50:51], v222 offset:16800
  v_and_b32 v177, s80, v177
  v_and_b32 v178, s80, v178
  v_and_b32 v179, s80, v179
  v_mfma_f32_32x32x16_bf16 a[32:47], v[72:75], a[124:127], a[32:47]
  ds_read_b64_tr_b16 v[52:53], v222 offset:20640
  ds_read_b64_tr_b16 v[54:55], v222 offset:21920
  v_add_f32 v88, v88, v12
  v_add_f32 v90, v90, v13
  v_add_f32 v92, v92, v14
  s_waitcnt lgkmcnt(8)
  v_mfma_f32_32x32x16_bf16 a[64:79], v[76:79], a[176:179], a[64:79]
  ds_read_b64_tr_b16 v[56:57], v222 offset:25760
  ds_read_b64_tr_b16 v[58:59], v222 offset:27040
  v_add_f32 v94, v94, v15
  v_add_f32 v89, v89, v176
  v_add_f32 v91, v91, v177
  v_add_f32 v93, v93, v178
  s_waitcnt lgkmcnt(8)
  v_mfma_f32_32x32x16_bf16 a[64:79], v[40:43], a[180:183], a[64:79]
  ds_read_b64_tr_b16 v[60:61], v222 offset:30880
  ds_read_b64_tr_b16 v[62:63], v222 offset:32160
  v_accvgpr_read_b32 v232, a32
  v_accvgpr_read_b32 v233, a33
  v_accvgpr_read_b32 v234, a34
  v_accvgpr_read_b32 v235, a35
  v_accvgpr_read_b32 v236, a36
  v_accvgpr_read_b32 v237, a37
  v_add_f32 v95, v95, v179
  s_waitcnt vmcnt(12)
  v_add_f32 v96, v96, v180
  v_add_f32 v97, v97, v181
  s_waitcnt lgkmcnt(6)
  v_mfma_f32_32x32x16_bf16 a[64:79], v[44:47], a[184:187], a[64:79]
  ds_read_b64_tr_b16 v[64:65], v222 offset:36000
  ds_read_b64_tr_b16 v[66:67], v222 offset:37280
  v_accvgpr_read_b32 v238, a38
  v_accvgpr_read_b32 v239, a39
  v_cvt_pk_bf16_f32 v120, v232, v233
  v_cvt_pk_bf16_f32 v121, v234, v235
  v_cvt_pk_bf16_f32 v122, v236, v237
  v_add_f32 v98, v98, v182
  v_add_f32 v99, v99, v183
  s_waitcnt vmcnt(11)
  v_lshlrev_b32 v12, 16, v184
  v_mfma_f32_32x32x16_bf16 a[64:79], v[48:51], a[188:191], a[64:79]
  ds_read_b64_tr_b16 v[68:69], v223 offset:160
  v_cvt_pk_bf16_f32 v123, v238, v239
  v_accvgpr_read_b32 v240, a40
  v_accvgpr_read_b32 v241, a41
  v_accvgpr_read_b32 v242, a42
  v_lshlrev_b32 v13, 16, v185
  v_lshlrev_b32 v14, 16, v186
  v_lshlrev_b32 v15, 16, v187
  v_and_b32 v184, s80, v184
  s_waitcnt lgkmcnt(3)
  v_mfma_f32_32x32x16_bf16 a[64:79], v[52:55], a[240:243], a[64:79]
  buffer_store_dwordx4 v[120:123], v226, s[64:67], s21 offen sc1
  ds_read_b64_tr_b16 v[70:71], v223 offset:1440
  ds_read_b64_tr_b16 v[72:73], v223 offset:5280
  ds_read_b64_tr_b16 v[74:75], v223 offset:6560
  v_accvgpr_read_b32 v243, a43
  v_accvgpr_read_b32 v244, a44
  v_accvgpr_read_b32 v245, a45
  v_accvgpr_read_b32 v246, a46
  v_accvgpr_read_b32 v247, a47
  v_and_b32 v185, s80, v185
  v_and_b32 v186, s80, v186
  v_and_b32 v187, s80, v187
  v_mfma_f32_32x32x16_bf16 a[64:79], v[56:59], a[244:247], a[64:79]
  ds_read_b64_tr_b16 v[76:77], v223 offset:10400
  ds_read_b64_tr_b16 v[78:79], v223 offset:11680
  v_cvt_pk_bf16_f32 v124, v240, v241
  v_cvt_pk_bf16_f32 v125, v242, v243
  v_cvt_pk_bf16_f32 v126, v244, v245
  v_cvt_pk_bf16_f32 v127, v246, v247
  v_add_f32 v80, v80, v12
  v_add_f32 v82, v82, v13
  v_add_f32 v84, v84, v14
  v_add_f32 v86, v86, v15
  v_mfma_f32_32x32x16_bf16 a[64:79], v[60:63], a[248:251], a[64:79]
  buffer_store_dwordx4 v[124:127], v226, s[64:67], s21 offen offset:1024 sc1
  ds_read_b64_tr_b16 v[40:41], v223 offset:15520
  ds_read_b64_tr_b16 v[42:43], v223 offset:16800
  v_add_f32 v81, v81, v184
  v_add_f32 v83, v83, v185
  v_add_f32 v85, v85, v186
  s_waitcnt lgkmcnt(5)
  v_mfma_f32_32x32x16_bf16 a[64:79], v[64:67], a[252:255], a[64:79]
  ds_read_b64_tr_b16 v[44:45], v223 offset:20640
  ds_read_b64_tr_b16 v[46:47], v223 offset:21920
  v_add_f32 v87, v87, v187
  s_waitcnt vmcnt(12)
  v_lshlrev_b32 v12, 16, v188
  v_lshlrev_b32 v13, 16, v189
  v_mfma_f32_32x32x16_bf16 a[64:79], v[68:71], a[16:19], a[64:79]
  ds_read_b64_tr_b16 v[48:49], v223 offset:25760
  ds_read_b64_tr_b16 v[50:51], v223 offset:27040
  v_lshlrev_b32 v14, 16, v190
  v_lshlrev_b32 v15, 16, v191
  v_and_b32 v188, s80, v188
  v_and_b32 v189, s80, v189
  s_waitcnt lgkmcnt(6)
  v_mfma_f32_32x32x16_bf16 a[64:79], v[72:75], a[20:23], a[64:79]
  ds_read_b64_tr_b16 v[52:53], v223 offset:30880
  ds_read_b64_tr_b16 v[54:55], v223 offset:32160
  v_and_b32 v190, s80, v190
  v_and_b32 v191, s80, v191
  v_add_f32 v88, v88, v12
  v_mfma_f32_32x32x16_bf16 a[64:79], v[76:79], a[24:27], a[64:79]
  ds_read_b64_tr_b16 v[56:57], v223 offset:36000
  ds_read_b64_tr_b16 v[58:59], v223 offset:37280
  v_add_f32 v90, v90, v13
  v_add_f32 v92, v92, v14
  v_add_f32 v94, v94, v15
  s_waitcnt lgkmcnt(8)
  v_mfma_f32_32x32x16_bf16 a[64:79], v[40:43], a[28:31], a[64:79]
  ds_read_b64_tr_b16 v[60:61], v224 offset:160
  ds_read_b64_tr_b16 v[62:63], v224 offset:1440
  v_add_f32 v89, v89, v188
  v_add_f32 v91, v91, v189
  v_add_f32 v93, v93, v190
  v_add_f32 v95, v95, v191
  s_waitcnt lgkmcnt(8)
  v_mfma_f32_32x32x16_bf16 a[64:79], v[44:47], a[48:51], a[64:79]
  ds_read_b64_tr_b16 v[64:65], v224 offset:5280
  ds_read_b64_tr_b16 v[66:67], v224 offset:6560
  s_waitcnt vmcnt(11)
  v_add_f32 v96, v96, v192
  v_add_f32 v97, v97, v193
  v_add_f32 v98, v98, v194
  s_waitcnt lgkmcnt(8)
  v_mfma_f32_32x32x16_bf16 a[64:79], v[48:51], a[52:55], a[64:79]
  ds_read_b64_tr_b16 v[68:69], v224 offset:10400
  ds_read_b64_tr_b16 v[70:71], v224 offset:11680
  v_add_f32 v99, v99, v195
  s_waitcnt vmcnt(10)
  v_lshlrev_b32 v12, 16, v196
  v_lshlrev_b32 v13, 16, v197
  s_waitcnt lgkmcnt(6)
  v_mfma_f32_32x32x16_bf16 a[64:79], v[52:55], a[56:59], a[64:79]
  ds_read_b64_tr_b16 v[72:73], v224 offset:15520
  ds_read_b64_tr_b16 v[74:75], v224 offset:16800
  v_lshlrev_b32 v14, 16, v198
  v_lshlrev_b32 v15, 16, v199
  v_and_b32 v196, s80, v196
  v_and_b32 v197, s80, v197
  v_mfma_f32_32x32x16_bf16 a[64:79], v[56:59], a[60:63], a[64:79]
  ds_read_b64_tr_b16 v[76:77], v224 offset:20640
  ds_read_b64_tr_b16 v[78:79], v224 offset:21920
  v_and_b32 v198, s80, v198
  v_and_b32 v199, s80, v199
  v_add_f32 v80, v80, v12
  s_waitcnt lgkmcnt(7)
  v_mfma_f32_32x32x16_bf16 a[64:79], v[60:63], a[80:83], a[64:79]
  ds_read_b64_tr_b16 v[40:41], v224 offset:25760
  ds_read_b64_tr_b16 v[42:43], v224 offset:27040
  v_add_f32 v82, v82, v13
  v_add_f32 v84, v84, v14
  v_add_f32 v86, v86, v15
  s_waitcnt lgkmcnt(8)
  v_mfma_f32_32x32x16_bf16 a[64:79], v[64:67], a[84:87], a[64:79]
  ds_read_b64_tr_b16 v[44:45], v224 offset:30880
  ds_read_b64_tr_b16 v[46:47], v224 offset:32160
  v_add_f32 v81, v81, v196
  v_add_f32 v83, v83, v197
  v_add_f32 v85, v85, v198
  v_add_f32 v87, v87, v199
  s_waitcnt lgkmcnt(8)
  v_mfma_f32_32x32x16_bf16 a[64:79], v[68:71], a[88:91], a[64:79]
  ds_read_b64_tr_b16 v[48:49], v224 offset:36000
  ds_read_b64_tr_b16 v[50:51], v224 offset:37280
  s_waitcnt vmcnt(9)
  v_lshlrev_b32 v12, 16, v200
  v_lshlrev_b32 v13, 16, v201
  v_lshlrev_b32 v14, 16, v202
  s_waitcnt lgkmcnt(7)
  v_mfma_f32_32x32x16_bf16 a[64:79], v[72:75], a[92:95], a[64:79]
  ds_read_b64_tr_b16 v[52:53], v221 offset:240
  ds_read_b64_tr_b16 v[54:55], v221 offset:1520
  v_lshlrev_b32 v15, 16, v203
  v_and_b32 v200, s80, v200
  v_and_b32 v201, s80, v201
  s_waitcnt lgkmcnt(7)
  v_mfma_f32_32x32x16_bf16 a[64:79], v[76:79], a[112:115], a[64:79]
  ds_read_b64_tr_b16 v[56:57], v221 offset:5360
  ds_read_b64_tr_b16 v[58:59], v221 offset:6640
  v_and_b32 v202, s80, v202
  v_and_b32 v203, s80, v203
  v_add_f32 v88, v88, v12
  v_add_f32 v90, v90, v13
  s_waitcnt lgkmcnt(6)
  v_mfma_f32_32x32x16_bf16 a[64:79], v[40:43], a[116:119], a[64:79]
  ds_read_b64_tr_b16 v[60:61], v221 offset:10480
  ds_read_b64_tr_b16 v[62:63], v221 offset:11760
  v_add_f32 v92, v92, v14
  v_add_f32 v94, v94, v15
  v_add_f32 v89, v89, v200
  v_mfma_f32_32x32x16_bf16 a[64:79], v[44:47], a[120:123], a[64:79]
  ds_read_b64_tr_b16 v[64:65], v221 offset:15600
  ds_read_b64_tr_b16 v[66:67], v221 offset:16880
  v_add_f32 v91, v91, v201
  v_add_f32 v93, v93, v202
  v_add_f32 v95, v95, v203
  s_waitcnt vmcnt(8)
  v_add_f32 v96, v96, v204
  s_waitcnt lgkmcnt(7)
  v_mfma_f32_32x32x16_bf16 a[64:79], v[48:51], a[124:127], a[64:79]
  ds_read_b64_tr_b16 v[68:69], v221 offset:20720
  ds_read_b64_tr_b16 v[70:71], v221 offset:22000
  v_add_f32 v97, v97, v205
  v_add_f32 v98, v98, v206
  v_add_f32 v99, v99, v207
  s_waitcnt lgkmcnt(7)
  v_mfma_f32_32x32x16_bf16 a[96:111], v[52:55], v[140:143], a[96:111]
  ds_read_b64_tr_b16 v[72:73], v221 offset:25840
  ds_read_b64_tr_b16 v[74:75], v221 offset:27120
  v_mul_f32 v16, 0xbfb8aa3b, v80
  v_mul_f32 v17, 0xbfb8aa3b, v81
  v_mul_f32 v18, 0xbfb8aa3b, v82
  s_waitcnt lgkmcnt(8)
  v_mfma_f32_32x32x16_bf16 a[96:111], v[56:59], v[144:147], a[96:111]
  ds_read_b64_tr_b16 v[76:77], v221 offset:30960
  ds_read_b64_tr_b16 v[78:79], v221 offset:32240
  v_accvgpr_read_b32 v232, a64
  v_accvgpr_read_b32 v233, a65
  v_accvgpr_read_b32 v234, a66
  v_accvgpr_read_b32 v235, a67
  v_accvgpr_read_b32 v236, a68
  v_accvgpr_read_b32 v237, a69
  v_mul_f32 v19, 0xbfb8aa3b, v83
  v_mul_f32 v20, 0xbfb8aa3b, v84
  v_mul_f32 v21, 0xbfb8aa3b, v85
  v_mul_f32 v22, 0xbfb8aa3b, v86
  s_waitcnt lgkmcnt(6)
  v_mfma_f32_32x32x16_bf16 a[96:111], v[60:63], v[148:151], a[96:111]
  ds_read_b64_tr_b16 v[40:41], v221 offset:36080
  ds_read_b64_tr_b16 v[42:43], v221 offset:37360
  v_accvgpr_read_b32 v238, a70
  v_accvgpr_read_b32 v239, a71
  v_cvt_pk_bf16_f32 v128, v232, v233
  v_cvt_pk_bf16_f32 v129, v234, v235
  v_cvt_pk_bf16_f32 v130, v236, v237
  v_mul_f32 v23, 0xbfb8aa3b, v87
  v_mul_f32 v24, 0xbfb8aa3b, v88
  v_mul_f32 v25, 0xbfb8aa3b, v89
  v_mfma_f32_32x32x16_bf16 a[96:111], v[64:67], v[152:155], a[96:111]
  ds_read_b64_tr_b16 v[44:45], v222 offset:240
  v_cvt_pk_bf16_f32 v131, v238, v239
  v_accvgpr_read_b32 v240, a72
  v_accvgpr_read_b32 v241, a73
  v_accvgpr_read_b32 v242, a74
  v_mul_f32 v26, 0xbfb8aa3b, v90
  v_mul_f32 v27, 0xbfb8aa3b, v91
  v_mul_f32 v28, 0xbfb8aa3b, v92
  s_waitcnt lgkmcnt(3)
  v_mfma_f32_32x32x16_bf16 a[96:111], v[68:71], v[156:159], a[96:111]
  buffer_store_dwordx4 v[128:131], v226, s[64:67], s22 offen sc1
  ds_read_b64_tr_b16 v[46:47], v222 offset:1520
  ds_read_b64_tr_b16 v[48:49], v222 offset:5360
  ds_read_b64_tr_b16 v[50:51], v222 offset:6640
  v_accvgpr_read_b32 v243, a75
  v_accvgpr_read_b32 v244, a76
  v_accvgpr_read_b32 v245, a77
  v_accvgpr_read_b32 v246, a78
  v_accvgpr_read_b32 v247, a79
  v_mul_f32 v29, 0xbfb8aa3b, v93
  v_mul_f32 v30, 0xbfb8aa3b, v94
  v_mul_f32 v31, 0xbfb8aa3b, v95
  v_mul_f32 v32, 0xbfb8aa3b, v96
  v_mfma_f32_32x32x16_bf16 a[96:111], v[72:75], v[160:163], a[96:111]
  ds_read_b64_tr_b16 v[52:53], v222 offset:10480
  ds_read_b64_tr_b16 v[54:55], v222 offset:11760
  v_cvt_pk_bf16_f32 v132, v240, v241
  v_cvt_pk_bf16_f32 v133, v242, v243
  v_cvt_pk_bf16_f32 v134, v244, v245
  v_cvt_pk_bf16_f32 v135, v246, v247
  v_mul_f32 v33, 0xbfb8aa3b, v97
  v_mul_f32 v34, 0xbfb8aa3b, v98
  v_mul_f32 v35, 0xbfb8aa3b, v99
  v_mfma_f32_32x32x16_bf16 a[96:111], v[76:79], v[164:167], a[96:111]
  buffer_store_dwordx4 v[132:135], v226, s[64:67], s22 offen offset:1024 sc1
  ds_read_b64_tr_b16 v[56:57], v222 offset:15600
  ds_read_b64_tr_b16 v[58:59], v222 offset:16880
  v_exp_f32 v16, v16
  v_exp_f32 v17, v17
  v_exp_f32 v18, v18
  s_waitcnt lgkmcnt(5)
  v_mfma_f32_32x32x16_bf16 a[96:111], v[40:43], v[168:171], a[96:111]
  ds_read_b64_tr_b16 v[60:61], v222 offset:20720
  ds_read_b64_tr_b16 v[62:63], v222 offset:22000
  v_exp_f32 v19, v19
  v_exp_f32 v20, v20
  v_exp_f32 v21, v21
  v_exp_f32 v22, v22
  v_mfma_f32_32x32x16_bf16 a[96:111], v[44:47], a[176:179], a[96:111]
  ds_read_b64_tr_b16 v[64:65], v222 offset:25840
  ds_read_b64_tr_b16 v[66:67], v222 offset:27120
  v_exp_f32 v23, v23
  v_exp_f32 v24, v24
  v_exp_f32 v25, v25
  s_waitcnt lgkmcnt(6)
  v_mfma_f32_32x32x16_bf16 a[96:111], v[48:51], a[180:183], a[96:111]
  ds_read_b64_tr_b16 v[68:69], v222 offset:30960
  ds_read_b64_tr_b16 v[70:71], v222 offset:32240
  v_exp_f32 v26, v26
  v_exp_f32 v27, v27
  v_exp_f32 v28, v28
  v_mfma_f32_32x32x16_bf16 a[96:111], v[52:55], a[184:187], a[96:111]
  ds_read_b64_tr_b16 v[72:73], v222 offset:36080
  ds_read_b64_tr_b16 v[74:75], v222 offset:37360
  v_exp_f32 v29, v29
  v_exp_f32 v30, v30
  v_exp_f32 v31, v31
  v_exp_f32 v32, v32
  s_waitcnt lgkmcnt(8)
  v_mfma_f32_32x32x16_bf16 a[96:111], v[56:59], a[188:191], a[96:111]
  ds_read_b64_tr_b16 v[76:77], v223 offset:240
  ds_read_b64_tr_b16 v[78:79], v223 offset:1520
  v_exp_f32 v33, v33
  v_exp_f32 v34, v34
  v_exp_f32 v35, v35
  s_waitcnt lgkmcnt(8)
  v_mfma_f32_32x32x16_bf16 a[96:111], v[60:63], a[240:243], a[96:111]
  ds_read_b64_tr_b16 v[40:41], v223 offset:5360
  ds_read_b64_tr_b16 v[42:43], v223 offset:6640
  v_add_f32 v16, 1.0, v16
  v_add_f32 v17, 1.0, v17
  v_add_f32 v18, 1.0, v18
  s_waitcnt lgkmcnt(8)
  v_mfma_f32_32x32x16_bf16 a[96:111], v[64:67], a[244:247], a[96:111]
  ds_read_b64_tr_b16 v[44:45], v223 offset:10480
  ds_read_b64_tr_b16 v[46:47], v223 offset:11760
  v_add_f32 v19, 1.0, v19
  v_add_f32 v20, 1.0, v20
  v_add_f32 v21, 1.0, v21
  v_add_f32 v22, 1.0, v22
  s_waitcnt lgkmcnt(7)
  v_mfma_f32_32x32x16_bf16 a[96:111], v[68:71], a[248:251], a[96:111]
  ds_read_b64_tr_b16 v[48:49], v223 offset:15600
  s_add_u32 s83, s23, 36864
  buffer_load_dwordx4 v[172:175], v226, s[64:67], s83 offen sc1
  ds_read_b64_tr_b16 v[50:51], v223 offset:16880
  v_add_f32 v23, 1.0, v23
  v_add_f32 v24, 1.0, v24
  v_add_f32 v25, 1.0, v25
  s_waitcnt lgkmcnt(6)
  v_mfma_f32_32x32x16_bf16 a[96:111], v[72:75], a[252:255], a[96:111]
  ds_read_b64_tr_b16 v[52:53], v223 offset:20720
  ds_read_b64_tr_b16 v[54:55], v223 offset:22000
  v_add_f32 v26, 1.0, v26
  v_add_f32 v27, 1.0, v27
  v_add_f32 v28, 1.0, v28
  v_add_f32 v29, 1.0, v29
  v_mfma_f32_32x32x16_bf16 a[96:111], v[76:79], a[16:19], a[96:111]
  ds_read_b64_tr_b16 v[56:57], v223 offset:25840
  buffer_load_dwordx4 v[176:179], v226, s[64:67], s83 offen offset:1024 sc1
  ds_read_b64_tr_b16 v[58:59], v223 offset:27120
  v_add_f32 v30, 1.0, v30
  v_add_f32 v31, 1.0, v31
  v_add_f32 v32, 1.0, v32
  s_waitcnt lgkmcnt(6)
  v_mfma_f32_32x32x16_bf16 a[96:111], v[40:43], a[20:23], a[96:111]
  ds_read_b64_tr_b16 v[60:61], v223 offset:30960
  ds_read_b64_tr_b16 v[62:63], v223 offset:32240
  v_add_f32 v33, 1.0, v33
  v_add_f32 v34, 1.0, v34
  v_add_f32 v35, 1.0, v35
  v_mfma_f32_32x32x16_bf16 a[96:111], v[44:47], a[24:27], a[96:111]
  ds_read_b64_tr_b16 v[64:65], v223 offset:36080
  buffer_load_dwordx4 v[180:183], v226, s[64:67], s83 offen offset:2048 sc1
  ds_read_b64_tr_b16 v[66:67], v223 offset:37360
  v_rcp_f32 v16, v16
  v_rcp_f32 v17, v17
  v_rcp_f32 v18, v18
  v_rcp_f32 v19, v19
  s_waitcnt lgkmcnt(7)
  v_mfma_f32_32x32x16_bf16 a[96:111], v[48:51], a[28:31], a[96:111]
  ds_read_b64_tr_b16 v[68:69], v224 offset:240
  ds_read_b64_tr_b16 v[70:71], v224 offset:1520
  v_rcp_f32 v20, v20
  v_rcp_f32 v21, v21
  v_rcp_f32 v22, v22
  s_waitcnt lgkmcnt(7)
  v_mfma_f32_32x32x16_bf16 a[96:111], v[52:55], a[48:51], a[96:111]
  ds_read_b64_tr_b16 v[72:73], v224 offset:5360
  s_add_u32 s83, s23, 61440
  buffer_load_dwordx4 v[204:207], v226, s[64:67], s83 offen offset:2048 sc1
  ds_read_b64_tr_b16 v[74:75], v224 offset:6640
  v_rcp_f32 v23, v23
  v_rcp_f32 v24, v24
  v_rcp_f32 v25, v25
  s_waitcnt lgkmcnt(6)
  v_mfma_f32_32x32x16_bf16 a[96:111], v[56:59], a[52:55], a[96:111]
  ds_read_b64_tr_b16 v[76:77], v224 offset:10480
  ds_read_b64_tr_b16 v[78:79], v224 offset:11760
  v_rcp_f32 v26, v26
  v_rcp_f32 v27, v27
  v_rcp_f32 v28, v28
  v_rcp_f32 v29, v29
  v_mfma_f32_32x32x16_bf16 a[96:111], v[60:63], a[56:59], a[96:111]
  ds_read_b64_tr_b16 v[40:41], v224 offset:15600
  s_add_u32 s83, s23, 49152
  buffer_load_dwordx4 v[192:195], v226, s[64:67], s83 offen offset:2048 sc1
  ds_read_b64_tr_b16 v[42:43], v224 offset:16880
  v_rcp_f32 v30, v30
  v_rcp_f32 v31, v31
  v_rcp_f32 v32, v32
  s_waitcnt lgkmcnt(6)
  v_mfma_f32_32x32x16_bf16 a[96:111], v[64:67], a[60:63], a[96:111]
  ds_read_b64_tr_b16 v[44:45], v224 offset:20720
  ds_read_b64_tr_b16 v[46:47], v224 offset:22000
  v_rcp_f32 v33, v33
  v_rcp_f32 v34, v34
  v_rcp_f32 v35, v35
  v_mfma_f32_32x32x16_bf16 a[96:111], v[68:71], a[80:83], a[96:111]
  ds_read_b64_tr_b16 v[48:49], v224 offset:25840
  buffer_load_dwordx4 v[184:187], v226, s[64:67], s83 offen sc1
  ds_read_b64_tr_b16 v[50:51], v224 offset:27120
  v_mul_f32 v80, v80, v16
  v_mul_f32 v81, v81, v17
  v_mul_f32 v82, v82, v18
  v_mul_f32 v83, v83, v19
  s_waitcnt lgkmcnt(6)
  v_mfma_f32_32x32x16_bf16 a[96:111], v[72:75], a[84:87], a[96:111]
  ds_read_b64_tr_b16 v[52:53], v224 offset:30960
  ds_read_b64_tr_b16 v[54:55], v224 offset:32240
  v_mul_f32 v84, v84, v20
  v_mul_f32 v85, v85, v21
  v_mul_f32 v86, v86, v22
  v_mfma_f32_32x32x16_bf16 a[96:111], v[76:79], a[88:91], a[96:111]
  ds_read_b64_tr_b16 v[56:57], v224 offset:36080
  buffer_load_dwordx4 v[188:191], v226, s[64:67], s83 offen offset:1024 sc1
  ds_read_b64_tr_b16 v[58:59], v224 offset:37360
  v_mul_f32 v87, v87, v23
  v_mul_f32 v88, v88, v24
  v_mul_f32 v89, v89, v25
  s_waitcnt lgkmcnt(8)
  v_mfma_f32_32x32x16_bf16 a[96:111], v[40:43], a[92:95], a[96:111]
  v_mul_f32 v90, v90, v26
  v_mul_f32 v91, v91, v27
  v_mul_f32 v92, v92, v28
  v_mul_f32 v93, v93, v29
  s_waitcnt lgkmcnt(6)
  v_mfma_f32_32x32x16_bf16 a[96:111], v[44:47], a[112:115], a[96:111]
  v_mul_f32 v94, v94, v30
  v_mul_f32 v95, v95, v31
  v_mul_f32 v96, v96, v32
  s_waitcnt lgkmcnt(4)
  v_mfma_f32_32x32x16_bf16 a[96:111], v[48:51], a[116:119], a[96:111]
  v_mul_f32 v97, v97, v33
  v_mul_f32 v98, v98, v34
  v_mul_f32 v99, v99, v35
  s_waitcnt lgkmcnt(2)
  v_mfma_f32_32x32x16_bf16 a[96:111], v[52:55], a[120:123], a[96:111]
  s_waitcnt lgkmcnt(0)
  v_mfma_f32_32x32x16_bf16 a[96:111], v[56:59], a[124:127], a[96:111]
  s_add_u32 s83, s23, 61440
  buffer_load_dwordx4 v[196:199], v226, s[64:67], s83 offen sc1
  buffer_load_dwordx4 v[200:203], v226, s[64:67], s83 offen offset:1024 sc1
  s_nop 8
  v_accvgpr_read_b32 v16, a96
  v_accvgpr_read_b32 v17, a97
  v_accvgpr_read_b32 v18, a98
  v_accvgpr_read_b32 v19, a99
  v_accvgpr_read_b32 v20, a100
  v_accvgpr_read_b32 v21, a101
  v_accvgpr_read_b32 v22, a102
  v_accvgpr_read_b32 v23, a103
  v_accvgpr_read_b32 v24, a104
  v_accvgpr_read_b32 v25, a105
  v_accvgpr_read_b32 v26, a106
  v_accvgpr_read_b32 v27, a107
  v_accvgpr_read_b32 v28, a108
  v_accvgpr_read_b32 v29, a109
  v_accvgpr_read_b32 v30, a110
  v_accvgpr_read_b32 v31, a111
  v_accvgpr_read_b32 v32, a172
  v_accvgpr_read_b32 v33, a173
  v_accvgpr_read_b32 v34, a174
  v_accvgpr_read_b32 v35, a175
  s_waitcnt vmcnt(8)
  v_max_u32 v10, v172, v174
  v_max_u32 v11, v173, v175
  s_waitcnt vmcnt(7)
  v_max3_u32 v10, v10, v176, v178
  v_max3_u32 v11, v11, v177, v179
  s_waitcnt vmcnt(6)
  v_max3_u32 v10, v10, v180, v182
  v_max3_u32 v11, v11, v181, v183
  s_waitcnt vmcnt(5)
  v_max3_u32 v10, v10, v204, v206
  v_max3_u32 v11, v11, v205, v207
  s_waitcnt vmcnt(4)
  v_max3_u32 v10, v10, v192, v194
  v_max3_u32 v11, v11, v193, v195
  s_waitcnt vmcnt(3)
  v_max3_u32 v10, v10, v184, v186
  v_max3_u32 v11, v11, v185, v187
  s_waitcnt vmcnt(2)
  v_max3_u32 v10, v10, v188, v190
  v_max3_u32 v11, v11, v189, v191
  v_max_u32 v10, v10, v11
  v_cmp_eq_u32 vcc, -1, v10
  s_nop 4
  s_cbranch_vccnz L_reXB
L_backXB:
  v_lshlrev_b32 v12, 16, v172
  v_lshlrev_b32 v13, 16, v173
  v_lshlrev_b32 v14, 16, v174
  v_lshlrev_b32 v15, 16, v175
  v_and_b32 v172, s80, v172
  v_and_b32 v173, s80, v173
  v_and_b32 v174, s80, v174
  v_and_b32 v175, s80, v175
  v_add_f32 v16, v16, v12
  v_add_f32 v18, v18, v13
  v_add_f32 v20, v20, v14
  v_add_f32 v22, v22, v15
  v_add_f32 v17, v17, v172
  v_add_f32 v19, v19, v173
  v_add_f32 v21, v21, v174
  v_add_f32 v23, v23, v175
  v_lshlrev_b32 v12, 16, v176
  v_lshlrev_b32 v13, 16, v177
  v_lshlrev_b32 v14, 16, v178
  v_lshlrev_b32 v15, 16, v179
  v_and_b32 v176, s80, v176
  v_and_b32 v177, s80, v177
  v_and_b32 v178, s80, v178
  v_and_b32 v179, s80, v179
  v_add_f32 v24, v24, v12
  v_add_f32 v26, v26, v13
  v_add_f32 v28, v28, v14
  v_add_f32 v30, v30, v15
  v_add_f32 v25, v25, v176
  v_add_f32 v27, v27, v177
  v_add_f32 v29, v29, v178
  v_add_f32 v31, v31, v179
  v_add_f32 v32, v32, v180
  v_add_f32 v33, v33, v181
  v_add_f32 v34, v34, v182
  v_add_f32 v35, v35, v183
  v_add_f32 v32, v32, v204
  v_add_f32 v33, v33, v205
  v_add_f32 v34, v34, v206
  v_add_f32 v35, v35, v207
  v_add_f32 v32, v32, v192
  v_add_f32 v33, v33, v193
  v_add_f32 v34, v34, v194
  v_add_f32 v35, v35, v195
  v_lshlrev_b32 v12, 16, v184
  v_lshlrev_b32 v13, 16, v185
  v_lshlrev_b32 v14, 16, v186
  v_lshlrev_b32 v15, 16, v187
  v_and_b32 v184, s80, v184
  v_and_b32 v185, s80, v185
  v_and_b32 v186, s80, v186
  v_and_b32 v187, s80, v187
  v_add_f32 v16, v16, v12
  v_add_f32 v18, v18, v13
  v_add_f32 v20, v20, v14
  v_add_f32 v22, v22, v15
  v_add_f32 v17, v17, v184
  v_add_f32 v19, v19, v185
  v_add_f32 v21, v21, v186
  v_add_f32 v23, v23, v187
  v_lshlrev_b32 v12, 16, v188
  v_lshlrev_b32 v13, 16, v189
  v_lshlrev_b32 v14, 16, v190
  v_lshlrev_b32 v15, 16, v191
  v_and_b32 v188, s80, v188
  v_and_b32 v189, s80, v189
  v_and_b32 v190, s80, v190
  v_and_b32 v191, s80, v191
  v_add_f32 v24, v24, v12
  v_add_f32 v26, v26, v13
  v_add_f32 v28, v28, v14
  v_add_f32 v30, v30, v15
  v_add_f32 v25, v25, v188
  v_add_f32 v27, v27, v189
  v_add_f32 v29, v29, v190
  v_add_f32 v31, v31, v191
  s_waitcnt vmcnt(1)
  v_max_u32 v10, v196, v198
  v_max_u32 v11, v197, v199
  s_waitcnt vmcnt(0)
  v_max3_u32 v10, v10, v200, v202
  v_max3_u32 v11, v11, v201, v203
  v_max_u32 v10, v10, v11
  v_cmp_eq_u32 vcc, -1, v10
  s_nop 4
  s_cbranch_vccnz L_reXC
L_backXC:
  v_lshlrev_b32 v12, 16, v196
  v_lshlrev_b32 v13, 16, v197
  v_lshlrev_b32 v14, 16, v198
  v_lshlrev_b32 v15, 16, v199
  v_and_b32 v196, s80, v196
  v_and_b32 v197, s80, v197
  v_and_b32 v198, s80, v198
  v_and_b32 v199, s80, v199
  v_add_f32 v16, v16, v12
  v_add_f32 v18, v18, v13
  v_add_f32 v20, v20, v14
  v_add_f32 v22, v22, v15
  v_add_f32 v17, v17, v196
  v_add_f32 v19, v19, v197
  v_add_f32 v21, v21, v198
  v_add_f32 v23, v23, v199
  v_lshlrev_b32 v12, 16, v200
  v_lshlrev_b32 v13, 16, v201
  v_lshlrev_b32 v14, 16, v202
  v_lshlrev_b32 v15, 16, v203
  v_and_b32 v200, s80, v200
  v_and_b32 v201, s80, v201
  v_and_b32 v202, s80, v202
  v_and_b32 v203, s80, v203
  v_add_f32 v24, v24, v12
  v_add_f32 v26, v26, v13
  v_add_f32 v28, v28, v14
  v_add_f32 v30, v30, v15
  v_add_f32 v25, v25, v200
  v_add_f32 v27, v27, v201
  v_add_f32 v29, v29, v202
  v_add_f32 v31, v31, v203
  v_lshlrev_b32 v10, 16, v100
  v_and_b32 v11, s80, v100
  v_fmac_f32 v10, v80, v16
  v_fmac_f32 v11, v81, v17
  v_cvt_pk_bf16_f32 v100, v10, v11
  v_lshlrev_b32 v12, 16, v101
  v_and_b32 v13, s80, v101
  v_fmac_f32 v12, v82, v18
  v_fmac_f32 v13, v83, v19
  v_cvt_pk_bf16_f32 v101, v12, v13
  v_lshlrev_b32 v10, 16, v102
  v_and_b32 v11, s80, v102
  v_fmac_f32 v10, v84, v20
  v_fmac_f32 v11, v85, v21
  v_cvt_pk_bf16_f32 v102, v10, v11
  v_lshlrev_b32 v12, 16, v103
  v_and_b32 v13, s80, v103
  v_fmac_f32 v12, v86, v22
  v_fmac_f32 v13, v87, v23
  v_cvt_pk_bf16_f32 v103, v12, v13
  buffer_store_dwordx4 v[100:103], v227, s[56:59], s72 offen
  v_lshlrev_b32 v10, 16, v104
  v_and_b32 v11, s80, v104
  v_fmac_f32 v10, v88, v24
  v_fmac_f32 v11, v89, v25
  v_cvt_pk_bf16_f32 v104, v10, v11
  v_lshlrev_b32 v12, 16, v105
  v_and_b32 v13, s80, v105
  v_fmac_f32 v12, v90, v26
  v_fmac_f32 v13, v91, v27
  v_cvt_pk_bf16_f32 v105, v12, v13
  v_lshlrev_b32 v10, 16, v106
  v_and_b32 v11, s80, v106
  v_fmac_f32 v10, v92, v28
  v_fmac_f32 v11, v93, v29
  v_cvt_pk_bf16_f32 v106, v10, v11
  v_lshlrev_b32 v12, 16, v107
  v_and_b32 v13, s80, v107
  v_fmac_f32 v12, v94, v30
  v_fmac_f32 v13, v95, v31
  v_cvt_pk_bf16_f32 v107, v12, v13
  buffer_store_dwordx4 v[104:107], v227, s[56:59], s72 offen offset:16
  v_lshlrev_b32 v10, 16, v108
  v_and_b32 v11, s80, v108
  v_fmac_f32 v10, v96, v32
  v_fmac_f32 v11, v97, v33
  v_cvt_pk_bf16_f32 v108, v10, v11
  v_lshlrev_b32 v12, 16, v109
  v_and_b32 v13, s80, v109
  v_fmac_f32 v12, v98, v34
  v_fmac_f32 v13, v99, v35
  v_cvt_pk_bf16_f32 v109, v12, v13
  buffer_store_dwordx2 v[108:109], v9, s[56:59], s72 offen
L_k1_end:
  s_endpgm
L_spinS:
  s_mov_b32 s87, 20000
L_spinS_l:
  buffer_load_dword v45, off, s[60:63], s86 offset:16 sc1
  s_waitcnt vmcnt(0)
  v_readfirstlane_b32 s82, v45
  s_nop 1
  s_cmp_ge_u32 s82, 32
  s_cbranch_scc1 L_backS
  s_sub_u32 s87, s87, 1
  s_cmp_lg_u32 s87, 0
  s_cbranch_scc1 L_spinS_l
  s_branch L_backS
L_spinA:
  s_mov_b32 s87, 20000
L_spinA_l:
  buffer_load_dword v3, off, s[60:63], s86 sc1
  s_waitcnt vmcnt(0)
  v_readfirstlane_b32 s82, v3
  s_nop 1
  s_cmp_ge_u32 s82, 32
  s_cbranch_scc1 L_backA
  s_sub_u32 s87, s87, 1
  s_cmp_lg_u32 s87, 0
  s_cbranch_scc1 L_spinA_l
  s_branch L_backA
L_spinO1:
  s_mov_b32 s87, 20000
L_spinO1_l:
  buffer_load_dword v3, v228, s[64:67], s76 offen sc1
  s_waitcnt vmcnt(0)
  v_cmp_ne_u32 vcc, 0, v3
  s_nop 1
  s_and_b32 s82, vcc_lo, s81
  s_cmp_eq_u32 s82, s81
  s_cbranch_scc1 L_backO1
  s_sub_u32 s87, s87, 1
  s_cmp_lg_u32 s87, 0
  s_cbranch_scc1 L_spinO1_l
  s_branch L_backO1
L_spinO2:
  s_mov_b32 s87, 20000
L_spinO2_l:
  buffer_load_dword v3, v228, s[64:67], s76 offen sc1
  s_waitcnt vmcnt(0)
  v_cmp_ne_u32 vcc, 0, v3
  s_nop 1
  s_and_b32 s82, vcc_lo, s6
  s_cmp_eq_u32 s82, s6
  s_cbranch_scc1 L_backO2
  s_sub_u32 s87, s87, 1
  s_cmp_lg_u32 s87, 0
  s_cbranch_scc1 L_spinO2_l
  s_branch L_backO2
L_spinD:
  s_mov_b32 s87, 20000
L_spinD_l:
  buffer_load_dword v3, v228, s[64:67], s76 offen sc1
  s_waitcnt vmcnt(0)
  v_cmp_ne_u32 vcc, 0, v3
  s_nop 1
  s_and_b32 s82, vcc_lo, 15
  s_cmp_eq_u32 s82, 15
  s_cbranch_scc1 L_backD
  s_sub_u32 s87, s87, 1
  s_cmp_lg_u32 s87, 0
  s_cbranch_scc1 L_spinD_l
  s_branch L_backD
L_reXB:
  s_mov_b32 s87, 20000
L_reXB_l:
  s_add_u32 s83, s23, 36864
  buffer_load_dwordx4 v[172:175], v226, s[64:67], s83 offen sc1
  buffer_load_dwordx4 v[176:179], v226, s[64:67], s83 offen offset:1024 sc1
  buffer_load_dwordx4 v[180:183], v226, s[64:67], s83 offen offset:2048 sc1
  s_add_u32 s83, s23, 61440
  buffer_load_dwordx4 v[204:207], v226, s[64:67], s83 offen offset:2048 sc1
  s_add_u32 s83, s23, 49152
  buffer_load_dwordx4 v[192:195], v226, s[64:67], s83 offen offset:2048 sc1
  buffer_load_dwordx4 v[184:187], v226, s[64:67], s83 offen sc1
  buffer_load_dwordx4 v[188:191], v226, s[64:67], s83 offen offset:1024 sc1
  s_waitcnt vmcnt(0)
  v_max_u32 v10, v172, v174
  v_max_u32 v11, v173, v175
  v_max3_u32 v10, v10, v176, v178
  v_max3_u32 v11, v11, v177, v179
  v_max3_u32 v10, v10, v180, v182
  v_max3_u32 v11, v11, v181, v183
  v_max3_u32 v10, v10, v204, v206
  v_max3_u32 v11, v11, v205, v207
  v_max3_u32 v10, v10, v192, v194
  v_max3_u32 v11, v11, v193, v195
  v_max3_u32 v10, v10, v184, v186
  v_max3_u32 v11, v11, v185, v187
  v_max3_u32 v10, v10, v188, v190
  v_max3_u32 v11, v11, v189, v191
  v_max_u32 v10, v10, v11
  v_cmp_eq_u32 vcc, -1, v10
  s_nop 4
  s_cbranch_vccz L_backXB
  s_sub_u32 s87, s87, 1
  s_cmp_lg_u32 s87, 0
  s_cbranch_scc1 L_reXB_l
  s_branch L_backXB
L_reXC:
  s_mov_b32 s87, 20000
L_reXC_l:
  s_add_u32 s83, s23, 61440
  buffer_load_dwordx4 v[196:199], v226, s[64:67], s83 offen sc1
  buffer_load_dwordx4 v[200:203], v226, s[64:67], s83 offen offset:1024 sc1
  s_waitcnt vmcnt(0)
  v_max_u32 v10, v196, v198
  v_max_u32 v11, v197, v199
  v_max3_u32 v10, v10, v200, v202
  v_max3_u32 v11, v11, v201, v203
  v_max_u32 v10, v10, v11
  v_cmp_eq_u32 vcc, -1, v10
  s_nop 4
  s_cbranch_vccz L_backXC
  s_sub_u32 s87, s87, 1
  s_cmp_lg_u32 s87, 0
  s_cbranch_scc1 L_reXC_l
  s_branch L_backXC
L_slow:
  s_waitcnt vmcnt(0) lgkmcnt(0)
  s_nop 15
  s_nop 15
  v_lshrrev_b32 v14, 5, v6
  v_and_b32 v10, 31, v6
  v_lshlrev_b32 v10, 8, v10
  v_lshl_add_u32 v10, v14, 4, v10
  v_and_b32 v11, 19, v6
  v_bfe_u32 v15, v6, 2, 1
  v_lshl_add_u32 v11, v15, 3, v11
  v_bfe_u32 v15, v6, 3, 1
  v_lshl_add_u32 v11, v15, 2, v11
  v_lshlrev_b32 v11, 1, v11
  v_lshl_add_u32 v11, v14, 10, v11
  v_mov_b32 v12, 0xff800000
  v_mov_b32 v13, 0xff800000
  s_mov_b32 s82, 0
L_slow1:
  s_lshl_b32 s83, s3, 1
  s_add_u32 s83, s83, 0
  s_and_b32 s83, s83, 7
  s_lshl_b32 s83, s83, 5
  s_add_u32 s83, s83, s82
  buffer_load_dwordx4 a[160:163], v10, s[24:27], s83 offen
  s_lshl_b32 s83, s3, 1
  s_add_u32 s83, s83, 1
  s_and_b32 s83, s83, 7
  s_lshl_b32 s83, s83, 5
  s_add_u32 s83, s83, s82
  buffer_load_dwordx4 a[164:167], v10, s[24:27], s83 offen
  s_lshl_b32 s83, s3, 1
  s_add_u32 s83, s83, 2
  s_and_b32 s83, s83, 7
  s_lshl_b32 s83, s83, 5
  s_add_u32 s83, s83, s82
  buffer_load_dwordx4 a[168:171], v10, s[24:27], s83 offen
  s_lshl_b32 s83, s3, 1
  s_add_u32 s83, s83, 3
  s_and_b32 s83, s83, 7
  s_lshl_b32 s83, s83, 5
  s_add_u32 s83, s83, s82
  buffer_load_dwordx4 a[172:175], v10, s[24:27], s83 offen
  s_lshl_b32 s83, s3, 1
  s_add_u32 s83, s83, 4
  s_and_b32 s83, s83, 7
  s_lshl_b32 s83, s83, 5
  s_add_u32 s83, s83, s82
  buffer_load_dwordx4 a[176:179], v10, s[24:27], s83 offen
  s_lshl_b32 s83, s3, 1
  s_add_u32 s83, s83, 5
  s_and_b32 s83, s83, 7
  s_lshl_b32 s83, s83, 5
  s_add_u32 s83, s83, s82
  buffer_load_dwordx4 a[180:183], v10, s[24:27], s83 offen
  s_lshl_b32 s83, s3, 1
  s_add_u32 s83, s83, 6
  s_and_b32 s83, s83, 7
  s_lshl_b32 s83, s83, 5
  s_add_u32 s83, s83, s82
  buffer_load_dwordx4 a[184:187], v10, s[24:27], s83 offen
  s_lshl_b32 s83, s3, 1
  s_add_u32 s83, s83, 7
  s_and_b32 s83, s83, 7
  s_lshl_b32 s83, s83, 5
  s_add_u32 s83, s83, s82
  buffer_load_dwordx4 a[188:191], v10, s[24:27], s83 offen
  s_waitcnt vmcnt(7)
  v_mfma_f32_32x32x16_bf16 v[48:63], a[160:163], v[128:131], 0
  v_mfma_f32_32x32x16_bf16 v[64:79], a[160:163], v[132:135], 0
  s_waitcnt vmcnt(6)
  v_mfma_f32_32x32x16_bf16 v[48:63], a[164:167], v[136:139], v[48:63]
  v_mfma_f32_32x32x16_bf16 v[64:79], a[164:167], v[140:143], v[64:79]
  s_waitcnt vmcnt(5)
  v_mfma_f32_32x32x16_bf16 v[48:63], a[168:171], v[144:147], v[48:63]
  v_mfma_f32_32x32x16_bf16 v[64:79], a[168:171], v[148:151], v[64:79]
  s_waitcnt vmcnt(4)
  v_mfma_f32_32x32x16_bf16 v[48:63], a[172:175], v[152:155], v[48:63]
  v_mfma_f32_32x32x16_bf16 v[64:79], a[172:175], v[156:159], v[64:79]
  s_waitcnt vmcnt(3)
  v_mfma_f32_32x32x16_bf16 v[48:63], a[176:179], v[160:163], v[48:63]
  v_mfma_f32_32x32x16_bf16 v[64:79], a[176:179], v[164:167], v[64:79]
  s_waitcnt vmcnt(2)
  v_mfma_f32_32x32x16_bf16 v[48:63], a[180:183], v[168:171], v[48:63]
  v_mfma_f32_32x32x16_bf16 v[64:79], a[180:183], v[172:175], v[64:79]
  s_waitcnt vmcnt(1)
  v_mfma_f32_32x32x16_bf16 v[48:63], a[184:187], v[176:179], v[48:63]
  v_mfma_f32_32x32x16_bf16 v[64:79], a[184:187], v[180:183], v[64:79]
  s_waitcnt vmcnt(0)
  v_mfma_f32_32x32x16_bf16 v[48:63], a[188:191], v[184:187], v[48:63]
  v_mfma_f32_32x32x16_bf16 v[64:79], a[188:191], v[188:191], v[64:79]
  s_nop 10
  v_max3_f32 v12, v12, v48, v49
  v_max3_f32 v12, v12, v50, v51
  v_max3_f32 v12, v12, v52, v53
  v_max3_f32 v12, v12, v54, v55
  v_max3_f32 v12, v12, v56, v57
  v_max3_f32 v12, v12, v58, v59
  v_max3_f32 v12, v12, v60, v61
  v_max3_f32 v12, v12, v62, v63
  v_max3_f32 v13, v13, v64, v65
  v_max3_f32 v13, v13, v66, v67
  v_max3_f32 v13, v13, v68, v69
  v_max3_f32 v13, v13, v70, v71
  v_max3_f32 v13, v13, v72, v73
  v_max3_f32 v13, v13, v74, v75
  v_max3_f32 v13, v13, v76, v77
  v_max3_f32 v13, v13, v78, v79
  s_add_u32 s82, s82, 8192
  s_cmp_lt_u32 s82, 131072
  s_waitcnt vmcnt(0) lgkmcnt(0)
  s_nop 15
  s_nop 15
  s_cbranch_scc1 L_slow1
  v_mov_b32 v14, v12
  s_nop 1
  v_permlane32_swap_b32 v12, v14
  v_max_f32 v12, v12, v14
  v_mul_f32 v12, -1.0, v12
  v_mov_b32 v14, v13
  s_nop 1
  v_permlane32_swap_b32 v13, v14
  v_max_f32 v13, v13, v14
  v_mul_f32 v13, -1.0, v13
  v_accvgpr_write_b32 a0, 0
  v_accvgpr_write_b32 a1, 0
  v_accvgpr_write_b32 a2, 0
  v_accvgpr_write_b32 a3, 0
  v_accvgpr_write_b32 a4, 0
  v_accvgpr_write_b32 a5, 0
  v_accvgpr_write_b32 a6, 0
  v_accvgpr_write_b32 a7, 0
  v_accvgpr_write_b32 a8, 0
  v_accvgpr_write_b32 a9, 0
  v_accvgpr_write_b32 a10, 0
  v_accvgpr_write_b32 a11, 0
  v_accvgpr_write_b32 a12, 0
  v_accvgpr_write_b32 a13, 0
  v_accvgpr_write_b32 a14, 0
  v_accvgpr_write_b32 a15, 0
  v_accvgpr_write_b32 a16, 0
  v_accvgpr_write_b32 a17, 0
  v_accvgpr_write_b32 a18, 0
  v_accvgpr_write_b32 a19, 0
  v_accvgpr_write_b32 a20, 0
  v_accvgpr_write_b32 a21, 0
  v_accvgpr_write_b32 a22, 0
  v_accvgpr_write_b32 a23, 0
  v_accvgpr_write_b32 a24, 0
  v_accvgpr_write_b32 a25, 0
  v_accvgpr_write_b32 a26, 0
  v_accvgpr_write_b32 a27, 0
  v_accvgpr_write_b32 a28, 0
  v_accvgpr_write_b32 a29, 0
  v_accvgpr_write_b32 a30, 0
  v_accvgpr_write_b32 a31, 0
  v_accvgpr_write_b32 a32, 0
  v_accvgpr_write_b32 a33, 0
  v_accvgpr_write_b32 a34, 0
  v_accvgpr_write_b32 a35, 0
  v_accvgpr_write_b32 a36, 0
  v_accvgpr_write_b32 a37, 0
  v_accvgpr_write_b32 a38, 0
  v_accvgpr_write_b32 a39, 0
  v_accvgpr_write_b32 a40, 0
  v_accvgpr_write_b32 a41, 0
  v_accvgpr_write_b32 a42, 0
  v_accvgpr_write_b32 a43, 0
  v_accvgpr_write_b32 a44, 0
  v_accvgpr_write_b32 a45, 0
  v_accvgpr_write_b32 a46, 0
  v_accvgpr_write_b32 a47, 0
  v_accvgpr_write_b32 a48, 0
  v_accvgpr_write_b32 a49, 0
  v_accvgpr_write_b32 a50, 0
  v_accvgpr_write_b32 a51, 0
  v_accvgpr_write_b32 a52, 0
  v_accvgpr_write_b32 a53, 0
  v_accvgpr_write_b32 a54, 0
  v_accvgpr_write_b32 a55, 0
  v_accvgpr_write_b32 a56, 0
  v_accvgpr_write_b32 a57, 0
  v_accvgpr_write_b32 a58, 0
  v_accvgpr_write_b32 a59, 0
  v_accvgpr_write_b32 a60, 0
  v_accvgpr_write_b32 a61, 0
  v_accvgpr_write_b32 a62, 0
  v_accvgpr_write_b32 a63, 0
  v_accvgpr_write_b32 a64, 0
  v_accvgpr_write_b32 a65, 0
  v_accvgpr_write_b32 a66, 0
  v_accvgpr_write_b32 a67, 0
  v_accvgpr_write_b32 a68, 0
  v_accvgpr_write_b32 a69, 0
  v_accvgpr_write_b32 a70, 0
  v_accvgpr_write_b32 a71, 0
  v_accvgpr_write_b32 a72, 0
  v_accvgpr_write_b32 a73, 0
  v_accvgpr_write_b32 a74, 0
  v_accvgpr_write_b32 a75, 0
  v_accvgpr_write_b32 a76, 0
  v_accvgpr_write_b32 a77, 0
  v_accvgpr_write_b32 a78, 0
  v_accvgpr_write_b32 a79, 0
  v_accvgpr_write_b32 a80, 0
  v_accvgpr_write_b32 a81, 0
  v_accvgpr_write_b32 a82, 0
  v_accvgpr_write_b32 a83, 0
  v_accvgpr_write_b32 a84, 0
  v_accvgpr_write_b32 a85, 0
  v_accvgpr_write_b32 a86, 0
  v_accvgpr_write_b32 a87, 0
  v_accvgpr_write_b32 a88, 0
  v_accvgpr_write_b32 a89, 0
  v_accvgpr_write_b32 a90, 0
  v_accvgpr_write_b32 a91, 0
  v_accvgpr_write_b32 a92, 0
  v_accvgpr_write_b32 a93, 0
  v_accvgpr_write_b32 a94, 0
  v_accvgpr_write_b32 a95, 0
  v_accvgpr_write_b32 a96, 0
  v_accvgpr_write_b32 a97, 0
  v_accvgpr_write_b32 a98, 0
  v_accvgpr_write_b32 a99, 0
  v_accvgpr_write_b32 a100, 0
  v_accvgpr_write_b32 a101, 0
  v_accvgpr_write_b32 a102, 0
  v_accvgpr_write_b32 a103, 0
  v_accvgpr_write_b32 a104, 0
  v_accvgpr_write_b32 a105, 0
  v_accvgpr_write_b32 a106, 0
  v_accvgpr_write_b32 a107, 0
  v_accvgpr_write_b32 a108, 0
  v_accvgpr_write_b32 a109, 0
  v_accvgpr_write_b32 a110, 0
  v_accvgpr_write_b32 a111, 0
  v_accvgpr_write_b32 a112, 0
  v_accvgpr_write_b32 a113, 0
  v_accvgpr_write_b32 a114, 0
  v_accvgpr_write_b32 a115, 0
  v_accvgpr_write_b32 a116, 0
  v_accvgpr_write_b32 a117, 0
  v_accvgpr_write_b32 a118, 0
  v_accvgpr_write_b32 a119, 0
  v_accvgpr_write_b32 a120, 0
  v_accvgpr_write_b32 a121, 0
  v_accvgpr_write_b32 a122, 0
  v_accvgpr_write_b32 a123, 0
  v_accvgpr_write_b32 a124, 0
  v_accvgpr_write_b32 a125, 0
  v_accvgpr_write_b32 a126, 0
  v_accvgpr_write_b32 a127, 0
  v_mov_b32 v192, 0
  v_mov_b32 v193, 0
  v_mov_b32 v194, 0
  v_mov_b32 v195, 0
  s_mov_b32 s82, 0
  s_waitcnt vmcnt(0) lgkmcnt(0)
  s_nop 15
  s_nop 15
L_slow2:
  s_lshl_b32 s83, s3, 1
  s_add_u32 s83, s83, 0
  s_and_b32 s83, s83, 7
  s_lshl_b32 s83, s83, 5
  s_add_u32 s83, s83, s82
  buffer_load_dwordx4 a[160:163], v10, s[24:27], s83 offen
  s_lshl_b32 s83, s3, 1
  s_add_u32 s83, s83, 1
  s_and_b32 s83, s83, 7
  s_lshl_b32 s83, s83, 5
  s_add_u32 s83, s83, s82
  buffer_load_dwordx4 a[164:167], v10, s[24:27], s83 offen
  s_lshl_b32 s83, s3, 1
  s_add_u32 s83, s83, 2
  s_and_b32 s83, s83, 7
  s_lshl_b32 s83, s83, 5
  s_add_u32 s83, s83, s82
  buffer_load_dwordx4 a[168:171], v10, s[24:27], s83 offen
  s_lshl_b32 s83, s3, 1
  s_add_u32 s83, s83, 3
  s_and_b32 s83, s83, 7
  s_lshl_b32 s83, s83, 5
  s_add_u32 s83, s83, s82
  buffer_load_dwordx4 a[172:175], v10, s[24:27], s83 offen
  s_lshl_b32 s83, s3, 1
  s_add_u32 s83, s83, 4
  s_and_b32 s83, s83, 7
  s_lshl_b32 s83, s83, 5
  s_add_u32 s83, s83, s82
  buffer_load_dwordx4 a[176:179], v10, s[24:27], s83 offen
  s_lshl_b32 s83, s3, 1
  s_add_u32 s83, s83, 5
  s_and_b32 s83, s83, 7
  s_lshl_b32 s83, s83, 5
  s_add_u32 s83, s83, s82
  buffer_load_dwordx4 a[180:183], v10, s[24:27], s83 offen
  s_lshl_b32 s83, s3, 1
  s_add_u32 s83, s83, 6
  s_and_b32 s83, s83, 7
  s_lshl_b32 s83, s83, 5
  s_add_u32 s83, s83, s82
  buffer_load_dwordx4 a[184:187], v10, s[24:27], s83 offen
  s_lshl_b32 s83, s3, 1
  s_add_u32 s83, s83, 7
  s_and_b32 s83, s83, 7
  s_lshl_b32 s83, s83, 5
  s_add_u32 s83, s83, s82
  buffer_load_dwordx4 a[188:191], v10, s[24:27], s83 offen
  s_waitcnt vmcnt(7)
  v_mfma_f32_32x32x16_bf16 v[48:63], a[160:163], v[128:131], 0
  v_mfma_f32_32x32x16_bf16 v[64:79], a[160:163], v[132:135], 0
  s_waitcnt vmcnt(6)
  v_mfma_f32_32x32x16_bf16 v[48:63], a[164:167], v[136:139], v[48:63]
  v_mfma_f32_32x32x16_bf16 v[64:79], a[164:167], v[140:143], v[64:79]
  s_waitcnt vmcnt(5)
  v_mfma_f32_32x32x16_bf16 v[48:63], a[168:171], v[144:147], v[48:63]
  v_mfma_f32_32x32x16_bf16 v[64:79], a[168:171], v[148:151], v[64:79]
  s_waitcnt vmcnt(4)
  v_mfma_f32_32x32x16_bf16 v[48:63], a[172:175], v[152:155], v[48:63]
  v_mfma_f32_32x32x16_bf16 v[64:79], a[172:175], v[156:159], v[64:79]
  s_waitcnt vmcnt(3)
  v_mfma_f32_32x32x16_bf16 v[48:63], a[176:179], v[160:163], v[48:63]
  v_mfma_f32_32x32x16_bf16 v[64:79], a[176:179], v[164:167], v[64:79]
  s_waitcnt vmcnt(2)
  v_mfma_f32_32x32x16_bf16 v[48:63], a[180:183], v[168:171], v[48:63]
  v_mfma_f32_32x32x16_bf16 v[64:79], a[180:183], v[172:175], v[64:79]
  s_waitcnt vmcnt(1)
  v_mfma_f32_32x32x16_bf16 v[48:63], a[184:187], v[176:179], v[48:63]
  v_mfma_f32_32x32x16_bf16 v[64:79], a[184:187], v[180:183], v[64:79]
  s_waitcnt vmcnt(0)
  v_mfma_f32_32x32x16_bf16 v[48:63], a[188:191], v[184:187], v[48:63]
  v_mfma_f32_32x32x16_bf16 v[64:79], a[188:191], v[188:191], v[64:79]
  s_nop 10
  v_add_f32 v48, v12, v48
  v_add_f32 v49, v12, v49
  v_exp_f32 v48, v48
  v_exp_f32 v49, v49
  v_add_f32 v50, v12, v50
  v_add_f32 v51, v12, v51
  v_exp_f32 v50, v50
  v_add_f32 v192, v192, v48
  v_add_f32 v193, v193, v49
  v_exp_f32 v51, v51
  v_cvt_pk_bf16_f32 v96, v48, v49
  v_add_f32 v52, v12, v52
  v_add_f32 v53, v12, v53
  v_exp_f32 v52, v52
  v_add_f32 v192, v192, v50
  v_add_f32 v193, v193, v51
  v_exp_f32 v53, v53
  v_cvt_pk_bf16_f32 v97, v50, v51
  v_add_f32 v54, v12, v54
  v_add_f32 v55, v12, v55
  v_exp_f32 v54, v54
  v_add_f32 v192, v192, v52
  v_add_f32 v193, v193, v53
  v_exp_f32 v55, v55
  v_cvt_pk_bf16_f32 v98, v52, v53
  v_add_f32 v56, v12, v56
  v_add_f32 v57, v12, v57
  v_exp_f32 v56, v56
  v_add_f32 v192, v192, v54
  v_add_f32 v193, v193, v55
  v_exp_f32 v57, v57
  v_cvt_pk_bf16_f32 v99, v54, v55
  v_add_f32 v58, v12, v58
  v_add_f32 v59, v12, v59
  v_exp_f32 v58, v58
  v_add_f32 v192, v192, v56
  v_add_f32 v193, v193, v57
  v_exp_f32 v59, v59
  v_cvt_pk_bf16_f32 v100, v56, v57
  v_add_f32 v60, v12, v60
  v_add_f32 v61, v12, v61
  v_exp_f32 v60, v60
  v_add_f32 v192, v192, v58
  v_add_f32 v193, v193, v59
  v_exp_f32 v61, v61
  v_cvt_pk_bf16_f32 v101, v58, v59
  v_add_f32 v62, v12, v62
  v_add_f32 v63, v12, v63
  v_exp_f32 v62, v62
  v_add_f32 v192, v192, v60
  v_add_f32 v193, v193, v61
  v_exp_f32 v63, v63
  v_cvt_pk_bf16_f32 v102, v60, v61
  v_add_f32 v64, v13, v64
  v_add_f32 v65, v13, v65
  v_exp_f32 v64, v64
  v_add_f32 v192, v192, v62
  v_add_f32 v193, v193, v63
  v_exp_f32 v65, v65
  v_cvt_pk_bf16_f32 v103, v62, v63
  v_add_f32 v66, v13, v66
  v_add_f32 v67, v13, v67
  v_exp_f32 v66, v66
  v_add_f32 v194, v194, v64
  v_add_f32 v195, v195, v65
  v_exp_f32 v67, v67
  v_cvt_pk_bf16_f32 v104, v64, v65
  v_add_f32 v68, v13, v68
  v_add_f32 v69, v13, v69
  v_exp_f32 v68, v68
  v_add_f32 v194, v194, v66
  v_add_f32 v195, v195, v67
  v_exp_f32 v69, v69
  v_cvt_pk_bf16_f32 v105, v66, v67
  v_add_f32 v70, v13, v70
  v_add_f32 v71, v13, v71
  v_exp_f32 v70, v70
  v_add_f32 v194, v194, v68
  v_add_f32 v195, v195, v69
  v_exp_f32 v71, v71
  v_cvt_pk_bf16_f32 v106, v68, v69
  v_add_f32 v72, v13, v72
  v_add_f32 v73, v13, v73
  v_exp_f32 v72, v72
  v_add_f32 v194, v194, v70
  v_add_f32 v195, v195, v71
  v_exp_f32 v73, v73
  v_cvt_pk_bf16_f32 v107, v70, v71
  v_add_f32 v74, v13, v74
  v_add_f32 v75, v13, v75
  v_exp_f32 v74, v74
  v_add_f32 v194, v194, v72
  v_add_f32 v195, v195, v73
  v_exp_f32 v75, v75
  v_cvt_pk_bf16_f32 v108, v72, v73
  v_add_f32 v76, v13, v76
  v_add_f32 v77, v13, v77
  v_exp_f32 v76, v76
  v_add_f32 v194, v194, v74
  v_add_f32 v195, v195, v75
  v_exp_f32 v77, v77
  v_cvt_pk_bf16_f32 v109, v74, v75
  v_add_f32 v78, v13, v78
  v_add_f32 v79, v13, v79
  v_exp_f32 v78, v78
  v_add_f32 v194, v194, v76
  v_add_f32 v195, v195, v77
  v_exp_f32 v79, v79
  v_cvt_pk_bf16_f32 v110, v76, v77
  v_add_f32 v194, v194, v78
  v_add_f32 v195, v195, v79
  v_cvt_pk_bf16_f32 v111, v78, v79
  s_cmp_eq_u32 s82, 122880
  s_waitcnt vmcnt(0) lgkmcnt(0)
  s_nop 15
  s_nop 15
  s_cbranch_scc1 L_slow3
  s_add_u32 s83, s82, 0
  buffer_load_ushort v16, v11, s[28:31], s83 offen offset:0
  buffer_load_ushort v48, v11, s[28:31], s83 offen offset:256
  buffer_load_ushort v17, v11, s[28:31], s83 offen offset:512
  buffer_load_ushort v49, v11, s[28:31], s83 offen offset:768
  buffer_load_ushort v18, v11, s[28:31], s83 offen offset:2048
  buffer_load_ushort v50, v11, s[28:31], s83 offen offset:2304
  buffer_load_ushort v19, v11, s[28:31], s83 offen offset:2560
  buffer_load_ushort v51, v11, s[28:31], s83 offen offset:2816
  buffer_load_ushort v24, v11, s[28:31], s83 offen offset:64
  buffer_load_ushort v56, v11, s[28:31], s83 offen offset:320
  buffer_load_ushort v25, v11, s[28:31], s83 offen offset:576
  buffer_load_ushort v57, v11, s[28:31], s83 offen offset:832
  buffer_load_ushort v26, v11, s[28:31], s83 offen offset:2112
  buffer_load_ushort v58, v11, s[28:31], s83 offen offset:2368
  buffer_load_ushort v27, v11, s[28:31], s83 offen offset:2624
  buffer_load_ushort v59, v11, s[28:31], s83 offen offset:2880
  buffer_load_ushort v32, v11, s[28:31], s83 offen offset:128
  buffer_load_ushort v64, v11, s[28:31], s83 offen offset:384
  buffer_load_ushort v33, v11, s[28:31], s83 offen offset:640
  buffer_load_ushort v65, v11, s[28:31], s83 offen offset:896
  buffer_load_ushort v34, v11, s[28:31], s83 offen offset:2176
  buffer_load_ushort v66, v11, s[28:31], s83 offen offset:2432
  buffer_load_ushort v35, v11, s[28:31], s83 offen offset:2688
  buffer_load_ushort v67, v11, s[28:31], s83 offen offset:2944
  buffer_load_ushort v40, v11, s[28:31], s83 offen offset:192
  buffer_load_ushort v72, v11, s[28:31], s83 offen offset:448
  buffer_load_ushort v41, v11, s[28:31], s83 offen offset:704
  buffer_load_ushort v73, v11, s[28:31], s83 offen offset:960
  buffer_load_ushort v42, v11, s[28:31], s83 offen offset:2240
  buffer_load_ushort v74, v11, s[28:31], s83 offen offset:2496
  buffer_load_ushort v43, v11, s[28:31], s83 offen offset:2752
  buffer_load_ushort v75, v11, s[28:31], s83 offen offset:3008
  s_add_u32 s83, s82, 4096
  buffer_load_ushort v20, v11, s[28:31], s83 offen offset:0
  buffer_load_ushort v52, v11, s[28:31], s83 offen offset:256
  buffer_load_ushort v21, v11, s[28:31], s83 offen offset:512
  buffer_load_ushort v53, v11, s[28:31], s83 offen offset:768
  buffer_load_ushort v22, v11, s[28:31], s83 offen offset:2048
  buffer_load_ushort v54, v11, s[28:31], s83 offen offset:2304
  buffer_load_ushort v23, v11, s[28:31], s83 offen offset:2560
  buffer_load_ushort v55, v11, s[28:31], s83 offen offset:2816
  buffer_load_ushort v28, v11, s[28:31], s83 offen offset:64
  buffer_load_ushort v60, v11, s[28:31], s83 offen offset:320
  buffer_load_ushort v29, v11, s[28:31], s83 offen offset:576
  buffer_load_ushort v61, v11, s[28:31], s83 offen offset:832
  buffer_load_ushort v30, v11, s[28:31], s83 offen offset:2112
  buffer_load_ushort v62, v11, s[28:31], s83 offen offset:2368
  buffer_load_ushort v31, v11, s[28:31], s83 offen offset:2624
  buffer_load_ushort v63, v11, s[28:31], s83 offen offset:2880
  buffer_load_ushort v36, v11, s[28:31], s83 offen offset:128
  buffer_load_ushort v68, v11, s[28:31], s83 offen offset:384
  buffer_load_ushort v37, v11, s[28:31], s83 offen offset:640
  buffer_load_ushort v69, v11, s[28:31], s83 offen offset:896
  buffer_load_ushort v38, v11, s[28:31], s83 offen offset:2176
  buffer_load_ushort v70, v11, s[28:31], s83 offen offset:2432
  buffer_load_ushort v39, v11, s[28:31], s83 offen offset:2688
  buffer_load_ushort v71, v11, s[28:31], s83 offen offset:2944
  buffer_load_ushort v44, v11, s[28:31], s83 offen offset:192
  buffer_load_ushort v76, v11, s[28:31], s83 offen offset:448
  buffer_load_ushort v45, v11, s[28:31], s83 offen offset:704
  buffer_load_ushort v77, v11, s[28:31], s83 offen offset:960
  buffer_load_ushort v46, v11, s[28:31], s83 offen offset:2240
  buffer_load_ushort v78, v11, s[28:31], s83 offen offset:2496
  s_waitcnt vmcnt(60)
  buffer_load_ushort v47, v11, s[28:31], s83 offen offset:2752
  buffer_load_ushort v79, v11, s[28:31], s83 offen offset:3008
  s_waitcnt vmcnt(0) lgkmcnt(0)
  s_nop 15
  s_nop 15
  v_lshl_or_b32 v16, v48, 16, v16
  v_lshl_or_b32 v17, v49, 16, v17
  v_lshl_or_b32 v18, v50, 16, v18
  v_lshl_or_b32 v19, v51, 16, v19
  v_lshl_or_b32 v20, v52, 16, v20
  v_lshl_or_b32 v21, v53, 16, v21
  v_lshl_or_b32 v22, v54, 16, v22
  v_lshl_or_b32 v23, v55, 16, v23
  v_lshl_or_b32 v24, v56, 16, v24
  v_lshl_or_b32 v25, v57, 16, v25
  v_lshl_or_b32 v26, v58, 16, v26
  v_lshl_or_b32 v27, v59, 16, v27
  v_lshl_or_b32 v28, v60, 16, v28
  v_lshl_or_b32 v29, v61, 16, v29
  v_lshl_or_b32 v30, v62, 16, v30
  v_lshl_or_b32 v31, v63, 16, v31
  v_lshl_or_b32 v32, v64, 16, v32
  v_lshl_or_b32 v33, v65, 16, v33
  v_lshl_or_b32 v34, v66, 16, v34
  v_lshl_or_b32 v35, v67, 16, v35
  v_lshl_or_b32 v36, v68, 16, v36
  v_lshl_or_b32 v37, v69, 16, v37
  v_lshl_or_b32 v38, v70, 16, v38
  v_lshl_or_b32 v39, v71, 16, v39
  v_lshl_or_b32 v40, v72, 16, v40
  v_lshl_or_b32 v41, v73, 16, v41
  v_lshl_or_b32 v42, v74, 16, v42
  v_lshl_or_b32 v43, v75, 16, v43
  v_lshl_or_b32 v44, v76, 16, v44
  v_lshl_or_b32 v45, v77, 16, v45
  v_lshl_or_b32 v46, v78, 16, v46
  v_lshl_or_b32 v47, v79, 16, v47
  s_waitcnt vmcnt(0) lgkmcnt(0)
  s_nop 15
  s_nop 15
  v_mfma_f32_32x32x16_bf16 a[0:15], v[16:19], v[96:99], a[0:15]
  v_mfma_f32_32x32x16_bf16 a[16:31], v[16:19], v[104:107], a[16:31]
  v_mfma_f32_32x32x16_bf16 a[0:15], v[20:23], v[100:103], a[0:15]
  v_mfma_f32_32x32x16_bf16 a[16:31], v[20:23], v[108:111], a[16:31]
  v_mfma_f32_32x32x16_bf16 a[32:47], v[24:27], v[96:99], a[32:47]
  v_mfma_f32_32x32x16_bf16 a[48:63], v[24:27], v[104:107], a[48:63]
  v_mfma_f32_32x32x16_bf16 a[32:47], v[28:31], v[100:103], a[32:47]
  v_mfma_f32_32x32x16_bf16 a[48:63], v[28:31], v[108:111], a[48:63]
  v_mfma_f32_32x32x16_bf16 a[64:79], v[32:35], v[96:99], a[64:79]
  v_mfma_f32_32x32x16_bf16 a[80:95], v[32:35], v[104:107], a[80:95]
  v_mfma_f32_32x32x16_bf16 a[64:79], v[36:39], v[100:103], a[64:79]
  v_mfma_f32_32x32x16_bf16 a[80:95], v[36:39], v[108:111], a[80:95]
  v_mfma_f32_32x32x16_bf16 a[96:111], v[40:43], v[96:99], a[96:111]
  v_mfma_f32_32x32x16_bf16 a[112:127], v[40:43], v[104:107], a[112:127]
  v_mfma_f32_32x32x16_bf16 a[96:111], v[44:47], v[100:103], a[96:111]
  v_mfma_f32_32x32x16_bf16 a[112:127], v[44:47], v[108:111], a[112:127]
  s_add_u32 s82, s82, 8192
  s_waitcnt vmcnt(0) lgkmcnt(0)
  s_nop 15
  s_nop 15
  s_branch L_slow2
L_slow3:
  ds_read_b64_tr_b16 a[160:161], v212 offset:40960
  ds_read_b64_tr_b16 a[162:163], v212 offset:43008
  ds_read_b64_tr_b16 a[164:165], v212 offset:45056
  ds_read_b64_tr_b16 a[166:167], v212 offset:47104
  ds_read_b64_tr_b16 a[168:169], v213 offset:40960
  ds_read_b64_tr_b16 a[170:171], v213 offset:43008
  ds_read_b64_tr_b16 a[172:173], v213 offset:45056
  ds_read_b64_tr_b16 a[174:175], v213 offset:47104
  ds_read_b64_tr_b16 a[176:177], v214 offset:40960
  ds_read_b64_tr_b16 a[178:179], v214 offset:43008
  ds_read_b64_tr_b16 a[180:181], v214 offset:45056
  ds_read_b64_tr_b16 a[182:183], v214 offset:47104
  ds_read_b64_tr_b16 a[184:185], v215 offset:40960
  ds_read_b64_tr_b16 a[186:187], v215 offset:43008
  ds_read_b64_tr_b16 a[188:189], v215 offset:45056
  ds_read_b64_tr_b16 a[190:191], v215 offset:47104
  v_add_f32 v192, v192, v193
  v_mov_b32 v193, v192
  v_add_f32 v194, v194, v195
  v_mov_b32 v195, v194
  v_permlane32_swap_b32 v192, v193
  s_nop 0
  v_permlane32_swap_b32 v194, v195
  v_add_f32 v192, v192, v193
  v_add_f32 v194, v194, v195
  v_rcp_f32 v193, v192
  v_rcp_f32 v195, v194
  s_waitcnt vmcnt(0) lgkmcnt(0)
  s_nop 15
  s_nop 15
  s_branch L_slow_back
.section .rodata,"a"
.p2align 6
.amdhsa_kernel recurrent_scan__sliding_block_cached__swiglu_ffn__prompt_kernel
  .amdhsa_next_free_vgpr 512
  .amdhsa_next_free_sgpr 102
  .amdhsa_accum_offset 256
  .amdhsa_group_segment_fixed_size 0
  .amdhsa_kernarg_size 96
  .amdhsa_user_sgpr_count 2
  .amdhsa_user_sgpr_kernarg_segment_ptr 1
  .amdhsa_system_sgpr_workgroup_id_x 1
.end_amdhsa_kernel
```
